```python
import torch

def _softmax(x, axis=-1):
    return torch.softmax(x, dim=axis)

def _gelu(x):
    return torch.nn.functional.gelu(x, approximate='tanh')

def _silu(x):
    return torch.nn.functional.silu(x)

def _sigmoid(x):
    return torch.sigmoid(x)

def _layernorm(x, axis=-1, eps=1e-05):
    m = x.mean(dim=axis, keepdim=True)
    v = x.var(dim=axis, keepdim=True, unbiased=False)
    return (x - m) / torch.sqrt(v + eps)

def _scatter_add(tgt, idx, src, axis=0):
    return tgt.clone().index_add_(axis, idx, src)

def _segment_sum(src, seg, n):
    out = torch.zeros((n,) + src.shape[1:], dtype=src.dtype)
    return out.index_add_(0, seg, src)

def _pad(x, pw):
    flat = tuple((v for pair in reversed(pw) for v in pair))
    return torch.nn.functional.pad(x, flat)
kernel_name = 'gated_mix__memory_aug_recurrent_mem_tr__glu_gated_glu__prompt'

def setup_inputs():

    _w = lambda a: (lambda t: t.to(torch.bfloat16) if t.is_floating_point() else t)(torch.as_tensor(a))

    def _A_setup():
        B, S, Dm = (1, 2048, 640)
        H, Dh = (32, 192)
        M, seg = (8, 32)
        seg = min(seg, S)
        S = S // seg * seg
        return {'x': _w((lambda *s: torch.randn(*s, dtype=torch.bfloat16) * 0.05)(B, S, Dm)), 'mem0': _w((lambda *s: torch.randn(*s, dtype=torch.bfloat16) * 0.8)(B, M, Dm)), 'Wq': _w((lambda *s: torch.randn(*s, dtype=torch.bfloat16) * 1.6)(Dm, H, Dh) * Dm ** (-0.5)), 'Wk': _w((lambda *s: torch.randn(*s, dtype=torch.bfloat16) * 1.6)(Dm, H, Dh) * Dm ** (-0.5)), 'Wv': _w((lambda *s: torch.randn(*s, dtype=torch.bfloat16) * 0.8)(Dm, H, Dh) * Dm ** (-0.5)), 'Wo': _w((lambda *s: torch.randn(*s, dtype=torch.bfloat16) * 0.8)(H, Dh, Dm) * (H * Dh) ** (-0.5)), 'seg_len': seg}
    _A_in = _A_setup()

    def _B_setup():
        B, S, D, F = (1, 2048, 640, 1536)
        return {'x': _w((lambda *s: torch.randn(*s, dtype=torch.bfloat16) * 0.05)(B, S, D)), 'w_gate': _w((lambda *s: torch.randn(*s, dtype=torch.bfloat16) * 0.4)(D, F)), 'w_up': _w((lambda *s: torch.randn(*s, dtype=torch.bfloat16) * 0.05)(D, F)), 'w_down': _w((lambda *s: torch.randn(*s, dtype=torch.bfloat16) * 0.05)(F, D))}
    _B_in = _B_setup()
    return {'A_x': _A_in['x'], 'A_mem0': _A_in['mem0'], 'A_Wq': _A_in['Wq'], 'A_Wk': _A_in['Wk'], 'A_Wv': _A_in['Wv'], 'A_Wo': _A_in['Wo'], 'A_seg_len': _A_in['seg_len'], 'B_x': _B_in['x'], 'B_w_gate': _B_in['w_gate'], 'B_w_up': _B_in['w_up'], 'B_w_down': _B_in['w_down'], 'gate_w': _w((lambda *s: torch.randn(*s, dtype=torch.bfloat16) * 0.05)(640) * 16.0)}

def reference(A_x, A_mem0, A_Wq, A_Wk, A_Wv, A_Wo, A_seg_len, B_x, B_w_gate, B_w_up, B_w_down, gate_w):

    def _A_ref(x, mem0, Wq, Wk, Wv, Wo, seg_len):
        B, S, Dm = x.shape
        H, Dh = (Wq.shape[1], Wq.shape[2])
        M = mem0.shape[1]
        scale = Dh ** (-0.5)
        n_seg = S // seg_len
        L = M + seg_len
        idx = torch.arange(L)
        mask = (idx[:, None] < M) | (idx[:, None] >= idx[None, :])
        mem = mem0
        outs = []
        for s in range(n_seg):
            xs = x[:, s * seg_len:(s + 1) * seg_len, :].clone()
            h = torch.concatenate([mem, xs], axis=1)
            q = torch.einsum('btd,dhe->bhte', h, Wq)
            k = torch.einsum('btd,dhe->bhte', h, Wk)
            v = torch.einsum('btd,dhe->bhte', h, Wv)
            scores = torch.einsum('bhqe,bhke->bhqk', q, k) * scale
            scores = torch.where(mask[None, None], scores, -1000000000.0)
            p = _softmax(scores, axis=-1)
            o = torch.einsum('bhqk,bhke->bhqe', p, v)
            o = torch.einsum('bhte,hed->btd', o, Wo)
            mem = o[:, :M, :].clone()
            outs.append(o[:, M:, :])
        return torch.concatenate(outs, axis=1)

    def _B_ref(x, w_gate, w_up, w_down):
        g = torch.einsum('bsd,df->bsf', x, w_gate)
        u = torch.einsum('bsd,df->bsf', x, w_up)
        h = _sigmoid(g) * u
        return torch.einsum('bsf,fd->bsd', h, w_down)
    x = A_x
    g = _sigmoid((x * gate_w).sum(-1, keepdims=True))
    a = _A_ref(x, A_mem0, A_Wq, A_Wk, A_Wv, A_Wo, A_seg_len)
    b = _B_ref(x, B_w_gate, B_w_up, B_w_down)
    return g * a + (1 - g) * b
```

```asm
; @launch grid=(256,1,1) block=(256,1,1) lds=163840
.amdgcn_target "amdgcn-amd-amdhsa--gfx950"
.text
.globl gated_mix__memory_aug_recurrent_mem_tr__glu_gated_glu__prompt_kernel
.p2align 8
.type gated_mix__memory_aug_recurrent_mem_tr__glu_gated_glu__prompt_kernel,@function
gated_mix__memory_aug_recurrent_mem_tr__glu_gated_glu__prompt_kernel:
    s_load_dwordx2 s[4:5], s[0:1], 112
    s_load_dwordx2 s[6:7], s[0:1], 0
    s_load_dwordx2 s[36:37], s[0:1], 104
    s_load_dwordx2 s[38:39], s[0:1], 96
    s_getreg_b32 s40, hwreg(HW_REG_XCC_ID)
    v_lshrrev_b32 v1, 6, v0
    v_and_b32 v0, 63, v0
    v_readfirstlane_b32 s33, v1
    s_and_b32 s40, s40, 7
    s_mov_b32 s34, 0
    s_mov_b32 s35, 1048576
    s_mov_b32 s44, 0xffff
    s_waitcnt lgkmcnt(0)
    s_mov_b32 s8, s4
    s_mov_b32 s9, s5
    s_mov_b32 s10, 268435456
    s_mov_b32 s11, 0x20000
    s_mov_b32 s12, s6
    s_mov_b32 s13, s7
    s_mov_b32 s14, 2621440
    s_mov_b32 s15, 0x20000
    s_mov_b32 s28, s36
    s_mov_b32 s29, s37
    s_mov_b32 s30, 256
    s_mov_b32 s31, 0x20000
    s_mov_b32 s24, s38
    s_mov_b32 s25, s39
    s_mov_b32 s26, 2621440
    s_mov_b32 s27, 0x20000
    v_mov_b32 v5, 163824
    s_cmp_lg_u32 s33, 0
    s_cbranch_scc1 L_TK_WAIT
    s_mov_b32 s41, 32
    s_cmp_eq_u32 s40, 3
    s_cselect_b32 s41, 30, s41
    s_lshl_b32 s42, s40, 5
    v_mov_b32 v1, 1
    v_mov_b32 v2, s42
    s_mov_b64 exec, 1
    buffer_atomic_add v1, v2, s[28:31], 0 offen sc0 sc1
    s_waitcnt vmcnt(0)
    v_readfirstlane_b32 s43, v1
    s_mov_b64 exec, -1
    s_cmp_lt_u32 s43, s41
    s_cbranch_scc0 L_TK_SPARE
    s_add_u32 s44, s42, s43
    s_branch L_TK_HAVE
L_TK_SPARE:
    v_min_u32 v2, 7, v0
    v_mov_b32 v3, 32
    v_cmp_eq_u32 vcc, 3, v2
    s_nop 1
    v_cndmask_b32 v3, v3, 30, vcc
    v_lshlrev_b32 v2, 5, v2
    s_movk_i32 s47, 0x400
L_TK_SPIN:
    buffer_load_dword v1, v2, s[28:31], 0 offen sc1
    s_waitcnt vmcnt(0)
    v_cmp_lt_u32 vcc, v1, v3
    s_cbranch_vccz L_TK_NONE
    s_sub_u32 s47, s47, 1
    s_cbranch_scc0 L_TK_SPIN
    s_mov_b32 s40, 0
L_TK_STEAL:
    s_mov_b32 s41, 32
    s_cmp_eq_u32 s40, 3
    s_cselect_b32 s41, 30, s41
    s_lshl_b32 s42, s40, 5
    v_mov_b32 v1, 1
    v_mov_b32 v2, s42
    s_mov_b64 exec, 1
    buffer_atomic_add v1, v2, s[28:31], 0 offen sc0 sc1
    s_waitcnt vmcnt(0)
    v_readfirstlane_b32 s43, v1
    s_mov_b64 exec, -1
    s_cmp_lt_u32 s43, s41
    s_cbranch_scc0 L_TK_NEXT
    s_add_u32 s44, s42, s43
    s_branch L_TK_HAVE
L_TK_NEXT:
    s_add_u32 s40, s40, 1
    s_cmp_lt_u32 s40, 8
    s_cbranch_scc1 L_TK_STEAL
L_TK_NONE:
    s_mov_b32 s44, 0xffff
L_TK_HAVE:
    v_mov_b32 v1, s44
    ds_write_b32 v5, v1
L_TK_WAIT:
    s_waitcnt lgkmcnt(0)
    s_barrier
    ds_read_b32 v1, v5
    s_waitcnt lgkmcnt(0)
    v_readfirstlane_b32 s44, v1
    s_mov_b32 s45, s44
    s_cmp_gt_u32 s45, 255
    s_cbranch_scc1 RM_1
    s_add_u32 s44, s45, 0
    s_cmp_lt_u32 s45, 112
    s_cbranch_scc1 RM_1
    s_add_u32 s44, s45, 16
    s_cmp_lt_u32 s45, 128
    s_cbranch_scc1 RM_1
    s_add_u32 s44, s45, 14
    s_cmp_lt_u32 s45, 226
    s_cbranch_scc1 RM_1
    s_sub_u32 s44, s45, 104
    s_cmp_lt_u32 s45, 232
    s_cbranch_scc1 RM_1
    s_add_u32 s44, s45, 20
    s_cmp_lt_u32 s45, 234
    s_cbranch_scc1 RM_1
    s_add_u32 s44, s45, 6
    s_cmp_lt_u32 s45, 246
    s_cbranch_scc1 RM_1
    s_sub_u32 s44, s45, 134
    s_cmp_lt_u32 s45, 256
    s_cbranch_scc1 RM_1
RM_1:
    s_sub_u32 s32, s44, 0
    s_cmp_lt_u32 s44, 32
    s_cbranch_scc1 L_R1
    s_sub_u32 s32, s44, 32
    s_cmp_lt_u32 s44, 112
    s_cbranch_scc1 L_R2
    s_sub_u32 s32, s44, 112
    s_cmp_lt_u32 s44, 122
    s_cbranch_scc1 L_F2
    s_sub_u32 s32, s44, 122
    s_cmp_lt_u32 s44, 128
    s_cbranch_scc1 L_R5
    s_sub_u32 s32, s44, 128
    s_cmp_lt_u32 s44, 208
    s_cbranch_scc1 L_R3
    s_sub_u32 s32, s44, 208
    s_cmp_lt_u32 s44, 240
    s_cbranch_scc1 L_R4
    s_sub_u32 s32, s44, 240
    s_cmp_lt_u32 s44, 252
    s_cbranch_scc1 L_F1
    s_sub_u32 s32, s44, 246
    s_cmp_lt_u32 s44, 254
    s_cbranch_scc1 L_R5
L_EXIT:
    s_endpgm
L_R1:
    s_lshr_b32 s48, s32, 3
    s_bfe_u32 s49, s32, 0x20001
    s_and_b32 s50, s32, 1
    s_lshl_b32 s51, s48, 2
    s_add_u32 s51, s51, s49
    s_lshl_b32 s51, s51, 10
    s_lshl_b32 s45, s50, 7
    s_add_u32 s73, s51, s45
    s_lshr_b32 s46, s49, 1
    s_and_b32 s47, s49, 1
    s_lshl_b32 s47, s47, 1
    s_or_b32 s46, s46, s47
    s_lshl_b32 s46, s46, 8
    s_lshl_b32 s47, s48, 10
    s_add_u32 s46, s46, s47
    s_add_u32 s46, s46, s45
    s_add_u32 s74, s46, 16384
    v_mov_b32 v20, -1
    v_mov_b32 v21, -1
    v_mov_b32 v22, -1
    v_mov_b32 v23, -1
    s_lshl_b32 s45, s33, 6
    v_add_u32 v16, s45, v0
    v_lshrrev_b32 v17, 3, v16
    v_mul_u32_u24 v17, 20480, v17
    v_and_b32 v16, 7, v16
    v_lshl_add_u32 v17, v16, 4, v17
    s_add_u32 s45, s73, 786432
    buffer_store_dwordx4 v[20:23], v17, s[8:11], s45 offen sc1
    s_add_u32 s45, s73, 1441792
    buffer_store_dwordx4 v[20:23], v17, s[8:11], s45 offen sc1
    s_add_u32 s45, s73, 786688
    buffer_store_dwordx4 v[20:23], v17, s[8:11], s45 offen sc1
    s_add_u32 s45, s73, 1442048
    buffer_store_dwordx4 v[20:23], v17, s[8:11], s45 offen sc1
    s_add_u32 s45, s73, 786944
    buffer_store_dwordx4 v[20:23], v17, s[8:11], s45 offen sc1
    s_add_u32 s45, s73, 1442304
    buffer_store_dwordx4 v[20:23], v17, s[8:11], s45 offen sc1
    s_add_u32 s45, s73, 787200
    buffer_store_dwordx4 v[20:23], v17, s[8:11], s45 offen sc1
    s_add_u32 s45, s73, 1442560
    buffer_store_dwordx4 v[20:23], v17, s[8:11], s45 offen sc1
    s_add_u32 s45, s74, 786432
    buffer_store_dwordx4 v[20:23], v17, s[8:11], s45 offen sc1
    s_add_u32 s45, s74, 1441792
    buffer_store_dwordx4 v[20:23], v17, s[8:11], s45 offen sc1
    s_lshl_b32 s65, s32, 7
    s_add_u32 s55, s65, 1024
    s_add_u32 s65, s65, 10240
    s_cmp_lg_u32 s33, 0
    s_cbranch_scc1 R1R_2
    v_mov_b32 v1, 0
    v_mov_b32 v2, s65
    s_mov_b64 exec, 1
    buffer_store_dword v1, v2, s[8:11], 0 offen sc1
    s_mov_b64 exec, -1
R1R_2:
    s_waitcnt vmcnt(0) lgkmcnt(0)
    s_barrier
    s_cmp_lg_u32 s33, 0
    s_cbranch_scc1 SI_3
    v_mov_b32 v1, 1
    v_mov_b32 v2, 4
    s_mov_b64 exec, 1
    buffer_atomic_add v1, v2, s[28:31], 0 offen sc1
    s_mov_b64 exec, -1
SI_3:
    s_cmp_lt_u32 s33, 2
    s_cbranch_scc0 QK_4
    s_load_dwordx2 s[4:5], s[0:1], 16
    s_branch QK_5
QK_4:
    s_load_dwordx2 s[4:5], s[0:1], 24
QK_5:
    s_waitcnt lgkmcnt(0)
    s_mov_b32 s16, s4
    s_mov_b32 s17, s5
    s_mov_b32 s18, 7864320
    s_mov_b32 s19, 0x20000
    v_add_u32 v22, 0, v0
    v_mul_u32_u24 v23, 43691, v22
    v_lshrrev_b32 v23, 19, v23
    v_mul_u32_u24 v24, 12, v23
    v_sub_u32 v24, v22, v24
    v_mul_u32_u24 v23, 12288, v23
    v_lshl_add_u32 v16, v24, 4, v23
    v_add_u32 v22, 64, v0
    v_mul_u32_u24 v23, 43691, v22
    v_lshrrev_b32 v23, 19, v23
    v_mul_u32_u24 v24, 12, v23
    v_sub_u32 v24, v22, v24
    v_mul_u32_u24 v23, 12288, v23
    v_lshl_add_u32 v17, v24, 4, v23
    v_add_u32 v22, 128, v0
    v_mul_u32_u24 v23, 43691, v22
    v_lshrrev_b32 v23, 19, v23
    v_mul_u32_u24 v24, 12, v23
    v_sub_u32 v24, v22, v24
    v_mul_u32_u24 v23, 12288, v23
    v_lshl_add_u32 v18, v24, 4, v23
    v_add_u32 v22, 192, v0
    v_mul_u32_u24 v23, 43691, v22
    v_lshrrev_b32 v23, 19, v23
    v_mul_u32_u24 v24, 12, v23
    v_sub_u32 v24, v22, v24
    v_mul_u32_u24 v23, 12288, v23
    v_lshl_add_u32 v19, v24, 4, v23
    v_add_u32 v22, 256, v0
    v_mul_u32_u24 v23, 43691, v22
    v_lshrrev_b32 v23, 19, v23
    v_mul_u32_u24 v24, 12, v23
    v_sub_u32 v24, v22, v24
    v_mul_u32_u24 v23, 12288, v23
    v_lshl_add_u32 v20, v24, 4, v23
    v_add_u32 v22, 320, v0
    v_mul_u32_u24 v23, 43691, v22
    v_lshrrev_b32 v23, 19, v23
    v_mul_u32_u24 v24, 12, v23
    v_sub_u32 v24, v22, v24
    v_mul_u32_u24 v23, 12288, v23
    v_lshl_add_u32 v21, v24, 4, v23
    v_lshrrev_b32 v22, 4, v0
    v_bfe_u32 v23, v0, 2, 2
    v_lshl_add_u32 v22, v22, 3, v23
    v_mul_u32_u24 v22, 192, v22
    v_and_b32 v23, 3, v0
    v_lshl_add_u32 v25, v23, 3, v22
    s_mul_i32 s50, s33, 24576
    s_add_u32 s50, s50, 49152
    v_add_u32 v25, s50, v25
    s_mul_i32 s51, s32, 384
    s_and_b32 s45, s33, 1
    s_mul_i32 s45, s45, 192
    s_add_u32 s51, s51, s45
    v_lshlrev_b32 v4, 4, v0
    s_lshl_b32 s45, s33, 13
    v_add_u32 v4, s45, v4
    s_add_u32 s46, s51, 0
    s_add_u32 m0, s50, 0
    s_nop 0
    buffer_load_dwordx4 v16, s[16:19], s46 offen lds
    s_add_u32 m0, s50, 1024
    s_nop 0
    buffer_load_dwordx4 v17, s[16:19], s46 offen lds
    s_add_u32 m0, s50, 2048
    s_nop 0
    buffer_load_dwordx4 v18, s[16:19], s46 offen lds
    s_add_u32 m0, s50, 3072
    s_nop 0
    buffer_load_dwordx4 v19, s[16:19], s46 offen lds
    s_add_u32 m0, s50, 4096
    s_nop 0
    buffer_load_dwordx4 v20, s[16:19], s46 offen lds
    s_add_u32 m0, s50, 5120
    s_nop 0
    buffer_load_dwordx4 v21, s[16:19], s46 offen lds
    s_add_u32 s46, s51, 393216
    s_add_u32 m0, s50, 6144
    s_nop 0
    buffer_load_dwordx4 v16, s[16:19], s46 offen lds
    s_add_u32 m0, s50, 7168
    s_nop 0
    buffer_load_dwordx4 v17, s[16:19], s46 offen lds
    s_add_u32 m0, s50, 8192
    s_nop 0
    buffer_load_dwordx4 v18, s[16:19], s46 offen lds
    s_add_u32 m0, s50, 9216
    s_nop 0
    buffer_load_dwordx4 v19, s[16:19], s46 offen lds
    s_add_u32 m0, s50, 10240
    s_nop 0
    buffer_load_dwordx4 v20, s[16:19], s46 offen lds
    s_add_u32 m0, s50, 11264
    s_nop 0
    buffer_load_dwordx4 v21, s[16:19], s46 offen lds
    s_add_u32 s46, s51, 786432
    s_add_u32 m0, s50, 12288
    s_nop 0
    buffer_load_dwordx4 v16, s[16:19], s46 offen lds
    s_add_u32 m0, s50, 13312
    s_nop 0
    buffer_load_dwordx4 v17, s[16:19], s46 offen lds
    s_add_u32 m0, s50, 14336
    s_nop 0
    buffer_load_dwordx4 v18, s[16:19], s46 offen lds
    s_add_u32 m0, s50, 15360
    s_nop 0
    buffer_load_dwordx4 v19, s[16:19], s46 offen lds
    s_add_u32 m0, s50, 16384
    s_nop 0
    buffer_load_dwordx4 v20, s[16:19], s46 offen lds
    s_add_u32 m0, s50, 17408
    s_nop 0
    buffer_load_dwordx4 v21, s[16:19], s46 offen lds
    s_add_u32 s46, s51, 1179648
    s_add_u32 m0, s50, 18432
    s_nop 0
    buffer_load_dwordx4 v16, s[16:19], s46 offen lds
    s_add_u32 m0, s50, 19456
    s_nop 0
    buffer_load_dwordx4 v17, s[16:19], s46 offen lds
    s_add_u32 m0, s50, 20480
    s_nop 0
    buffer_load_dwordx4 v18, s[16:19], s46 offen lds
    s_add_u32 m0, s50, 21504
    s_nop 0
    buffer_load_dwordx4 v19, s[16:19], s46 offen lds
    s_add_u32 m0, s50, 22528
    s_nop 0
    buffer_load_dwordx4 v20, s[16:19], s46 offen lds
    s_add_u32 m0, s50, 23552
    s_nop 0
    buffer_load_dwordx4 v21, s[16:19], s46 offen lds
    s_waitcnt vmcnt(18)
    ds_read_b64_tr_b16 a[0:1], v25 offset:0
    ds_read_b64_tr_b16 a[2:3], v25 offset:768
    ds_read_b64_tr_b16 a[8:9], v25 offset:32
    ds_read_b64_tr_b16 a[10:11], v25 offset:800
    ds_read_b64_tr_b16 a[16:17], v25 offset:64
    ds_read_b64_tr_b16 a[18:19], v25 offset:832
    ds_read_b64_tr_b16 a[24:25], v25 offset:96
    ds_read_b64_tr_b16 a[26:27], v25 offset:864
    ds_read_b64_tr_b16 a[32:33], v25 offset:128
    ds_read_b64_tr_b16 a[34:35], v25 offset:896
    ds_read_b64_tr_b16 a[40:41], v25 offset:160
    ds_read_b64_tr_b16 a[42:43], v25 offset:928
    s_waitcnt lgkmcnt(0)
    s_add_u32 s46, s51, 1572864
    s_add_u32 m0, s50, 0
    s_nop 0
    buffer_load_dwordx4 v16, s[16:19], s46 offen lds
    s_add_u32 m0, s50, 1024
    s_nop 0
    buffer_load_dwordx4 v17, s[16:19], s46 offen lds
    s_add_u32 m0, s50, 2048
    s_nop 0
    buffer_load_dwordx4 v18, s[16:19], s46 offen lds
    s_add_u32 m0, s50, 3072
    s_nop 0
    buffer_load_dwordx4 v19, s[16:19], s46 offen lds
    s_add_u32 m0, s50, 4096
    s_nop 0
    buffer_load_dwordx4 v20, s[16:19], s46 offen lds
    s_add_u32 m0, s50, 5120
    s_nop 0
    buffer_load_dwordx4 v21, s[16:19], s46 offen lds
    s_waitcnt vmcnt(18)
    ds_read_b64_tr_b16 a[4:5], v25 offset:6144
    ds_read_b64_tr_b16 a[6:7], v25 offset:6912
    ds_read_b64_tr_b16 a[12:13], v25 offset:6176
    ds_read_b64_tr_b16 a[14:15], v25 offset:6944
    ds_read_b64_tr_b16 a[20:21], v25 offset:6208
    ds_read_b64_tr_b16 a[22:23], v25 offset:6976
    ds_read_b64_tr_b16 a[28:29], v25 offset:6240
    ds_read_b64_tr_b16 a[30:31], v25 offset:7008
    ds_read_b64_tr_b16 a[36:37], v25 offset:6272
    ds_read_b64_tr_b16 a[38:39], v25 offset:7040
    ds_read_b64_tr_b16 a[44:45], v25 offset:6304
    ds_read_b64_tr_b16 a[46:47], v25 offset:7072
    s_waitcnt lgkmcnt(0)
    s_add_u32 s46, s51, 1966080
    s_add_u32 m0, s50, 6144
    s_nop 0
    buffer_load_dwordx4 v16, s[16:19], s46 offen lds
    s_add_u32 m0, s50, 7168
    s_nop 0
    buffer_load_dwordx4 v17, s[16:19], s46 offen lds
    s_add_u32 m0, s50, 8192
    s_nop 0
    buffer_load_dwordx4 v18, s[16:19], s46 offen lds
    s_add_u32 m0, s50, 9216
    s_nop 0
    buffer_load_dwordx4 v19, s[16:19], s46 offen lds
    s_add_u32 m0, s50, 10240
    s_nop 0
    buffer_load_dwordx4 v20, s[16:19], s46 offen lds
    s_add_u32 m0, s50, 11264
    s_nop 0
    buffer_load_dwordx4 v21, s[16:19], s46 offen lds
    s_waitcnt vmcnt(18)
    ds_read_b64_tr_b16 v[52:53], v25 offset:12288
    ds_read_b64_tr_b16 v[54:55], v25 offset:13056
    ds_read_b64_tr_b16 a[48:49], v25 offset:12320
    ds_read_b64_tr_b16 a[50:51], v25 offset:13088
    ds_read_b64_tr_b16 a[56:57], v25 offset:12352
    ds_read_b64_tr_b16 a[58:59], v25 offset:13120
    ds_read_b64_tr_b16 a[64:65], v25 offset:12384
    ds_read_b64_tr_b16 a[66:67], v25 offset:13152
    ds_read_b64_tr_b16 a[72:73], v25 offset:12416
    ds_read_b64_tr_b16 a[74:75], v25 offset:13184
    ds_read_b64_tr_b16 a[80:81], v25 offset:12448
    ds_read_b64_tr_b16 a[82:83], v25 offset:13216
    s_waitcnt lgkmcnt(0)
    ds_write_b128 v4, v[52:55] offset:0
    s_add_u32 s46, s51, 2359296
    s_add_u32 m0, s50, 12288
    s_nop 0
    buffer_load_dwordx4 v16, s[16:19], s46 offen lds
    s_add_u32 m0, s50, 13312
    s_nop 0
    buffer_load_dwordx4 v17, s[16:19], s46 offen lds
    s_add_u32 m0, s50, 14336
    s_nop 0
    buffer_load_dwordx4 v18, s[16:19], s46 offen lds
    s_add_u32 m0, s50, 15360
    s_nop 0
    buffer_load_dwordx4 v19, s[16:19], s46 offen lds
    s_add_u32 m0, s50, 16384
    s_nop 0
    buffer_load_dwordx4 v20, s[16:19], s46 offen lds
    s_add_u32 m0, s50, 17408
    s_nop 0
    buffer_load_dwordx4 v21, s[16:19], s46 offen lds
    s_waitcnt vmcnt(18)
    ds_read_b64_tr_b16 v[52:53], v25 offset:18432
    ds_read_b64_tr_b16 v[54:55], v25 offset:19200
    ds_read_b64_tr_b16 a[52:53], v25 offset:18464
    ds_read_b64_tr_b16 a[54:55], v25 offset:19232
    ds_read_b64_tr_b16 a[60:61], v25 offset:18496
    ds_read_b64_tr_b16 a[62:63], v25 offset:19264
    ds_read_b64_tr_b16 a[68:69], v25 offset:18528
    ds_read_b64_tr_b16 a[70:71], v25 offset:19296
    ds_read_b64_tr_b16 a[76:77], v25 offset:18560
    ds_read_b64_tr_b16 a[78:79], v25 offset:19328
    ds_read_b64_tr_b16 a[84:85], v25 offset:18592
    ds_read_b64_tr_b16 a[86:87], v25 offset:19360
    s_waitcnt lgkmcnt(0)
    ds_write_b128 v4, v[52:55] offset:1024
    s_add_u32 s46, s51, 2752512
    s_add_u32 m0, s50, 18432
    s_nop 0
    buffer_load_dwordx4 v16, s[16:19], s46 offen lds
    s_add_u32 m0, s50, 19456
    s_nop 0
    buffer_load_dwordx4 v17, s[16:19], s46 offen lds
    s_add_u32 m0, s50, 20480
    s_nop 0
    buffer_load_dwordx4 v18, s[16:19], s46 offen lds
    s_add_u32 m0, s50, 21504
    s_nop 0
    buffer_load_dwordx4 v19, s[16:19], s46 offen lds
    s_add_u32 m0, s50, 22528
    s_nop 0
    buffer_load_dwordx4 v20, s[16:19], s46 offen lds
    s_add_u32 m0, s50, 23552
    s_nop 0
    buffer_load_dwordx4 v21, s[16:19], s46 offen lds
    s_waitcnt vmcnt(18)
    ds_read_b64_tr_b16 a[88:89], v25 offset:0
    ds_read_b64_tr_b16 a[90:91], v25 offset:768
    ds_read_b64_tr_b16 a[96:97], v25 offset:32
    ds_read_b64_tr_b16 a[98:99], v25 offset:800
    ds_read_b64_tr_b16 a[104:105], v25 offset:64
    ds_read_b64_tr_b16 a[106:107], v25 offset:832
    ds_read_b64_tr_b16 a[112:113], v25 offset:96
    ds_read_b64_tr_b16 a[114:115], v25 offset:864
    ds_read_b64_tr_b16 a[120:121], v25 offset:128
    ds_read_b64_tr_b16 a[122:123], v25 offset:896
    ds_read_b64_tr_b16 a[128:129], v25 offset:160
    ds_read_b64_tr_b16 a[130:131], v25 offset:928
    s_waitcnt lgkmcnt(0)
    s_add_u32 s46, s51, 3145728
    s_add_u32 m0, s50, 0
    s_nop 0
    buffer_load_dwordx4 v16, s[16:19], s46 offen lds
    s_add_u32 m0, s50, 1024
    s_nop 0
    buffer_load_dwordx4 v17, s[16:19], s46 offen lds
    s_add_u32 m0, s50, 2048
    s_nop 0
    buffer_load_dwordx4 v18, s[16:19], s46 offen lds
    s_add_u32 m0, s50, 3072
    s_nop 0
    buffer_load_dwordx4 v19, s[16:19], s46 offen lds
    s_add_u32 m0, s50, 4096
    s_nop 0
    buffer_load_dwordx4 v20, s[16:19], s46 offen lds
    s_add_u32 m0, s50, 5120
    s_nop 0
    buffer_load_dwordx4 v21, s[16:19], s46 offen lds
    s_waitcnt vmcnt(18)
    ds_read_b64_tr_b16 a[92:93], v25 offset:6144
    ds_read_b64_tr_b16 a[94:95], v25 offset:6912
    ds_read_b64_tr_b16 a[100:101], v25 offset:6176
    ds_read_b64_tr_b16 a[102:103], v25 offset:6944
    ds_read_b64_tr_b16 a[108:109], v25 offset:6208
    ds_read_b64_tr_b16 a[110:111], v25 offset:6976
    ds_read_b64_tr_b16 a[116:117], v25 offset:6240
    ds_read_b64_tr_b16 a[118:119], v25 offset:7008
    ds_read_b64_tr_b16 a[124:125], v25 offset:6272
    ds_read_b64_tr_b16 a[126:127], v25 offset:7040
    ds_read_b64_tr_b16 a[132:133], v25 offset:6304
    ds_read_b64_tr_b16 a[134:135], v25 offset:7072
    s_waitcnt lgkmcnt(0)
    s_add_u32 s46, s51, 3538944
    s_add_u32 m0, s50, 6144
    s_nop 0
    buffer_load_dwordx4 v16, s[16:19], s46 offen lds
    s_add_u32 m0, s50, 7168
    s_nop 0
    buffer_load_dwordx4 v17, s[16:19], s46 offen lds
    s_add_u32 m0, s50, 8192
    s_nop 0
    buffer_load_dwordx4 v18, s[16:19], s46 offen lds
    s_add_u32 m0, s50, 9216
    s_nop 0
    buffer_load_dwordx4 v19, s[16:19], s46 offen lds
    s_add_u32 m0, s50, 10240
    s_nop 0
    buffer_load_dwordx4 v20, s[16:19], s46 offen lds
    s_add_u32 m0, s50, 11264
    s_nop 0
    buffer_load_dwordx4 v21, s[16:19], s46 offen lds
    s_waitcnt vmcnt(18)
    ds_read_b64_tr_b16 v[52:53], v25 offset:12288
    ds_read_b64_tr_b16 v[54:55], v25 offset:13056
    ds_read_b64_tr_b16 a[136:137], v25 offset:12320
    ds_read_b64_tr_b16 a[138:139], v25 offset:13088
    ds_read_b64_tr_b16 a[144:145], v25 offset:12352
    ds_read_b64_tr_b16 a[146:147], v25 offset:13120
    ds_read_b64_tr_b16 a[152:153], v25 offset:12384
    ds_read_b64_tr_b16 a[154:155], v25 offset:13152
    ds_read_b64_tr_b16 a[160:161], v25 offset:12416
    ds_read_b64_tr_b16 a[162:163], v25 offset:13184
    ds_read_b64_tr_b16 a[168:169], v25 offset:12448
    ds_read_b64_tr_b16 a[170:171], v25 offset:13216
    s_waitcnt lgkmcnt(0)
    ds_write_b128 v4, v[52:55] offset:2048
    s_add_u32 s46, s51, 3932160
    s_add_u32 m0, s50, 12288
    s_nop 0
    buffer_load_dwordx4 v16, s[16:19], s46 offen lds
    s_add_u32 m0, s50, 13312
    s_nop 0
    buffer_load_dwordx4 v17, s[16:19], s46 offen lds
    s_add_u32 m0, s50, 14336
    s_nop 0
    buffer_load_dwordx4 v18, s[16:19], s46 offen lds
    s_add_u32 m0, s50, 15360
    s_nop 0
    buffer_load_dwordx4 v19, s[16:19], s46 offen lds
    s_add_u32 m0, s50, 16384
    s_nop 0
    buffer_load_dwordx4 v20, s[16:19], s46 offen lds
    s_add_u32 m0, s50, 17408
    s_nop 0
    buffer_load_dwordx4 v21, s[16:19], s46 offen lds
    s_waitcnt vmcnt(18)
    ds_read_b64_tr_b16 v[52:53], v25 offset:18432
    ds_read_b64_tr_b16 v[54:55], v25 offset:19200
    ds_read_b64_tr_b16 a[140:141], v25 offset:18464
    ds_read_b64_tr_b16 a[142:143], v25 offset:19232
    ds_read_b64_tr_b16 a[148:149], v25 offset:18496
    ds_read_b64_tr_b16 a[150:151], v25 offset:19264
    ds_read_b64_tr_b16 a[156:157], v25 offset:18528
    ds_read_b64_tr_b16 a[158:159], v25 offset:19296
    ds_read_b64_tr_b16 a[164:165], v25 offset:18560
    ds_read_b64_tr_b16 a[166:167], v25 offset:19328
    ds_read_b64_tr_b16 a[172:173], v25 offset:18592
    ds_read_b64_tr_b16 a[174:175], v25 offset:19360
    s_waitcnt lgkmcnt(0)
    ds_write_b128 v4, v[52:55] offset:3072
    s_add_u32 s46, s51, 4325376
    s_add_u32 m0, s50, 18432
    s_nop 0
    buffer_load_dwordx4 v16, s[16:19], s46 offen lds
    s_add_u32 m0, s50, 19456
    s_nop 0
    buffer_load_dwordx4 v17, s[16:19], s46 offen lds
    s_add_u32 m0, s50, 20480
    s_nop 0
    buffer_load_dwordx4 v18, s[16:19], s46 offen lds
    s_add_u32 m0, s50, 21504
    s_nop 0
    buffer_load_dwordx4 v19, s[16:19], s46 offen lds
    s_add_u32 m0, s50, 22528
    s_nop 0
    buffer_load_dwordx4 v20, s[16:19], s46 offen lds
    s_add_u32 m0, s50, 23552
    s_nop 0
    buffer_load_dwordx4 v21, s[16:19], s46 offen lds
    s_waitcnt vmcnt(18)
    ds_read_b64_tr_b16 a[176:177], v25 offset:0
    ds_read_b64_tr_b16 a[178:179], v25 offset:768
    ds_read_b64_tr_b16 a[184:185], v25 offset:32
    ds_read_b64_tr_b16 a[186:187], v25 offset:800
    ds_read_b64_tr_b16 a[192:193], v25 offset:64
    ds_read_b64_tr_b16 a[194:195], v25 offset:832
    ds_read_b64_tr_b16 a[200:201], v25 offset:96
    ds_read_b64_tr_b16 a[202:203], v25 offset:864
    ds_read_b64_tr_b16 a[208:209], v25 offset:128
    ds_read_b64_tr_b16 a[210:211], v25 offset:896
    ds_read_b64_tr_b16 a[216:217], v25 offset:160
    ds_read_b64_tr_b16 a[218:219], v25 offset:928
    s_waitcnt lgkmcnt(0)
    s_add_u32 s46, s51, 4718592
    s_add_u32 m0, s50, 0
    s_nop 0
    buffer_load_dwordx4 v16, s[16:19], s46 offen lds
    s_add_u32 m0, s50, 1024
    s_nop 0
    buffer_load_dwordx4 v17, s[16:19], s46 offen lds
    s_add_u32 m0, s50, 2048
    s_nop 0
    buffer_load_dwordx4 v18, s[16:19], s46 offen lds
    s_add_u32 m0, s50, 3072
    s_nop 0
    buffer_load_dwordx4 v19, s[16:19], s46 offen lds
    s_add_u32 m0, s50, 4096
    s_nop 0
    buffer_load_dwordx4 v20, s[16:19], s46 offen lds
    s_add_u32 m0, s50, 5120
    s_nop 0
    buffer_load_dwordx4 v21, s[16:19], s46 offen lds
    s_waitcnt vmcnt(18)
    ds_read_b64_tr_b16 a[180:181], v25 offset:6144
    ds_read_b64_tr_b16 a[182:183], v25 offset:6912
    ds_read_b64_tr_b16 a[188:189], v25 offset:6176
    ds_read_b64_tr_b16 a[190:191], v25 offset:6944
    ds_read_b64_tr_b16 a[196:197], v25 offset:6208
    ds_read_b64_tr_b16 a[198:199], v25 offset:6976
    ds_read_b64_tr_b16 a[204:205], v25 offset:6240
    ds_read_b64_tr_b16 a[206:207], v25 offset:7008
    ds_read_b64_tr_b16 a[212:213], v25 offset:6272
    ds_read_b64_tr_b16 a[214:215], v25 offset:7040
    ds_read_b64_tr_b16 a[220:221], v25 offset:6304
    ds_read_b64_tr_b16 a[222:223], v25 offset:7072
    s_waitcnt lgkmcnt(0)
    s_add_u32 s46, s51, 5111808
    s_add_u32 m0, s50, 6144
    s_nop 0
    buffer_load_dwordx4 v16, s[16:19], s46 offen lds
    s_add_u32 m0, s50, 7168
    s_nop 0
    buffer_load_dwordx4 v17, s[16:19], s46 offen lds
    s_add_u32 m0, s50, 8192
    s_nop 0
    buffer_load_dwordx4 v18, s[16:19], s46 offen lds
    s_add_u32 m0, s50, 9216
    s_nop 0
    buffer_load_dwordx4 v19, s[16:19], s46 offen lds
    s_add_u32 m0, s50, 10240
    s_nop 0
    buffer_load_dwordx4 v20, s[16:19], s46 offen lds
    s_add_u32 m0, s50, 11264
    s_nop 0
    buffer_load_dwordx4 v21, s[16:19], s46 offen lds
    s_waitcnt vmcnt(18)
    ds_read_b64_tr_b16 a[224:225], v25 offset:12288
    ds_read_b64_tr_b16 a[226:227], v25 offset:13056
    ds_read_b64_tr_b16 a[232:233], v25 offset:12320
    ds_read_b64_tr_b16 a[234:235], v25 offset:13088
    ds_read_b64_tr_b16 a[240:241], v25 offset:12352
    ds_read_b64_tr_b16 a[242:243], v25 offset:13120
    ds_read_b64_tr_b16 a[248:249], v25 offset:12384
    ds_read_b64_tr_b16 a[250:251], v25 offset:13152
    ds_read_b64_tr_b16 v[60:61], v25 offset:12416
    ds_read_b64_tr_b16 v[62:63], v25 offset:13184
    ds_read_b64_tr_b16 v[68:69], v25 offset:12448
    ds_read_b64_tr_b16 v[70:71], v25 offset:13216
    s_waitcnt lgkmcnt(0)
    s_add_u32 s46, s51, 5505024
    s_add_u32 m0, s50, 12288
    s_nop 0
    buffer_load_dwordx4 v16, s[16:19], s46 offen lds
    s_add_u32 m0, s50, 13312
    s_nop 0
    buffer_load_dwordx4 v17, s[16:19], s46 offen lds
    s_add_u32 m0, s50, 14336
    s_nop 0
    buffer_load_dwordx4 v18, s[16:19], s46 offen lds
    s_add_u32 m0, s50, 15360
    s_nop 0
    buffer_load_dwordx4 v19, s[16:19], s46 offen lds
    s_add_u32 m0, s50, 16384
    s_nop 0
    buffer_load_dwordx4 v20, s[16:19], s46 offen lds
    s_add_u32 m0, s50, 17408
    s_nop 0
    buffer_load_dwordx4 v21, s[16:19], s46 offen lds
    s_waitcnt vmcnt(18)
    ds_read_b64_tr_b16 a[228:229], v25 offset:18432
    ds_read_b64_tr_b16 a[230:231], v25 offset:19200
    ds_read_b64_tr_b16 a[236:237], v25 offset:18464
    ds_read_b64_tr_b16 a[238:239], v25 offset:19232
    ds_read_b64_tr_b16 a[244:245], v25 offset:18496
    ds_read_b64_tr_b16 a[246:247], v25 offset:19264
    ds_read_b64_tr_b16 a[252:253], v25 offset:18528
    ds_read_b64_tr_b16 a[254:255], v25 offset:19296
    ds_read_b64_tr_b16 v[64:65], v25 offset:18560
    ds_read_b64_tr_b16 v[66:67], v25 offset:19328
    ds_read_b64_tr_b16 v[72:73], v25 offset:18592
    ds_read_b64_tr_b16 v[74:75], v25 offset:19360
    s_waitcnt lgkmcnt(0)
    s_add_u32 s46, s51, 5898240
    s_add_u32 m0, s50, 18432
    s_nop 0
    buffer_load_dwordx4 v16, s[16:19], s46 offen lds
    s_add_u32 m0, s50, 19456
    s_nop 0
    buffer_load_dwordx4 v17, s[16:19], s46 offen lds
    s_add_u32 m0, s50, 20480
    s_nop 0
    buffer_load_dwordx4 v18, s[16:19], s46 offen lds
    s_add_u32 m0, s50, 21504
    s_nop 0
    buffer_load_dwordx4 v19, s[16:19], s46 offen lds
    s_add_u32 m0, s50, 22528
    s_nop 0
    buffer_load_dwordx4 v20, s[16:19], s46 offen lds
    s_add_u32 m0, s50, 23552
    s_nop 0
    buffer_load_dwordx4 v21, s[16:19], s46 offen lds
    s_waitcnt vmcnt(18)
    ds_read_b64_tr_b16 v[52:53], v25 offset:0
    ds_read_b64_tr_b16 v[54:55], v25 offset:768
    ds_read_b64_tr_b16 v[76:77], v25 offset:32
    ds_read_b64_tr_b16 v[78:79], v25 offset:800
    ds_read_b64_tr_b16 v[84:85], v25 offset:64
    ds_read_b64_tr_b16 v[86:87], v25 offset:832
    ds_read_b64_tr_b16 v[92:93], v25 offset:96
    ds_read_b64_tr_b16 v[94:95], v25 offset:864
    ds_read_b64_tr_b16 v[100:101], v25 offset:128
    ds_read_b64_tr_b16 v[102:103], v25 offset:896
    ds_read_b64_tr_b16 v[108:109], v25 offset:160
    ds_read_b64_tr_b16 v[110:111], v25 offset:928
    s_waitcnt lgkmcnt(0)
    ds_write_b128 v4, v[52:55] offset:4096
    s_add_u32 s46, s51, 6291456
    s_add_u32 m0, s50, 0
    s_nop 0
    buffer_load_dwordx4 v16, s[16:19], s46 offen lds
    s_add_u32 m0, s50, 1024
    s_nop 0
    buffer_load_dwordx4 v17, s[16:19], s46 offen lds
    s_add_u32 m0, s50, 2048
    s_nop 0
    buffer_load_dwordx4 v18, s[16:19], s46 offen lds
    s_add_u32 m0, s50, 3072
    s_nop 0
    buffer_load_dwordx4 v19, s[16:19], s46 offen lds
    s_add_u32 m0, s50, 4096
    s_nop 0
    buffer_load_dwordx4 v20, s[16:19], s46 offen lds
    s_add_u32 m0, s50, 5120
    s_nop 0
    buffer_load_dwordx4 v21, s[16:19], s46 offen lds
    s_waitcnt vmcnt(18)
    ds_read_b64_tr_b16 v[52:53], v25 offset:6144
    ds_read_b64_tr_b16 v[54:55], v25 offset:6912
    ds_read_b64_tr_b16 v[80:81], v25 offset:6176
    ds_read_b64_tr_b16 v[82:83], v25 offset:6944
    ds_read_b64_tr_b16 v[88:89], v25 offset:6208
    ds_read_b64_tr_b16 v[90:91], v25 offset:6976
    ds_read_b64_tr_b16 v[96:97], v25 offset:6240
    ds_read_b64_tr_b16 v[98:99], v25 offset:7008
    ds_read_b64_tr_b16 v[104:105], v25 offset:6272
    ds_read_b64_tr_b16 v[106:107], v25 offset:7040
    ds_read_b64_tr_b16 v[112:113], v25 offset:6304
    ds_read_b64_tr_b16 v[114:115], v25 offset:7072
    s_waitcnt lgkmcnt(0)
    ds_write_b128 v4, v[52:55] offset:5120
    s_add_u32 s46, s51, 6684672
    s_add_u32 m0, s50, 6144
    s_nop 0
    buffer_load_dwordx4 v16, s[16:19], s46 offen lds
    s_add_u32 m0, s50, 7168
    s_nop 0
    buffer_load_dwordx4 v17, s[16:19], s46 offen lds
    s_add_u32 m0, s50, 8192
    s_nop 0
    buffer_load_dwordx4 v18, s[16:19], s46 offen lds
    s_add_u32 m0, s50, 9216
    s_nop 0
    buffer_load_dwordx4 v19, s[16:19], s46 offen lds
    s_add_u32 m0, s50, 10240
    s_nop 0
    buffer_load_dwordx4 v20, s[16:19], s46 offen lds
    s_add_u32 m0, s50, 11264
    s_nop 0
    buffer_load_dwordx4 v21, s[16:19], s46 offen lds
    s_waitcnt vmcnt(18)
    ds_read_b64_tr_b16 v[116:117], v25 offset:12288
    ds_read_b64_tr_b16 v[118:119], v25 offset:13056
    ds_read_b64_tr_b16 v[124:125], v25 offset:12320
    ds_read_b64_tr_b16 v[126:127], v25 offset:13088
    ds_read_b64_tr_b16 v[132:133], v25 offset:12352
    ds_read_b64_tr_b16 v[134:135], v25 offset:13120
    ds_read_b64_tr_b16 v[140:141], v25 offset:12384
    ds_read_b64_tr_b16 v[142:143], v25 offset:13152
    ds_read_b64_tr_b16 v[148:149], v25 offset:12416
    ds_read_b64_tr_b16 v[150:151], v25 offset:13184
    ds_read_b64_tr_b16 v[156:157], v25 offset:12448
    ds_read_b64_tr_b16 v[158:159], v25 offset:13216
    s_waitcnt lgkmcnt(0)
    s_add_u32 s46, s51, 7077888
    s_add_u32 m0, s50, 12288
    s_nop 0
    buffer_load_dwordx4 v16, s[16:19], s46 offen lds
    s_add_u32 m0, s50, 13312
    s_nop 0
    buffer_load_dwordx4 v17, s[16:19], s46 offen lds
    s_add_u32 m0, s50, 14336
    s_nop 0
    buffer_load_dwordx4 v18, s[16:19], s46 offen lds
    s_add_u32 m0, s50, 15360
    s_nop 0
    buffer_load_dwordx4 v19, s[16:19], s46 offen lds
    s_add_u32 m0, s50, 16384
    s_nop 0
    buffer_load_dwordx4 v20, s[16:19], s46 offen lds
    s_add_u32 m0, s50, 17408
    s_nop 0
    buffer_load_dwordx4 v21, s[16:19], s46 offen lds
    s_waitcnt vmcnt(18)
    ds_read_b64_tr_b16 v[120:121], v25 offset:18432
    ds_read_b64_tr_b16 v[122:123], v25 offset:19200
    ds_read_b64_tr_b16 v[128:129], v25 offset:18464
    ds_read_b64_tr_b16 v[130:131], v25 offset:19232
    ds_read_b64_tr_b16 v[136:137], v25 offset:18496
    ds_read_b64_tr_b16 v[138:139], v25 offset:19264
    ds_read_b64_tr_b16 v[144:145], v25 offset:18528
    ds_read_b64_tr_b16 v[146:147], v25 offset:19296
    ds_read_b64_tr_b16 v[152:153], v25 offset:18560
    ds_read_b64_tr_b16 v[154:155], v25 offset:19328
    ds_read_b64_tr_b16 v[160:161], v25 offset:18592
    ds_read_b64_tr_b16 v[162:163], v25 offset:19360
    s_waitcnt lgkmcnt(0)
    s_add_u32 s46, s51, 7471104
    s_add_u32 m0, s50, 18432
    s_nop 0
    buffer_load_dwordx4 v16, s[16:19], s46 offen lds
    s_add_u32 m0, s50, 19456
    s_nop 0
    buffer_load_dwordx4 v17, s[16:19], s46 offen lds
    s_add_u32 m0, s50, 20480
    s_nop 0
    buffer_load_dwordx4 v18, s[16:19], s46 offen lds
    s_add_u32 m0, s50, 21504
    s_nop 0
    buffer_load_dwordx4 v19, s[16:19], s46 offen lds
    s_add_u32 m0, s50, 22528
    s_nop 0
    buffer_load_dwordx4 v20, s[16:19], s46 offen lds
    s_add_u32 m0, s50, 23552
    s_nop 0
    buffer_load_dwordx4 v21, s[16:19], s46 offen lds
    s_waitcnt vmcnt(18)
    ds_read_b64_tr_b16 v[52:53], v25 offset:0
    ds_read_b64_tr_b16 v[54:55], v25 offset:768
    ds_read_b64_tr_b16 v[164:165], v25 offset:32
    ds_read_b64_tr_b16 v[166:167], v25 offset:800
    ds_read_b64_tr_b16 v[172:173], v25 offset:64
    ds_read_b64_tr_b16 v[174:175], v25 offset:832
    ds_read_b64_tr_b16 v[180:181], v25 offset:96
    ds_read_b64_tr_b16 v[182:183], v25 offset:864
    ds_read_b64_tr_b16 v[188:189], v25 offset:128
    ds_read_b64_tr_b16 v[190:191], v25 offset:896
    ds_read_b64_tr_b16 v[196:197], v25 offset:160
    ds_read_b64_tr_b16 v[198:199], v25 offset:928
    s_waitcnt lgkmcnt(0)
    ds_write_b128 v4, v[52:55] offset:6144
    s_waitcnt vmcnt(12)
    ds_read_b64_tr_b16 v[52:53], v25 offset:6144
    ds_read_b64_tr_b16 v[54:55], v25 offset:6912
    ds_read_b64_tr_b16 v[168:169], v25 offset:6176
    ds_read_b64_tr_b16 v[170:171], v25 offset:6944
    ds_read_b64_tr_b16 v[176:177], v25 offset:6208
    ds_read_b64_tr_b16 v[178:179], v25 offset:6976
    ds_read_b64_tr_b16 v[184:185], v25 offset:6240
    ds_read_b64_tr_b16 v[186:187], v25 offset:7008
    ds_read_b64_tr_b16 v[192:193], v25 offset:6272
    ds_read_b64_tr_b16 v[194:195], v25 offset:7040
    ds_read_b64_tr_b16 v[200:201], v25 offset:6304
    ds_read_b64_tr_b16 v[202:203], v25 offset:7072
    s_waitcnt lgkmcnt(0)
    ds_write_b128 v4, v[52:55] offset:7168
    s_waitcnt vmcnt(6)
    ds_read_b64_tr_b16 v[204:205], v25 offset:12288
    ds_read_b64_tr_b16 v[206:207], v25 offset:13056
    ds_read_b64_tr_b16 v[212:213], v25 offset:12320
    ds_read_b64_tr_b16 v[214:215], v25 offset:13088
    ds_read_b64_tr_b16 v[220:221], v25 offset:12352
    ds_read_b64_tr_b16 v[222:223], v25 offset:13120
    ds_read_b64_tr_b16 v[228:229], v25 offset:12384
    ds_read_b64_tr_b16 v[230:231], v25 offset:13152
    ds_read_b64_tr_b16 v[236:237], v25 offset:12416
    ds_read_b64_tr_b16 v[238:239], v25 offset:13184
    ds_read_b64_tr_b16 v[244:245], v25 offset:12448
    ds_read_b64_tr_b16 v[246:247], v25 offset:13216
    s_waitcnt lgkmcnt(0)
    s_waitcnt vmcnt(0)
    ds_read_b64_tr_b16 v[208:209], v25 offset:18432
    ds_read_b64_tr_b16 v[210:211], v25 offset:19200
    ds_read_b64_tr_b16 v[216:217], v25 offset:18464
    ds_read_b64_tr_b16 v[218:219], v25 offset:19232
    ds_read_b64_tr_b16 v[224:225], v25 offset:18496
    ds_read_b64_tr_b16 v[226:227], v25 offset:19264
    ds_read_b64_tr_b16 v[232:233], v25 offset:18528
    ds_read_b64_tr_b16 v[234:235], v25 offset:19296
    ds_read_b64_tr_b16 v[240:241], v25 offset:18560
    ds_read_b64_tr_b16 v[242:243], v25 offset:19328
    ds_read_b64_tr_b16 v[248:249], v25 offset:18592
    ds_read_b64_tr_b16 v[250:251], v25 offset:19360
    s_waitcnt lgkmcnt(0)
    s_waitcnt lgkmcnt(0)
    s_lshl_b32 s53, s33, 10
    s_cmp_lt_u32 s33, 2
    s_cselect_b32 s54, 2, 1
    s_lshl_b32 s54, s54, 12
    v_lshlrev_b32 v5, 4, v0
    v_add_u32 v8, 32768, v5
    v_add_u32 v6, s53, v8
    v_add_u32 v7, s54, v6
    s_add_u32 s53, s53, 131072
    v_and_b32 v1, 8, v0
    v_cmp_eq_u32 vcc, 0, v1
    v_mov_b32 v9, 0xeeee
    v_mov_b32 v1, 0x4444
    v_cndmask_b32 v9, v9, v1, vcc
    v_lshrrev_b32 v1, 5, v0
    v_lshlrev_b32 v1, 4, v1
    v_and_b32 v2, 15, v0
    v_add_u32 v1, v1, v2
    s_and_b32 s45, s33, 1
    s_mul_i32 s45, s45, 96
    v_add_u32 v1, s45, v1
    v_lshlrev_b32 v1, 4, v1
    v_bfe_u32 v2, v0, 4, 1
    v_lshl_add_u32 v1, v2, 3, v1
    s_cmp_lt_u32 s33, 2
    s_cselect_b32 s45, 0, 3072
    s_add_u32 s45, s45, 43008
    v_add_u32 v10, s45, v1
    v_lshrrev_b32 v1, 4, v0
    v_bfe_u32 v2, v0, 2, 2
    v_lshl_add_u32 v1, v1, 3, v2
    v_lshlrev_b32 v1, 4, v1
    v_and_b32 v2, 1, v0
    v_lshl_add_u32 v1, v2, 3, v1
    v_add_u32 v11, 43008, v1
    v_add_u32 v12, 49152, v5
    v_lshrrev_b32 v1, 4, v0
    v_and_b32 v2, 7, v0
    v_lshlrev_b32 v2, 4, v2
    v_lshl_add_u32 v13, v1, 8, v2
    v_lshl_add_u32 v14, v1, 3, v2
    v_lshl_add_u32 v15, v1, 7, v2
    s_add_u32 s73, s73, 786432
    s_add_u32 s74, s74, 786432
    s_mul_i32 s70, s32, 24576
    s_add_u32 s70, s70, 50331648
    s_mul_i32 s71, s32, 3072
    s_add_u32 s71, s71, 101711872
    s_mov_b32 s72, 0x3dd53b95
    s_cmp_eq_u32 s33, 0
    s_mov_b32 s77, 6144
    s_cmp_eq_u32 s33, 1
    s_cselect_b32 s77, 0, s77
    s_cmp_eq_u32 s33, 2
    s_cselect_b32 s77, 4096, s77
    s_cmp_eq_u32 s33, 3
    s_cselect_b32 s77, 2048, s77
    s_mov_b32 s66, 0xff00ff
    s_mov_b32 s67, 0xff00ff
    s_mov_b32 s68, 0xff
    s_mov_b32 s69, 0x0
    s_cmp_lg_u32 s33, 0
    s_cbranch_scc1 R1I_6
    v_mov_b32 v2, 4
    s_movk_i32 s45, 254
PL_7:
    buffer_load_dword v1, v2, s[28:31], 0 offen sc1
    s_waitcnt vmcnt(0)
    v_cmp_gt_u32 vcc, s45, v1
    s_cbranch_vccz PD_8
    s_sub_u32 s35, s35, 1
    s_cbranch_scc1 TO_9
    s_branch PL_7
PD_8:
R1I_6:
    s_barrier
    s_cmp_lt_u32 s33, 2
    s_cbranch_scc1 R1K_10
    s_mov_b32 s75, 1
    v_mov_b32 v2, s55
PL_11:
    buffer_load_dword v1, v2, s[8:11], 0 offen sc1
    s_waitcnt vmcnt(0)
    v_cmp_gt_u32 vcc, s75, v1
    s_cbranch_vccz PD_12
    s_sub_u32 s35, s35, 1
    s_cbranch_scc1 TO_13
    s_branch PL_11
PD_12:
    s_mul_i32 s45, s34, 786432
    s_add_u32 s45, s45, s70
    s_and_b32 s46, s33, 1
    s_mul_i32 s47, s46, 6144
    s_add_u32 s45, s45, s47
    buffer_load_dwordx4 v[16:19], v5, s[8:11], s45 offen offset:0 sc1
    buffer_load_dwordx4 v[20:23], v5, s[8:11], s45 offen offset:1024 sc1
    buffer_load_dwordx4 v[24:27], v5, s[8:11], s45 offen offset:2048 sc1
    buffer_load_dwordx4 v[28:31], v5, s[8:11], s45 offen offset:3072 sc1
    s_add_u32 s45, s45, 4096
    buffer_load_dwordx4 v[32:35], v5, s[8:11], s45 offen offset:0 sc1
    buffer_load_dwordx4 v[36:39], v5, s[8:11], s45 offen offset:1024 sc1
    s_and_b32 s46, s34, 1
    s_mul_i32 s46, s46, 12288
    s_add_u32 s46, s46, s47
    v_add_u32 v2, s46, v12
    s_waitcnt vmcnt(0)
    ds_write_b128 v2, v[16:19] offset:0
    ds_write_b128 v2, v[20:23] offset:1024
    ds_write_b128 v2, v[24:27] offset:2048
    ds_write_b128 v2, v[28:31] offset:3072
    ds_write_b128 v2, v[32:35] offset:4096
    ds_write_b128 v2, v[36:39] offset:5120
R1K_10:
R1L_14:
    s_mul_i32 s56, s34, 10240
    s_add_u32 s56, s56, s53
    s_add_u32 s57, s56, 4096
    s_add_u32 s58, s56, s54
    s_waitcnt lgkmcnt(0)
    v_add_u32 v3, s77, v4
    ds_read_b128 v[52:55], v3 offset:0
    ds_read_b128 v[56:59], v3 offset:1024
    v_mov_b32 v16, 0
    v_mov_b32 v17, 0
    v_mov_b32 v18, 0
    v_mov_b32 v19, 0
    v_mov_b32 v20, 0
    v_mov_b32 v21, 0
    v_mov_b32 v22, 0
    v_mov_b32 v23, 0
    v_mov_b32 v24, 0
    v_mov_b32 v25, 0
    v_mov_b32 v26, 0
    v_mov_b32 v27, 0
    v_mov_b32 v28, 0
    v_mov_b32 v29, 0
    v_mov_b32 v30, 0
    v_mov_b32 v31, 0
    v_mov_b32 v32, 0
    v_mov_b32 v33, 0
    v_mov_b32 v34, 0
    v_mov_b32 v35, 0
    v_mov_b32 v36, 0
    v_mov_b32 v37, 0
    v_mov_b32 v38, 0
    v_mov_b32 v39, 0
    buffer_load_dwordx4 v[40:43], v5, s[8:11], s56 offen sc0 sc1
    buffer_load_dwordx4 v[44:47], v5, s[8:11], s57 offen sc0 sc1
    buffer_load_dwordx4 v[48:51], v5, s[8:11], s58 offen sc0 sc1
    s_branch DC_16
DP_15:
    buffer_load_dwordx4 v[40:43], v5, s[8:11], s56 offen sc0 sc1
    buffer_load_dwordx4 v[44:47], v5, s[8:11], s57 offen sc0 sc1
    buffer_load_dwordx4 v[48:51], v5, s[8:11], s58 offen sc0 sc1
DC_16:
    s_waitcnt vmcnt(0)
    v_max3_u32 v1, v40, v41, v42
    v_max3_u32 v2, v46, v47, v48
    v_max3_u32 v1, v1, v43, v44
    v_max3_u32 v2, v2, v49, v50
    v_max_u32 v1, v1, v45
    v_max_u32 v2, v2, v51
    v_max_u32 v1, v1, v2
    v_cmp_eq_u32 vcc, -1, v1
    s_cbranch_vccz DD_17
    s_sub_u32 s35, s35, 1
    s_cbranch_scc1 TO_18
    s_branch DP_15
DD_17:
    ds_write_b128 v6, v[40:43]
    ds_write_b128 v6, v[44:47] offset:4096
    ds_write_b128 v7, v[48:51]
    s_cmp_eq_u32 s33, 1
    s_cbranch_scc1 R1V_20
    s_cmp_eq_u32 s33, 2
    s_cbranch_scc1 R1V_21
    s_cmp_eq_u32 s33, 3
    s_cbranch_scc1 R1V_22
R1V_19:
    v_smfmac_f32_16x16x64_bf16 v[36:39], v[48:51], v[196:203], v9
    v_smfmac_f32_16x16x64_bf16 v[32:35], v[48:51], v[188:195], v9
    v_smfmac_f32_16x16x64_bf16 v[28:31], v[48:51], v[180:187], v9
    v_smfmac_f32_16x16x64_bf16 v[24:27], v[48:51], v[172:179], v9
    v_smfmac_f32_16x16x64_bf16 v[20:23], v[48:51], v[164:171], v9
    s_waitcnt lgkmcnt(3)
    v_smfmac_f32_16x16x64_bf16 v[16:19], v[48:51], v[52:59], v9
    ds_read_b128 v[52:55], v4 offset:0
    ds_read_b128 v[56:59], v4 offset:1024
    s_waitcnt lgkmcnt(2)
    s_barrier
    ds_read_b128 v[48:51], v8 offset:1024
    v_smfmac_f32_16x16x64_bf16 v[36:39], v[40:43], a[40:47], v9
    v_smfmac_f32_16x16x64_bf16 v[32:35], v[40:43], a[32:39], v9
    v_smfmac_f32_16x16x64_bf16 v[28:31], v[40:43], a[24:31], v9
    v_smfmac_f32_16x16x64_bf16 v[24:27], v[40:43], a[16:23], v9
    v_smfmac_f32_16x16x64_bf16 v[20:23], v[40:43], a[8:15], v9
    v_smfmac_f32_16x16x64_bf16 v[16:19], v[40:43], a[0:7], v9
    ds_read_b128 v[40:43], v8 offset:3072
    s_waitcnt lgkmcnt(1)
    v_smfmac_f32_16x16x64_bf16 v[36:39], v[48:51], a[80:87], v9
    v_smfmac_f32_16x16x64_bf16 v[32:35], v[48:51], a[72:79], v9
    v_smfmac_f32_16x16x64_bf16 v[28:31], v[48:51], a[64:71], v9
    v_smfmac_f32_16x16x64_bf16 v[24:27], v[48:51], a[56:63], v9
    v_smfmac_f32_16x16x64_bf16 v[20:23], v[48:51], a[48:55], v9
    v_smfmac_f32_16x16x64_bf16 v[16:19], v[48:51], v[52:59], v9
    ds_read_b128 v[52:55], v4 offset:2048
    ds_read_b128 v[56:59], v4 offset:3072
    ds_read_b128 v[48:51], v8 offset:2048
    v_smfmac_f32_16x16x64_bf16 v[36:39], v[44:47], a[216:223], v9
    v_smfmac_f32_16x16x64_bf16 v[32:35], v[44:47], a[208:215], v9
    v_smfmac_f32_16x16x64_bf16 v[28:31], v[44:47], a[200:207], v9
    v_smfmac_f32_16x16x64_bf16 v[24:27], v[44:47], a[192:199], v9
    v_smfmac_f32_16x16x64_bf16 v[20:23], v[44:47], a[184:191], v9
    v_smfmac_f32_16x16x64_bf16 v[16:19], v[44:47], a[176:183], v9
    ds_read_b128 v[44:47], v8 offset:6144
    s_waitcnt lgkmcnt(4)
    v_smfmac_f32_16x16x64_bf16 v[36:39], v[40:43], a[168:175], v9
    v_smfmac_f32_16x16x64_bf16 v[32:35], v[40:43], a[160:167], v9
    v_smfmac_f32_16x16x64_bf16 v[28:31], v[40:43], a[152:159], v9
    v_smfmac_f32_16x16x64_bf16 v[24:27], v[40:43], a[144:151], v9
    v_smfmac_f32_16x16x64_bf16 v[20:23], v[40:43], a[136:143], v9
    s_waitcnt lgkmcnt(2)
    v_smfmac_f32_16x16x64_bf16 v[16:19], v[40:43], v[52:59], v9
    ds_read_b128 v[52:55], v4 offset:4096
    ds_read_b128 v[56:59], v4 offset:5120
    ds_read_b128 v[40:43], v8 offset:5120
    s_waitcnt lgkmcnt(4)
    v_smfmac_f32_16x16x64_bf16 v[36:39], v[48:51], a[128:135], v9
    v_smfmac_f32_16x16x64_bf16 v[32:35], v[48:51], a[120:127], v9
    v_smfmac_f32_16x16x64_bf16 v[28:31], v[48:51], a[112:119], v9
    v_smfmac_f32_16x16x64_bf16 v[24:27], v[48:51], a[104:111], v9
    v_smfmac_f32_16x16x64_bf16 v[20:23], v[48:51], a[96:103], v9
    v_smfmac_f32_16x16x64_bf16 v[16:19], v[48:51], a[88:95], v9
    ds_read_b128 v[48:51], v8 offset:7168
    s_waitcnt lgkmcnt(4)
    v_smfmac_f32_16x16x64_bf16 v[36:39], v[44:47], v[108:115], v9
    v_smfmac_f32_16x16x64_bf16 v[32:35], v[44:47], v[100:107], v9
    v_smfmac_f32_16x16x64_bf16 v[28:31], v[44:47], v[92:99], v9
    v_smfmac_f32_16x16x64_bf16 v[24:27], v[44:47], v[84:91], v9
    v_smfmac_f32_16x16x64_bf16 v[20:23], v[44:47], v[76:83], v9
    s_waitcnt lgkmcnt(2)
    v_smfmac_f32_16x16x64_bf16 v[16:19], v[44:47], v[52:59], v9
    ds_read_b128 v[44:47], v8 offset:9216
    s_waitcnt lgkmcnt(2)
    v_smfmac_f32_16x16x64_bf16 v[36:39], v[40:43], v[68:75], v9
    v_smfmac_f32_16x16x64_bf16 v[32:35], v[40:43], v[60:67], v9
    s_waitcnt lgkmcnt(1)
    v_smfmac_f32_16x16x64_bf16 v[36:39], v[48:51], v[156:163], v9
    v_smfmac_f32_16x16x64_bf16 v[32:35], v[48:51], v[148:155], v9
    s_waitcnt lgkmcnt(0)
    v_smfmac_f32_16x16x64_bf16 v[36:39], v[44:47], v[244:251], v9
    v_smfmac_f32_16x16x64_bf16 v[32:35], v[44:47], v[236:243], v9
    v_smfmac_f32_16x16x64_bf16 v[28:31], v[40:43], a[248:255], v9
    v_smfmac_f32_16x16x64_bf16 v[24:27], v[40:43], a[240:247], v9
    v_smfmac_f32_16x16x64_bf16 v[28:31], v[48:51], v[140:147], v9
    v_smfmac_f32_16x16x64_bf16 v[24:27], v[48:51], v[132:139], v9
    v_smfmac_f32_16x16x64_bf16 v[28:31], v[44:47], v[228:235], v9
    v_smfmac_f32_16x16x64_bf16 v[24:27], v[44:47], v[220:227], v9
    v_smfmac_f32_16x16x64_bf16 v[20:23], v[40:43], a[232:239], v9
    v_smfmac_f32_16x16x64_bf16 v[16:19], v[40:43], a[224:231], v9
    v_permlane32_swap_b32 v32, v36
    v_permlane32_swap_b32 v33, v37
    v_permlane32_swap_b32 v34, v38
    v_smfmac_f32_16x16x64_bf16 v[20:23], v[48:51], v[124:131], v9
    v_permlane32_swap_b32 v35, v39
    v_add_f32 v32, v32, v36
    v_add_f32 v33, v33, v37
    v_smfmac_f32_16x16x64_bf16 v[16:19], v[48:51], v[116:123], v9
    v_add_f32 v34, v34, v38
    v_add_f32 v35, v35, v39
    v_cvt_pk_bf16_f32 v32, v32, v33
    v_smfmac_f32_16x16x64_bf16 v[20:23], v[44:47], v[212:219], v9
    v_cvt_pk_bf16_f32 v33, v34, v35
    ds_write_b64 v10, v[32:33] offset:1024
    v_smfmac_f32_16x16x64_bf16 v[16:19], v[44:47], v[204:211], v9
    v_permlane32_swap_b32 v24, v28
    v_permlane32_swap_b32 v25, v29
    v_permlane32_swap_b32 v26, v30
    v_permlane32_swap_b32 v27, v31
    v_add_f32 v24, v24, v28
    v_add_f32 v25, v25, v29
    v_add_f32 v26, v26, v30
    v_add_f32 v27, v27, v31
    v_cvt_pk_bf16_f32 v24, v24, v25
    v_cvt_pk_bf16_f32 v25, v26, v27
    ds_write_b64 v10, v[24:25] offset:512
    v_permlane32_swap_b32 v16, v20
    v_permlane32_swap_b32 v17, v21
    v_permlane32_swap_b32 v18, v22
    v_permlane32_swap_b32 v19, v23
    v_add_f32 v16, v16, v20
    v_add_f32 v17, v17, v21
    v_add_f32 v18, v18, v22
    v_add_f32 v19, v19, v23
    v_cvt_pk_bf16_f32 v16, v16, v17
    v_cvt_pk_bf16_f32 v17, v18, v19
    ds_write_b64 v10, v[16:17] offset:0
    s_branch R1C_23
R1V_20:
    v_smfmac_f32_16x16x64_bf16 v[36:39], v[40:43], a[80:87], v9
    v_smfmac_f32_16x16x64_bf16 v[32:35], v[40:43], a[72:79], v9
    v_smfmac_f32_16x16x64_bf16 v[28:31], v[40:43], a[64:71], v9
    v_smfmac_f32_16x16x64_bf16 v[24:27], v[40:43], a[56:63], v9
    v_smfmac_f32_16x16x64_bf16 v[20:23], v[40:43], a[48:55], v9
    s_waitcnt lgkmcnt(3)
    v_smfmac_f32_16x16x64_bf16 v[16:19], v[40:43], v[52:59], v9
    ds_read_b128 v[52:55], v4 offset:2048
    ds_read_b128 v[56:59], v4 offset:3072
    s_waitcnt lgkmcnt(2)
    s_barrier
    ds_read_b128 v[40:43], v8 offset:3072
    v_smfmac_f32_16x16x64_bf16 v[36:39], v[44:47], v[68:75], v9
    v_smfmac_f32_16x16x64_bf16 v[32:35], v[44:47], v[60:67], v9
    v_smfmac_f32_16x16x64_bf16 v[28:31], v[44:47], a[248:255], v9
    v_smfmac_f32_16x16x64_bf16 v[24:27], v[44:47], a[240:247], v9
    v_smfmac_f32_16x16x64_bf16 v[20:23], v[44:47], a[232:239], v9
    v_smfmac_f32_16x16x64_bf16 v[16:19], v[44:47], a[224:231], v9
    ds_read_b128 v[44:47], v8 offset:6144
    s_waitcnt lgkmcnt(1)
    v_smfmac_f32_16x16x64_bf16 v[36:39], v[40:43], a[168:175], v9
    v_smfmac_f32_16x16x64_bf16 v[32:35], v[40:43], a[160:167], v9
    v_smfmac_f32_16x16x64_bf16 v[28:31], v[40:43], a[152:159], v9
    v_smfmac_f32_16x16x64_bf16 v[24:27], v[40:43], a[144:151], v9
    v_smfmac_f32_16x16x64_bf16 v[20:23], v[40:43], a[136:143], v9
    v_smfmac_f32_16x16x64_bf16 v[16:19], v[40:43], v[52:59], v9
    ds_read_b128 v[52:55], v4 offset:4096
    ds_read_b128 v[56:59], v4 offset:5120
    ds_read_b128 v[40:43], v8 offset:0
    v_smfmac_f32_16x16x64_bf16 v[36:39], v[48:51], v[244:251], v9
    v_smfmac_f32_16x16x64_bf16 v[32:35], v[48:51], v[236:243], v9
    v_smfmac_f32_16x16x64_bf16 v[28:31], v[48:51], v[228:235], v9
    v_smfmac_f32_16x16x64_bf16 v[24:27], v[48:51], v[220:227], v9
    v_smfmac_f32_16x16x64_bf16 v[20:23], v[48:51], v[212:219], v9
    v_smfmac_f32_16x16x64_bf16 v[16:19], v[48:51], v[204:211], v9
    ds_read_b128 v[48:51], v8 offset:8192
    s_waitcnt lgkmcnt(4)
    v_smfmac_f32_16x16x64_bf16 v[36:39], v[44:47], v[108:115], v9
    v_smfmac_f32_16x16x64_bf16 v[32:35], v[44:47], v[100:107], v9
    v_smfmac_f32_16x16x64_bf16 v[28:31], v[44:47], v[92:99], v9
    v_smfmac_f32_16x16x64_bf16 v[24:27], v[44:47], v[84:91], v9
    v_smfmac_f32_16x16x64_bf16 v[20:23], v[44:47], v[76:83], v9
    s_waitcnt lgkmcnt(2)
    v_smfmac_f32_16x16x64_bf16 v[16:19], v[44:47], v[52:59], v9
    ds_read_b128 v[52:55], v4 offset:6144
    ds_read_b128 v[56:59], v4 offset:7168
    ds_read_b128 v[44:47], v8 offset:2048
    s_waitcnt lgkmcnt(4)
    v_smfmac_f32_16x16x64_bf16 v[36:39], v[40:43], a[40:47], v9
    v_smfmac_f32_16x16x64_bf16 v[32:35], v[40:43], a[32:39], v9
    v_smfmac_f32_16x16x64_bf16 v[28:31], v[40:43], a[24:31], v9
    v_smfmac_f32_16x16x64_bf16 v[24:27], v[40:43], a[16:23], v9
    v_smfmac_f32_16x16x64_bf16 v[20:23], v[40:43], a[8:15], v9
    v_smfmac_f32_16x16x64_bf16 v[16:19], v[40:43], a[0:7], v9
    ds_read_b128 v[40:43], v8 offset:4096
    s_waitcnt lgkmcnt(4)
    v_smfmac_f32_16x16x64_bf16 v[36:39], v[48:51], v[196:203], v9
    v_smfmac_f32_16x16x64_bf16 v[32:35], v[48:51], v[188:195], v9
    v_smfmac_f32_16x16x64_bf16 v[28:31], v[48:51], v[180:187], v9
    v_smfmac_f32_16x16x64_bf16 v[24:27], v[48:51], v[172:179], v9
    v_smfmac_f32_16x16x64_bf16 v[20:23], v[48:51], v[164:171], v9
    s_waitcnt lgkmcnt(2)
    v_smfmac_f32_16x16x64_bf16 v[16:19], v[48:51], v[52:59], v9
    ds_read_b128 v[48:51], v8 offset:7168
    s_waitcnt lgkmcnt(2)
    v_smfmac_f32_16x16x64_bf16 v[36:39], v[44:47], a[128:135], v9
    v_smfmac_f32_16x16x64_bf16 v[32:35], v[44:47], a[120:127], v9
    s_waitcnt lgkmcnt(1)
    v_smfmac_f32_16x16x64_bf16 v[36:39], v[40:43], a[216:223], v9
    v_smfmac_f32_16x16x64_bf16 v[32:35], v[40:43], a[208:215], v9
    s_waitcnt lgkmcnt(0)
    v_smfmac_f32_16x16x64_bf16 v[36:39], v[48:51], v[156:163], v9
    v_smfmac_f32_16x16x64_bf16 v[32:35], v[48:51], v[148:155], v9
    v_smfmac_f32_16x16x64_bf16 v[28:31], v[44:47], a[112:119], v9
    v_smfmac_f32_16x16x64_bf16 v[24:27], v[44:47], a[104:111], v9
    v_smfmac_f32_16x16x64_bf16 v[28:31], v[40:43], a[200:207], v9
    v_smfmac_f32_16x16x64_bf16 v[24:27], v[40:43], a[192:199], v9
    v_smfmac_f32_16x16x64_bf16 v[28:31], v[48:51], v[140:147], v9
    v_smfmac_f32_16x16x64_bf16 v[24:27], v[48:51], v[132:139], v9
    v_smfmac_f32_16x16x64_bf16 v[20:23], v[44:47], a[96:103], v9
    v_smfmac_f32_16x16x64_bf16 v[16:19], v[44:47], a[88:95], v9
    v_permlane32_swap_b32 v32, v36
    v_permlane32_swap_b32 v33, v37
    v_permlane32_swap_b32 v34, v38
    v_smfmac_f32_16x16x64_bf16 v[20:23], v[40:43], a[184:191], v9
    v_permlane32_swap_b32 v35, v39
    v_add_f32 v32, v32, v36
    v_add_f32 v33, v33, v37
    v_smfmac_f32_16x16x64_bf16 v[16:19], v[40:43], a[176:183], v9
    v_add_f32 v34, v34, v38
    v_add_f32 v35, v35, v39
    v_cvt_pk_bf16_f32 v32, v32, v33
    v_smfmac_f32_16x16x64_bf16 v[20:23], v[48:51], v[124:131], v9
    v_cvt_pk_bf16_f32 v33, v34, v35
    ds_write_b64 v10, v[32:33] offset:1024
    v_smfmac_f32_16x16x64_bf16 v[16:19], v[48:51], v[116:123], v9
    v_permlane32_swap_b32 v24, v28
    v_permlane32_swap_b32 v25, v29
    v_permlane32_swap_b32 v26, v30
    v_permlane32_swap_b32 v27, v31
    v_add_f32 v24, v24, v28
    v_add_f32 v25, v25, v29
    v_add_f32 v26, v26, v30
    v_add_f32 v27, v27, v31
    v_cvt_pk_bf16_f32 v24, v24, v25
    v_cvt_pk_bf16_f32 v25, v26, v27
    ds_write_b64 v10, v[24:25] offset:512
    v_permlane32_swap_b32 v16, v20
    v_permlane32_swap_b32 v17, v21
    v_permlane32_swap_b32 v18, v22
    v_permlane32_swap_b32 v19, v23
    v_add_f32 v16, v16, v20
    v_add_f32 v17, v17, v21
    v_add_f32 v18, v18, v22
    v_add_f32 v19, v19, v23
    v_cvt_pk_bf16_f32 v16, v16, v17
    v_cvt_pk_bf16_f32 v17, v18, v19
    ds_write_b64 v10, v[16:17] offset:0
    s_branch R1C_23
R1V_21:
    v_smfmac_f32_16x16x64_bf16 v[36:39], v[44:47], v[108:115], v9
    v_smfmac_f32_16x16x64_bf16 v[32:35], v[44:47], v[100:107], v9
    v_smfmac_f32_16x16x64_bf16 v[28:31], v[44:47], v[92:99], v9
    v_smfmac_f32_16x16x64_bf16 v[24:27], v[44:47], v[84:91], v9
    v_smfmac_f32_16x16x64_bf16 v[20:23], v[44:47], v[76:83], v9
    s_waitcnt lgkmcnt(3)
    v_smfmac_f32_16x16x64_bf16 v[16:19], v[44:47], v[52:59], v9
    ds_read_b128 v[52:55], v4 offset:0
    ds_read_b128 v[56:59], v4 offset:1024
    s_waitcnt lgkmcnt(2)
    s_barrier
    ds_read_b128 v[48:51], v8 offset:1024
    ds_read_b128 v[44:47], v8 offset:0
    v_smfmac_f32_16x16x64_bf16 v[36:39], v[40:43], a[128:135], v9
    v_smfmac_f32_16x16x64_bf16 v[32:35], v[40:43], a[120:127], v9
    v_smfmac_f32_16x16x64_bf16 v[28:31], v[40:43], a[112:119], v9
    v_smfmac_f32_16x16x64_bf16 v[24:27], v[40:43], a[104:111], v9
    v_smfmac_f32_16x16x64_bf16 v[20:23], v[40:43], a[96:103], v9
    v_smfmac_f32_16x16x64_bf16 v[16:19], v[40:43], a[88:95], v9
    ds_read_b128 v[40:43], v8 offset:3072
    s_waitcnt lgkmcnt(2)
    v_smfmac_f32_16x16x64_bf16 v[36:39], v[48:51], a[80:87], v9
    v_smfmac_f32_16x16x64_bf16 v[32:35], v[48:51], a[72:79], v9
    v_smfmac_f32_16x16x64_bf16 v[28:31], v[48:51], a[64:71], v9
    v_smfmac_f32_16x16x64_bf16 v[24:27], v[48:51], a[56:63], v9
    v_smfmac_f32_16x16x64_bf16 v[20:23], v[48:51], a[48:55], v9
    v_smfmac_f32_16x16x64_bf16 v[16:19], v[48:51], v[52:59], v9
    ds_read_b128 v[52:55], v4 offset:2048
    ds_read_b128 v[56:59], v4 offset:3072
    ds_read_b128 v[48:51], v8 offset:4096
    s_waitcnt lgkmcnt(4)
    v_smfmac_f32_16x16x64_bf16 v[36:39], v[44:47], a[40:47], v9
    v_smfmac_f32_16x16x64_bf16 v[32:35], v[44:47], a[32:39], v9
    v_smfmac_f32_16x16x64_bf16 v[28:31], v[44:47], a[24:31], v9
    v_smfmac_f32_16x16x64_bf16 v[24:27], v[44:47], a[16:23], v9
    v_smfmac_f32_16x16x64_bf16 v[20:23], v[44:47], a[8:15], v9
    v_smfmac_f32_16x16x64_bf16 v[16:19], v[44:47], a[0:7], v9
    ds_read_b128 v[44:47], v8 offset:8192
    s_waitcnt lgkmcnt(4)
    v_smfmac_f32_16x16x64_bf16 v[36:39], v[40:43], a[168:175], v9
    v_smfmac_f32_16x16x64_bf16 v[32:35], v[40:43], a[160:167], v9
    v_smfmac_f32_16x16x64_bf16 v[28:31], v[40:43], a[152:159], v9
    v_smfmac_f32_16x16x64_bf16 v[24:27], v[40:43], a[144:151], v9
    v_smfmac_f32_16x16x64_bf16 v[20:23], v[40:43], a[136:143], v9
    s_waitcnt lgkmcnt(2)
    v_smfmac_f32_16x16x64_bf16 v[16:19], v[40:43], v[52:59], v9
    ds_read_b128 v[52:55], v4 offset:6144
    ds_read_b128 v[56:59], v4 offset:7168
    ds_read_b128 v[40:43], v8 offset:5120
    s_waitcnt lgkmcnt(4)
    v_smfmac_f32_16x16x64_bf16 v[36:39], v[48:51], a[216:223], v9
    v_smfmac_f32_16x16x64_bf16 v[32:35], v[48:51], a[208:215], v9
    v_smfmac_f32_16x16x64_bf16 v[28:31], v[48:51], a[200:207], v9
    v_smfmac_f32_16x16x64_bf16 v[24:27], v[48:51], a[192:199], v9
    v_smfmac_f32_16x16x64_bf16 v[20:23], v[48:51], a[184:191], v9
    v_smfmac_f32_16x16x64_bf16 v[16:19], v[48:51], a[176:183], v9
    ds_read_b128 v[48:51], v8 offset:7168
    s_waitcnt lgkmcnt(4)
    v_smfmac_f32_16x16x64_bf16 v[36:39], v[44:47], v[196:203], v9
    v_smfmac_f32_16x16x64_bf16 v[32:35], v[44:47], v[188:195], v9
    v_smfmac_f32_16x16x64_bf16 v[28:31], v[44:47], v[180:187], v9
    v_smfmac_f32_16x16x64_bf16 v[24:27], v[44:47], v[172:179], v9
    v_smfmac_f32_16x16x64_bf16 v[20:23], v[44:47], v[164:171], v9
    s_waitcnt lgkmcnt(2)
    v_smfmac_f32_16x16x64_bf16 v[16:19], v[44:47], v[52:59], v9
    ds_read_b128 v[44:47], v8 offset:9216
    s_waitcnt lgkmcnt(2)
    v_smfmac_f32_16x16x64_bf16 v[36:39], v[40:43], v[68:75], v9
    v_smfmac_f32_16x16x64_bf16 v[32:35], v[40:43], v[60:67], v9
    s_waitcnt lgkmcnt(1)
    v_smfmac_f32_16x16x64_bf16 v[36:39], v[48:51], v[156:163], v9
    v_smfmac_f32_16x16x64_bf16 v[32:35], v[48:51], v[148:155], v9
    s_waitcnt lgkmcnt(0)
    v_smfmac_f32_16x16x64_bf16 v[36:39], v[44:47], v[244:251], v9
    v_smfmac_f32_16x16x64_bf16 v[32:35], v[44:47], v[236:243], v9
    v_smfmac_f32_16x16x64_bf16 v[28:31], v[40:43], a[248:255], v9
    v_smfmac_f32_16x16x64_bf16 v[24:27], v[40:43], a[240:247], v9
    v_smfmac_f32_16x16x64_bf16 v[28:31], v[48:51], v[140:147], v9
    v_smfmac_f32_16x16x64_bf16 v[24:27], v[48:51], v[132:139], v9
    v_smfmac_f32_16x16x64_bf16 v[28:31], v[44:47], v[228:235], v9
    v_smfmac_f32_16x16x64_bf16 v[24:27], v[44:47], v[220:227], v9
    v_smfmac_f32_16x16x64_bf16 v[20:23], v[40:43], a[232:239], v9
    v_smfmac_f32_16x16x64_bf16 v[16:19], v[40:43], a[224:231], v9
    v_permlane32_swap_b32 v32, v36
    v_permlane32_swap_b32 v33, v37
    v_permlane32_swap_b32 v34, v38
    v_smfmac_f32_16x16x64_bf16 v[20:23], v[48:51], v[124:131], v9
    v_permlane32_swap_b32 v35, v39
    v_add_f32 v32, v32, v36
    v_add_f32 v33, v33, v37
    v_smfmac_f32_16x16x64_bf16 v[16:19], v[48:51], v[116:123], v9
    v_add_f32 v34, v34, v38
    v_add_f32 v35, v35, v39
    v_cvt_pk_bf16_f32 v32, v32, v33
    v_smfmac_f32_16x16x64_bf16 v[20:23], v[44:47], v[212:219], v9
    v_cvt_pk_bf16_f32 v33, v34, v35
    ds_write_b64 v10, v[32:33] offset:1024
    v_smfmac_f32_16x16x64_bf16 v[16:19], v[44:47], v[204:211], v9
    v_permlane32_swap_b32 v24, v28
    v_permlane32_swap_b32 v25, v29
    v_permlane32_swap_b32 v26, v30
    v_permlane32_swap_b32 v27, v31
    v_add_f32 v24, v24, v28
    v_add_f32 v25, v25, v29
    v_add_f32 v26, v26, v30
    v_add_f32 v27, v27, v31
    v_cvt_pk_bf16_f32 v24, v24, v25
    v_cvt_pk_bf16_f32 v25, v26, v27
    ds_write_b64 v10, v[24:25] offset:512
    v_permlane32_swap_b32 v16, v20
    v_permlane32_swap_b32 v17, v21
    v_permlane32_swap_b32 v18, v22
    v_permlane32_swap_b32 v19, v23
    v_add_f32 v16, v16, v20
    v_add_f32 v17, v17, v21
    v_add_f32 v18, v18, v22
    v_add_f32 v19, v19, v23
    v_cvt_pk_bf16_f32 v16, v16, v17
    v_cvt_pk_bf16_f32 v17, v18, v19
    ds_write_b64 v10, v[16:17] offset:0
    s_branch R1C_23
R1V_22:
    v_smfmac_f32_16x16x64_bf16 v[36:39], v[40:43], a[168:175], v9
    v_smfmac_f32_16x16x64_bf16 v[32:35], v[40:43], a[160:167], v9
    v_smfmac_f32_16x16x64_bf16 v[28:31], v[40:43], a[152:159], v9
    v_smfmac_f32_16x16x64_bf16 v[24:27], v[40:43], a[144:151], v9
    v_smfmac_f32_16x16x64_bf16 v[20:23], v[40:43], a[136:143], v9
    s_waitcnt lgkmcnt(3)
    v_smfmac_f32_16x16x64_bf16 v[16:19], v[40:43], v[52:59], v9
    ds_read_b128 v[52:55], v4 offset:0
    ds_read_b128 v[56:59], v4 offset:1024
    s_waitcnt lgkmcnt(2)
    s_barrier
    ds_read_b128 v[48:51], v8 offset:1024
    ds_read_b128 v[40:43], v8 offset:0
    v_smfmac_f32_16x16x64_bf16 v[36:39], v[44:47], v[156:163], v9
    v_smfmac_f32_16x16x64_bf16 v[32:35], v[44:47], v[148:155], v9
    v_smfmac_f32_16x16x64_bf16 v[28:31], v[44:47], v[140:147], v9
    v_smfmac_f32_16x16x64_bf16 v[24:27], v[44:47], v[132:139], v9
    v_smfmac_f32_16x16x64_bf16 v[20:23], v[44:47], v[124:131], v9
    v_smfmac_f32_16x16x64_bf16 v[16:19], v[44:47], v[116:123], v9
    ds_read_b128 v[44:47], v8 offset:6144
    s_waitcnt lgkmcnt(2)
    v_smfmac_f32_16x16x64_bf16 v[36:39], v[48:51], a[80:87], v9
    v_smfmac_f32_16x16x64_bf16 v[32:35], v[48:51], a[72:79], v9
    v_smfmac_f32_16x16x64_bf16 v[28:31], v[48:51], a[64:71], v9
    v_smfmac_f32_16x16x64_bf16 v[24:27], v[48:51], a[56:63], v9
    v_smfmac_f32_16x16x64_bf16 v[20:23], v[48:51], a[48:55], v9
    v_smfmac_f32_16x16x64_bf16 v[16:19], v[48:51], v[52:59], v9
    ds_read_b128 v[52:55], v4 offset:4096
    ds_read_b128 v[56:59], v4 offset:5120
    ds_read_b128 v[48:51], v8 offset:2048
    s_waitcnt lgkmcnt(4)
    v_smfmac_f32_16x16x64_bf16 v[36:39], v[40:43], a[40:47], v9
    v_smfmac_f32_16x16x64_bf16 v[32:35], v[40:43], a[32:39], v9
    v_smfmac_f32_16x16x64_bf16 v[28:31], v[40:43], a[24:31], v9
    v_smfmac_f32_16x16x64_bf16 v[24:27], v[40:43], a[16:23], v9
    v_smfmac_f32_16x16x64_bf16 v[20:23], v[40:43], a[8:15], v9
    v_smfmac_f32_16x16x64_bf16 v[16:19], v[40:43], a[0:7], v9
    ds_read_b128 v[40:43], v8 offset:8192
    s_waitcnt lgkmcnt(4)
    v_smfmac_f32_16x16x64_bf16 v[36:39], v[44:47], v[108:115], v9
    v_smfmac_f32_16x16x64_bf16 v[32:35], v[44:47], v[100:107], v9
    v_smfmac_f32_16x16x64_bf16 v[28:31], v[44:47], v[92:99], v9
    v_smfmac_f32_16x16x64_bf16 v[24:27], v[44:47], v[84:91], v9
    v_smfmac_f32_16x16x64_bf16 v[20:23], v[44:47], v[76:83], v9
    s_waitcnt lgkmcnt(2)
    v_smfmac_f32_16x16x64_bf16 v[16:19], v[44:47], v[52:59], v9
    ds_read_b128 v[52:55], v4 offset:6144
    ds_read_b128 v[56:59], v4 offset:7168
    ds_read_b128 v[44:47], v8 offset:4096
    s_waitcnt lgkmcnt(4)
    v_smfmac_f32_16x16x64_bf16 v[36:39], v[48:51], a[128:135], v9
    v_smfmac_f32_16x16x64_bf16 v[32:35], v[48:51], a[120:127], v9
    v_smfmac_f32_16x16x64_bf16 v[28:31], v[48:51], a[112:119], v9
    v_smfmac_f32_16x16x64_bf16 v[24:27], v[48:51], a[104:111], v9
    v_smfmac_f32_16x16x64_bf16 v[20:23], v[48:51], a[96:103], v9
    v_smfmac_f32_16x16x64_bf16 v[16:19], v[48:51], a[88:95], v9
    ds_read_b128 v[48:51], v8 offset:5120
    s_waitcnt lgkmcnt(4)
    v_smfmac_f32_16x16x64_bf16 v[36:39], v[40:43], v[196:203], v9
    v_smfmac_f32_16x16x64_bf16 v[32:35], v[40:43], v[188:195], v9
    v_smfmac_f32_16x16x64_bf16 v[28:31], v[40:43], v[180:187], v9
    v_smfmac_f32_16x16x64_bf16 v[24:27], v[40:43], v[172:179], v9
    v_smfmac_f32_16x16x64_bf16 v[20:23], v[40:43], v[164:171], v9
    s_waitcnt lgkmcnt(2)
    v_smfmac_f32_16x16x64_bf16 v[16:19], v[40:43], v[52:59], v9
    ds_read_b128 v[40:43], v8 offset:9216
    s_waitcnt lgkmcnt(2)
    v_smfmac_f32_16x16x64_bf16 v[36:39], v[44:47], a[216:223], v9
    v_smfmac_f32_16x16x64_bf16 v[32:35], v[44:47], a[208:215], v9
    s_waitcnt lgkmcnt(1)
    v_smfmac_f32_16x16x64_bf16 v[36:39], v[48:51], v[68:75], v9
    v_smfmac_f32_16x16x64_bf16 v[32:35], v[48:51], v[60:67], v9
    s_waitcnt lgkmcnt(0)
    v_smfmac_f32_16x16x64_bf16 v[36:39], v[40:43], v[244:251], v9
    v_smfmac_f32_16x16x64_bf16 v[32:35], v[40:43], v[236:243], v9
    v_smfmac_f32_16x16x64_bf16 v[28:31], v[44:47], a[200:207], v9
    v_smfmac_f32_16x16x64_bf16 v[24:27], v[44:47], a[192:199], v9
    v_smfmac_f32_16x16x64_bf16 v[28:31], v[48:51], a[248:255], v9
    v_smfmac_f32_16x16x64_bf16 v[24:27], v[48:51], a[240:247], v9
    v_smfmac_f32_16x16x64_bf16 v[28:31], v[40:43], v[228:235], v9
    v_smfmac_f32_16x16x64_bf16 v[24:27], v[40:43], v[220:227], v9
    v_smfmac_f32_16x16x64_bf16 v[20:23], v[44:47], a[184:191], v9
    v_smfmac_f32_16x16x64_bf16 v[16:19], v[44:47], a[176:183], v9
    v_permlane32_swap_b32 v32, v36
    v_permlane32_swap_b32 v33, v37
    v_permlane32_swap_b32 v34, v38
    v_smfmac_f32_16x16x64_bf16 v[20:23], v[48:51], a[232:239], v9
    v_permlane32_swap_b32 v35, v39
    v_add_f32 v32, v32, v36
    v_add_f32 v33, v33, v37
    v_smfmac_f32_16x16x64_bf16 v[16:19], v[48:51], a[224:231], v9
    v_add_f32 v34, v34, v38
    v_add_f32 v35, v35, v39
    v_cvt_pk_bf16_f32 v32, v32, v33
    v_smfmac_f32_16x16x64_bf16 v[20:23], v[40:43], v[212:219], v9
    v_cvt_pk_bf16_f32 v33, v34, v35
    ds_write_b64 v10, v[32:33] offset:1024
    v_smfmac_f32_16x16x64_bf16 v[16:19], v[40:43], v[204:211], v9
    v_permlane32_swap_b32 v24, v28
    v_permlane32_swap_b32 v25, v29
    v_permlane32_swap_b32 v26, v30
    v_permlane32_swap_b32 v27, v31
    v_add_f32 v24, v24, v28
    v_add_f32 v25, v25, v29
    v_add_f32 v26, v26, v30
    v_add_f32 v27, v27, v31
    v_cvt_pk_bf16_f32 v24, v24, v25
    v_cvt_pk_bf16_f32 v25, v26, v27
    ds_write_b64 v10, v[24:25] offset:512
    v_permlane32_swap_b32 v16, v20
    v_permlane32_swap_b32 v17, v21
    v_permlane32_swap_b32 v18, v22
    v_permlane32_swap_b32 v19, v23
    v_add_f32 v16, v16, v20
    v_add_f32 v17, v17, v21
    v_add_f32 v18, v18, v22
    v_add_f32 v19, v19, v23
    v_cvt_pk_bf16_f32 v16, v16, v17
    v_cvt_pk_bf16_f32 v17, v18, v19
    ds_write_b64 v10, v[16:17] offset:0
R1C_23:
    s_waitcnt lgkmcnt(0)
    s_barrier
    s_cmp_eq_u32 s33, 1
    s_cbranch_scc1 R1A_24
    s_cmp_ge_u32 s33, 2
    s_cbranch_scc1 R1B_25
    s_cmp_eq_u32 s34, 63
    s_cbranch_scc1 R1E_26
    ds_read_b64_tr_b16 v[20:21], v11 offset:0
    ds_read_b64_tr_b16 v[22:23], v11 offset:64
    ds_read_b64_tr_b16 v[24:25], v11 offset:3072
    ds_read_b64_tr_b16 v[26:27], v11 offset:3136
    ds_read_b64_tr_b16 v[28:29], v11 offset:512
    ds_read_b64_tr_b16 v[30:31], v11 offset:576
    ds_read_b64_tr_b16 v[32:33], v11 offset:3584
    ds_read_b64_tr_b16 v[34:35], v11 offset:3648
    ds_read_b64_tr_b16 v[36:37], v11 offset:1024
    ds_read_b64_tr_b16 v[38:39], v11 offset:1088
    ds_read_b64_tr_b16 v[40:41], v11 offset:4096
    ds_read_b64_tr_b16 v[42:43], v11 offset:4160
    ds_read_b64_tr_b16 v[44:45], v11 offset:1536
    ds_read_b64_tr_b16 v[46:47], v11 offset:1600
    ds_read_b64_tr_b16 v[48:49], v11 offset:4608
    ds_read_b64_tr_b16 v[50:51], v11 offset:4672
    ds_read_b64_tr_b16 v[52:53], v11 offset:2048
    ds_read_b64_tr_b16 v[54:55], v11 offset:2112
    ds_read_b64_tr_b16 v[56:57], v11 offset:5120
    ds_read_b64_tr_b16 v[58:59], v11 offset:5184
    s_waitcnt lgkmcnt(15)
    v_mfma_f32_16x16x32_bf16 v[16:19], v[24:27], v[20:23], 0
    ds_read_b64_tr_b16 v[20:21], v11 offset:2560
    ds_read_b64_tr_b16 v[22:23], v11 offset:2624
    ds_read_b64_tr_b16 v[24:25], v11 offset:5632
    ds_read_b64_tr_b16 v[26:27], v11 offset:5696
    s_waitcnt lgkmcnt(15)
    v_mfma_f32_16x16x32_bf16 v[16:19], v[32:35], v[28:31], v[16:19]
    s_waitcnt lgkmcnt(12)
    v_mfma_f32_16x16x32_bf16 v[16:19], v[40:43], v[36:39], v[16:19]
    s_waitcnt lgkmcnt(8)
    v_mfma_f32_16x16x32_bf16 v[16:19], v[48:51], v[44:47], v[16:19]
    s_waitcnt lgkmcnt(4)
    v_mfma_f32_16x16x32_bf16 v[16:19], v[56:59], v[52:55], v[16:19]
    s_waitcnt lgkmcnt(0)
    v_mfma_f32_16x16x32_bf16 v[16:19], v[24:27], v[20:23], v[16:19]
    s_mul_i32 s45, s34, 20480
    s_add_u32 s46, s45, s74
    s_add_u32 s45, s45, s73
    s_nop 4
    v_max3_f32 v28, v16, v17, v18
    v_max_f32 v28, v28, v19
    v_mov_b32 v29, v28
    s_nop 1
    v_permlane32_swap_b32 v28, v29
    v_max_f32 v28, v28, v29
    v_mov_b32 v29, v28
    s_nop 1
    v_permlane16_swap_b32 v28, v29
    v_max_f32 v28, v28, v29
    v_mul_f32 v28, s72, v28
    v_fma_f32 v16, v16, s72, -v28
    v_fma_f32 v17, v17, s72, -v28
    v_fma_f32 v18, v18, s72, -v28
    v_fma_f32 v19, v19, s72, -v28
    v_exp_f32 v16, v16
    v_exp_f32 v17, v17
    v_exp_f32 v18, v18
    v_exp_f32 v19, v19
    s_nop 0
    v_pk_add_f32 v[30:31], v[16:17], v[18:19]
    v_add_f32 v29, v30, v31
    v_mul_f32 v29, 0.5, v29
    v_mov_b32 v30, v29
    s_nop 1
    v_permlane32_swap_b32 v29, v30
    v_add_f32 v29, v29, v30
    v_mov_b32 v30, v29
    s_nop 1
    v_permlane16_swap_b32 v29, v30
    v_add_f32 v29, v29, v30
    ds_write_b64 v5, v[28:29] offset:32768
    s_waitcnt lgkmcnt(0)
    s_barrier
    ds_read_b64 v[32:33], v5 offset:32768
    ds_read_b64 v[34:35], v5 offset:33792
    ds_read_b64 v[36:37], v5 offset:34816
    s_waitcnt lgkmcnt(0)
    v_max3_f32 v41, v32, v34, v36
    v_sub_f32 v38, v32, v41
    v_sub_f32 v39, v34, v41
    v_sub_f32 v40, v36, v41
    v_exp_f32 v38, v38
    v_exp_f32 v39, v39
    v_exp_f32 v40, v40
    v_mul_f32 v41, v33, v38
    v_fma_f32 v41, v35, v39, v41
    v_fma_f32 v41, v37, v40, v41
    v_rcp_f32 v41, v41
    s_nop 0
    v_mul_f32 v38, v38, v41
    v_mul_f32 v16, v16, v38
    v_mul_f32 v17, v17, v38
    v_mul_f32 v18, v18, v38
    v_mul_f32 v19, v19, v38
    v_cvt_pk_bf16_f32 v32, v16, v17
    v_cvt_pk_bf16_f32 v33, v18, v19
    v_mov_b32 v34, v32
    v_mov_b32 v35, v33
    s_nop 0
    v_permlane16_swap_b32 v32, v34
    v_permlane16_swap_b32 v33, v35
    s_mov_b64 exec, s[68:69]
    buffer_store_dwordx4 v[32:35], v14, s[8:11], s46 offen sc1
    s_mov_b64 exec, -1
    s_sleep 39
    s_branch R1E_26
R1A_24:
    s_cmp_eq_u32 s34, 63
    s_cbranch_scc1 R1D_27
    s_barrier
R1D_27:
    ds_read_b64_tr_b16 v[16:17], v11 offset:3072
    ds_read_b64_tr_b16 v[18:19], v11 offset:3136
    ds_read_b64_tr_b16 v[20:21], v11 offset:3584
    ds_read_b64_tr_b16 v[22:23], v11 offset:3648
    ds_read_b64_tr_b16 v[24:25], v11 offset:4096
    ds_read_b64_tr_b16 v[26:27], v11 offset:4160
    ds_read_b64_tr_b16 v[28:29], v11 offset:4608
    ds_read_b64_tr_b16 v[30:31], v11 offset:4672
    ds_read_b64_tr_b16 v[32:33], v11 offset:5120
    ds_read_b64_tr_b16 v[34:35], v11 offset:5184
    ds_read_b64_tr_b16 v[36:37], v11 offset:5632
    ds_read_b64_tr_b16 v[38:39], v11 offset:5696
    s_mul_i32 s45, s34, 98304
    s_add_u32 s45, s45, s71
    s_waitcnt lgkmcnt(0)
    s_mov_b64 exec, s[66:67]
    buffer_store_dwordx4 v[16:19], v15, s[8:11], s45 offen offset:0 sc1
    buffer_store_dwordx4 v[20:23], v15, s[8:11], s45 offen offset:512 sc1
    buffer_store_dwordx4 v[24:27], v15, s[8:11], s45 offen offset:1024 sc1
    buffer_store_dwordx4 v[28:31], v15, s[8:11], s45 offen offset:1536 sc1
    buffer_store_dwordx4 v[32:35], v15, s[8:11], s45 offen offset:2048 sc1
    buffer_store_dwordx4 v[36:39], v15, s[8:11], s45 offen offset:2560 sc1
    s_mov_b64 exec, -1
    s_waitcnt vmcnt(0)
    s_add_u32 s45, s34, 1
    v_mov_b32 v1, s45
    v_mov_b32 v2, s65
    s_mov_b64 exec, 1
    buffer_store_dword v1, v2, s[8:11], 0 offen sc1
    s_mov_b64 exec, -1
    s_branch R1E_26
R1B_25:
    s_cmp_eq_u32 s34, 63
    s_cbranch_scc1 R1E_26
    s_add_u32 s45, s34, 0
    s_and_b32 s45, s45, 1
    s_mul_i32 s45, s45, 12288
    s_and_b32 s46, s33, 1
    s_mul_i32 s46, s46, 6144
    s_add_u32 s45, s45, s46
    v_add_u32 v1, s45, v12
    ds_read_b64_tr_b16 v[20:21], v11 offset:0
    ds_read_b64_tr_b16 v[22:23], v11 offset:64
    ds_read_b128 v[24:27], v1 offset:0
    ds_read_b64_tr_b16 v[28:29], v11 offset:512
    ds_read_b64_tr_b16 v[30:31], v11 offset:576
    ds_read_b128 v[32:35], v1 offset:1024
    ds_read_b64_tr_b16 v[36:37], v11 offset:1024
    ds_read_b64_tr_b16 v[38:39], v11 offset:1088
    ds_read_b128 v[40:43], v1 offset:2048
    ds_read_b64_tr_b16 v[44:45], v11 offset:1536
    ds_read_b64_tr_b16 v[46:47], v11 offset:1600
    ds_read_b128 v[48:51], v1 offset:3072
    ds_read_b64_tr_b16 v[52:53], v11 offset:2048
    ds_read_b64_tr_b16 v[54:55], v11 offset:2112
    ds_read_b128 v[56:59], v1 offset:4096
    s_waitcnt lgkmcnt(12)
    v_mfma_f32_16x16x32_bf16 v[16:19], v[24:27], v[20:23], 0
    ds_read_b64_tr_b16 v[20:21], v11 offset:2560
    ds_read_b64_tr_b16 v[22:23], v11 offset:2624
    ds_read_b128 v[24:27], v1 offset:5120
    s_waitcnt lgkmcnt(12)
    v_mfma_f32_16x16x32_bf16 v[16:19], v[32:35], v[28:31], v[16:19]
    s_waitcnt lgkmcnt(9)
    v_mfma_f32_16x16x32_bf16 v[16:19], v[40:43], v[36:39], v[16:19]
    s_waitcnt lgkmcnt(6)
    v_mfma_f32_16x16x32_bf16 v[16:19], v[48:51], v[44:47], v[16:19]
    s_waitcnt lgkmcnt(3)
    v_mfma_f32_16x16x32_bf16 v[16:19], v[56:59], v[52:55], v[16:19]
    s_waitcnt lgkmcnt(0)
    v_mfma_f32_16x16x32_bf16 v[16:19], v[24:27], v[20:23], v[16:19]
    s_mul_i32 s45, s34, 20480
    s_add_u32 s46, s45, s74
    s_add_u32 s45, s45, s73
    s_nop 4
    v_max3_f32 v28, v16, v17, v18
    v_max_f32 v28, v28, v19
    v_mov_b32 v29, v28
    s_nop 1
    v_permlane32_swap_b32 v28, v29
    v_max_f32 v28, v28, v29
    v_mov_b32 v29, v28
    s_nop 1
    v_permlane16_swap_b32 v28, v29
    v_max_f32 v28, v28, v29
    v_mul_f32 v28, s72, v28
    v_fma_f32 v16, v16, s72, -v28
    v_fma_f32 v17, v17, s72, -v28
    v_fma_f32 v18, v18, s72, -v28
    v_fma_f32 v19, v19, s72, -v28
    v_exp_f32 v16, v16
    v_exp_f32 v17, v17
    v_exp_f32 v18, v18
    v_exp_f32 v19, v19
    s_nop 0
    v_pk_add_f32 v[30:31], v[16:17], v[18:19]
    v_add_f32 v29, v30, v31
    v_mov_b32 v30, v29
    s_nop 1
    v_permlane32_swap_b32 v29, v30
    v_add_f32 v29, v29, v30
    v_mov_b32 v30, v29
    s_nop 1
    v_permlane16_swap_b32 v29, v30
    v_add_f32 v29, v29, v30
    s_cmp_eq_u32 s33, 3
    s_cbranch_scc1 R1F_28
    ds_write_b64 v5, v[28:29] offset:33792
    s_waitcnt lgkmcnt(0)
    s_barrier
    ds_read_b64 v[32:33], v5 offset:32768
    ds_read_b64 v[34:35], v5 offset:33792
    ds_read_b64 v[36:37], v5 offset:34816
    ds_read_b128 v[44:47], v5 offset:35840
    s_waitcnt lgkmcnt(1)
    v_max3_f32 v41, v32, v34, v36
    v_sub_f32 v38, v32, v41
    v_sub_f32 v39, v34, v41
    v_sub_f32 v40, v36, v41
    v_exp_f32 v38, v38
    v_exp_f32 v39, v39
    v_exp_f32 v40, v40
    v_mul_f32 v41, v33, v38
    v_fma_f32 v41, v35, v39, v41
    v_fma_f32 v41, v37, v40, v41
    v_rcp_f32 v41, v41
    s_nop 0
    v_mul_f32 v39, v39, v41
    v_mul_f32 v40, v40, v41
    v_mul_f32 v16, v16, v39
    v_mul_f32 v17, v17, v39
    v_mul_f32 v18, v18, v39
    v_mul_f32 v19, v19, v39
    s_waitcnt lgkmcnt(0)
    v_mul_f32 v44, v44, v40
    v_mul_f32 v45, v45, v40
    v_mul_f32 v46, v46, v40
    v_mul_f32 v47, v47, v40
    v_cvt_pk_bf16_f32 v28, v16, v17
    v_cvt_pk_bf16_f32 v30, v44, v45
    v_cvt_pk_bf16_f32 v29, v18, v19
    v_cvt_pk_bf16_f32 v31, v46, v47
    s_mov_b64 exec, s[66:67]
    buffer_store_dwordx4 v[28:31], v13, s[8:11], s45 offen sc1
    s_mov_b64 exec, -1
    s_branch R1G_29
R1F_28:
    ds_write_b64 v5, v[28:29] offset:34816
    ds_write_b128 v5, v[16:19] offset:35840
    s_waitcnt lgkmcnt(0)
    s_barrier
R1G_29:
    s_add_u32 s75, s34, 2
    s_add_u32 s76, s34, 1
    v_mov_b32 v2, s55
PL_30:
    buffer_load_dword v1, v2, s[8:11], 0 offen sc1
    s_waitcnt vmcnt(0)
    v_cmp_gt_u32 vcc, s75, v1
    s_cbranch_vccz PD_31
    s_sub_u32 s35, s35, 1
    s_cbranch_scc1 TO_32
    s_branch PL_30
PD_31:
    s_mul_i32 s45, s76, 786432
    s_add_u32 s45, s45, s70
    s_and_b32 s46, s33, 1
    s_mul_i32 s47, s46, 6144
    s_add_u32 s45, s45, s47
    buffer_load_dwordx4 v[16:19], v5, s[8:11], s45 offen offset:0 sc1
    buffer_load_dwordx4 v[20:23], v5, s[8:11], s45 offen offset:1024 sc1
    buffer_load_dwordx4 v[24:27], v5, s[8:11], s45 offen offset:2048 sc1
    buffer_load_dwordx4 v[28:31], v5, s[8:11], s45 offen offset:3072 sc1
    s_add_u32 s45, s45, 4096
    buffer_load_dwordx4 v[32:35], v5, s[8:11], s45 offen offset:0 sc1
    buffer_load_dwordx4 v[36:39], v5, s[8:11], s45 offen offset:1024 sc1
    s_and_b32 s46, s76, 1
    s_mul_i32 s46, s46, 12288
    s_add_u32 s46, s46, s47
    v_add_u32 v2, s46, v12
    s_waitcnt vmcnt(0)
    ds_write_b128 v2, v[16:19] offset:0
    ds_write_b128 v2, v[20:23] offset:1024
    ds_write_b128 v2, v[24:27] offset:2048
    ds_write_b128 v2, v[28:31] offset:3072
    ds_write_b128 v2, v[32:35] offset:4096
    ds_write_b128 v2, v[36:39] offset:5120
R1E_26:
    s_barrier
    s_add_u32 s34, s34, 1
    s_cmp_lt_u32 s34, 64
    s_cbranch_scc1 R1L_14
    s_waitcnt vmcnt(0)
    s_endpgm
L_R2:
    v_mov_b32 v20, -1
    v_mov_b32 v21, -1
    v_mov_b32 v22, -1
    v_mov_b32 v23, -1
    s_lshl_b32 s45, s33, 6
    v_add_u32 v16, s45, v0
    s_lshl_b32 s46, s32, 7
    s_add_u32 s46, s46, 141312
    v_add_u32 v17, 0, v16
    v_lshrrev_b32 v18, 3, v17
    v_mul_u32_u24 v18, 10240, v18
    v_and_b32 v19, 7, v17
    v_lshl_add_u32 v18, v19, 4, v18
    buffer_store_dwordx4 v[20:23], v18, s[8:11], s46 offen sc1
    v_add_u32 v17, 256, v16
    v_lshrrev_b32 v18, 3, v17
    v_mul_u32_u24 v18, 10240, v18
    v_and_b32 v19, 7, v17
    v_lshl_add_u32 v18, v19, 4, v18
    v_cmp_gt_u32 vcc, 504, v17
    s_and_saveexec_b64 s[48:49], vcc
    buffer_store_dwordx4 v[20:23], v18, s[8:11], s46 offen sc1
    s_mov_b64 exec, s[48:49]
    s_lshr_b32 s45, s32, 3
    s_lshl_b32 s59, s45, 6
    s_bfe_u32 s45, s32, 0x20001
    s_lshl_b32 s45, s45, 4
    s_add_u32 s59, s59, s45
    s_and_b32 s45, s32, 1
    s_lshl_b32 s45, s45, 1
    s_add_u32 s59, s59, s45
    s_load_dwordx2 s[4:5], s[0:1], 8
    s_waitcnt lgkmcnt(0)
    s_mov_b32 s16, s4
    s_mov_b32 s17, s5
    s_mov_b32 s18, 10240
    s_mov_b32 s19, 0x20000
    s_cmp_lg_u32 s33, 0
    s_cbranch_scc1 R2M0_33
    v_lshrrev_b32 v16, 2, v0
    v_mul_u32_u24 v16, 1280, v16
    v_and_b32 v17, 3, v0
    v_lshl_add_u32 v16, v17, 3, v16
    s_lshl_b32 s45, s59, 1
    s_mov_b32 exec_hi, 0
    buffer_load_dword v18, v16, s[16:19], s45 offen
    v_lshlrev_b32 v17, 2, v0
    s_lshl_b32 s46, s32, 7
    s_add_u32 s46, s46, 131072
    s_waitcnt vmcnt(0)
    v_min_u32 v18, -2, v18
    buffer_store_dword v18, v17, s[8:11], s46 offen sc1
    s_mov_b64 exec, -1
R2M0_33:
    s_cmp_lg_u32 s33, 0
    s_cbranch_scc1 FR_34
    s_mul_i32 s48, s32, 52429
    s_lshr_b32 s48, s48, 18
    s_mul_i32 s45, s48, 5
    s_sub_u32 s45, s32, s45
    s_lshl_b32 s45, s45, 7
    s_lshl_b32 s46, s48, 2
    s_add_u32 s45, s45, s46
    s_add_u32 s45, s45, 0
    v_mov_b32 v1, 0
    v_mov_b32 v2, s45
    s_mov_b64 exec, 1
    buffer_store_dword v1, v2, s[8:11], 0 offen sc1
    s_mov_b64 exec, -1
FR_34:
    s_waitcnt vmcnt(0) lgkmcnt(0)
    s_barrier
    s_cmp_lg_u32 s33, 0
    s_cbranch_scc1 SI_35
    v_mov_b32 v1, 1
    v_mov_b32 v2, 4
    s_mov_b64 exec, 1
    buffer_atomic_add v1, v2, s[28:31], 0 offen sc1
    s_mov_b64 exec, -1
SI_35:
    s_mul_i32 s48, s32, 52429
    s_lshr_b32 s48, s48, 18
    s_mul_i32 s45, s48, 5
    s_sub_u32 s49, s32, s45
    s_load_dwordx2 s[4:5], s[0:1], 32
    s_waitcnt lgkmcnt(0)
    s_mov_b32 s16, s4
    s_mov_b32 s17, s5
    s_mov_b32 s18, 7864320
    s_mov_b32 s19, 0x20000
    s_load_dwordx2 s[4:5], s[0:1], 40
    s_waitcnt lgkmcnt(0)
    s_mov_b32 s20, s4
    s_mov_b32 s21, s5
    s_mov_b32 s22, 7864320
    s_mov_b32 s23, 0x20000
    v_lshrrev_b32 v2, 4, v0
    v_and_b32 v3, 15, v0
    v_mul_u32_u24 v4, 1280, v2
    v_lshl_add_u32 v6, v3, 4, v4
    v_mul_u32_u24 v4, 288, v2
    v_lshl_add_u32 v7, v3, 4, v4
    s_mul_i32 s45, s33, 13824
    v_add_u32 v7, s45, v7
    v_bfe_u32 v4, v0, 2, 2
    v_lshl_add_u32 v4, v2, 3, v4
    v_mul_u32_u24 v4, 288, v4
    v_and_b32 v11, 3, v0
    v_lshl_add_u32 v8, v11, 3, v4
    v_lshrrev_b32 v4, 2, v3
    v_lshl_add_u32 v4, v4, 3, v11
    v_mul_u32_u24 v4, 12288, v4
    v_lshl_add_u32 v9, v2, 4, v4
    v_lshlrev_b32 v4, 6, v3
    v_lshl_add_u32 v10, v2, 4, v4
    s_mul_i32 s50, s48, 245760
    s_mul_i32 s45, s33, 61440
    s_add_u32 s50, s50, s45
    s_lshl_b32 s45, s49, 8
    s_add_u32 s50, s50, s45
    s_add_u32 s45, s50, 0
    buffer_load_dwordx4 v[64:67], v6, s[20:23], s45 offen
    s_add_u32 s45, s50, 5120
    buffer_load_dwordx4 v[68:71], v6, s[20:23], s45 offen
    s_add_u32 s45, s50, 10240
    buffer_load_dwordx4 v[72:75], v6, s[20:23], s45 offen
    s_add_u32 s45, s50, 15360
    buffer_load_dwordx4 v[76:79], v6, s[20:23], s45 offen
    s_add_u32 s45, s50, 20480
    buffer_load_dwordx4 v[80:83], v6, s[20:23], s45 offen
    s_add_u32 s45, s50, 25600
    buffer_load_dwordx4 v[84:87], v6, s[20:23], s45 offen
    s_add_u32 s45, s50, 30720
    buffer_load_dwordx4 v[88:91], v6, s[20:23], s45 offen
    s_add_u32 s45, s50, 35840
    buffer_load_dwordx4 v[92:95], v6, s[20:23], s45 offen
    s_add_u32 s45, s50, 40960
    buffer_load_dwordx4 v[96:99], v6, s[20:23], s45 offen
    s_add_u32 s45, s50, 46080
    buffer_load_dwordx4 v[100:103], v6, s[20:23], s45 offen
    s_add_u32 s45, s50, 51200
    buffer_load_dwordx4 v[104:107], v6, s[20:23], s45 offen
    s_add_u32 s45, s50, 56320
    buffer_load_dwordx4 v[108:111], v6, s[20:23], s45 offen
    s_mul_i32 s51, s33, 1966080
    s_mul_i32 s45, s48, 384
    s_add_u32 s51, s51, s45
    s_add_u32 s45, s51, 0
    buffer_load_dwordx4 v[112:115], v9, s[16:19], s45 offen offset:0
    buffer_load_dwordx4 v[116:119], v9, s[16:19], s45 offen offset:64
    buffer_load_dwordx4 v[120:123], v9, s[16:19], s45 offen offset:128
    buffer_load_dwordx4 v[124:127], v9, s[16:19], s45 offen offset:192
    buffer_load_dwordx4 v[128:131], v9, s[16:19], s45 offen offset:256
    buffer_load_dwordx4 v[132:135], v9, s[16:19], s45 offen offset:320
    s_add_u32 s45, s51, 49152
    buffer_load_dwordx4 v[136:139], v9, s[16:19], s45 offen offset:0
    buffer_load_dwordx4 v[140:143], v9, s[16:19], s45 offen offset:64
    buffer_load_dwordx4 v[144:147], v9, s[16:19], s45 offen offset:128
    buffer_load_dwordx4 v[148:151], v9, s[16:19], s45 offen offset:192
    buffer_load_dwordx4 v[152:155], v9, s[16:19], s45 offen offset:256
    buffer_load_dwordx4 v[156:159], v9, s[16:19], s45 offen offset:320
    s_waitcnt vmcnt(23)
    ds_write_b128 v7, v[64:67] offset:0
    s_waitcnt vmcnt(22)
    ds_write_b128 v7, v[68:71] offset:1152
    s_waitcnt vmcnt(21)
    ds_write_b128 v7, v[72:75] offset:2304
    s_waitcnt vmcnt(20)
    ds_write_b128 v7, v[76:79] offset:3456
    s_waitcnt vmcnt(19)
    ds_write_b128 v7, v[80:83] offset:4608
    s_waitcnt vmcnt(18)
    ds_write_b128 v7, v[84:87] offset:5760
    s_waitcnt vmcnt(17)
    ds_write_b128 v7, v[88:91] offset:6912
    s_waitcnt vmcnt(16)
    ds_write_b128 v7, v[92:95] offset:8064
    s_waitcnt vmcnt(15)
    ds_write_b128 v7, v[96:99] offset:9216
    s_waitcnt vmcnt(14)
    ds_write_b128 v7, v[100:103] offset:10368
    s_waitcnt vmcnt(13)
    ds_write_b128 v7, v[104:107] offset:11520
    s_waitcnt vmcnt(12)
    ds_write_b128 v7, v[108:111] offset:12672
    s_waitcnt lgkmcnt(0)
    s_barrier
    ds_read_b64_tr_b16 a[0:1], v8 offset:0
    ds_read_b64_tr_b16 a[2:3], v8 offset:1152
    ds_read_b64_tr_b16 a[4:5], v8 offset:9216
    ds_read_b64_tr_b16 a[6:7], v8 offset:10368
    ds_read_b64_tr_b16 a[8:9], v8 offset:18432
    ds_read_b64_tr_b16 a[10:11], v8 offset:19584
    ds_read_b64_tr_b16 a[12:13], v8 offset:27648
    ds_read_b64_tr_b16 a[14:15], v8 offset:28800
    ds_read_b64_tr_b16 a[16:17], v8 offset:36864
    ds_read_b64_tr_b16 a[18:19], v8 offset:38016
    ds_read_b64_tr_b16 a[20:21], v8 offset:46080
    ds_read_b64_tr_b16 a[22:23], v8 offset:47232
    ds_read_b64_tr_b16 a[24:25], v8 offset:32
    ds_read_b64_tr_b16 a[26:27], v8 offset:1184
    ds_read_b64_tr_b16 a[28:29], v8 offset:9248
    ds_read_b64_tr_b16 a[30:31], v8 offset:10400
    ds_read_b64_tr_b16 a[32:33], v8 offset:18464
    ds_read_b64_tr_b16 a[34:35], v8 offset:19616
    ds_read_b64_tr_b16 a[36:37], v8 offset:27680
    ds_read_b64_tr_b16 a[38:39], v8 offset:28832
    ds_read_b64_tr_b16 a[40:41], v8 offset:36896
    ds_read_b64_tr_b16 a[42:43], v8 offset:38048
    ds_read_b64_tr_b16 a[44:45], v8 offset:46112
    ds_read_b64_tr_b16 a[46:47], v8 offset:47264
    ds_read_b64_tr_b16 a[48:49], v8 offset:64
    ds_read_b64_tr_b16 a[50:51], v8 offset:1216
    ds_read_b64_tr_b16 a[52:53], v8 offset:9280
    ds_read_b64_tr_b16 a[54:55], v8 offset:10432
    ds_read_b64_tr_b16 a[56:57], v8 offset:18496
    ds_read_b64_tr_b16 a[58:59], v8 offset:19648
    ds_read_b64_tr_b16 a[60:61], v8 offset:27712
    ds_read_b64_tr_b16 a[62:63], v8 offset:28864
    ds_read_b64_tr_b16 a[64:65], v8 offset:36928
    ds_read_b64_tr_b16 a[66:67], v8 offset:38080
    ds_read_b64_tr_b16 a[68:69], v8 offset:46144
    ds_read_b64_tr_b16 a[70:71], v8 offset:47296
    ds_read_b64_tr_b16 a[72:73], v8 offset:96
    ds_read_b64_tr_b16 a[74:75], v8 offset:1248
    ds_read_b64_tr_b16 a[76:77], v8 offset:9312
    ds_read_b64_tr_b16 a[78:79], v8 offset:10464
    ds_read_b64_tr_b16 a[80:81], v8 offset:18528
    ds_read_b64_tr_b16 a[82:83], v8 offset:19680
    ds_read_b64_tr_b16 a[84:85], v8 offset:27744
    ds_read_b64_tr_b16 a[86:87], v8 offset:28896
    ds_read_b64_tr_b16 a[88:89], v8 offset:36960
    ds_read_b64_tr_b16 a[90:91], v8 offset:38112
    ds_read_b64_tr_b16 a[92:93], v8 offset:46176
    ds_read_b64_tr_b16 a[94:95], v8 offset:47328
    ds_read_b64_tr_b16 a[96:97], v8 offset:128
    ds_read_b64_tr_b16 a[98:99], v8 offset:1280
    ds_read_b64_tr_b16 a[100:101], v8 offset:9344
    ds_read_b64_tr_b16 a[102:103], v8 offset:10496
    ds_read_b64_tr_b16 a[104:105], v8 offset:18560
    ds_read_b64_tr_b16 a[106:107], v8 offset:19712
    ds_read_b64_tr_b16 a[108:109], v8 offset:27776
    ds_read_b64_tr_b16 a[110:111], v8 offset:28928
    ds_read_b64_tr_b16 a[112:113], v8 offset:36992
    ds_read_b64_tr_b16 a[114:115], v8 offset:38144
    ds_read_b64_tr_b16 a[116:117], v8 offset:46208
    ds_read_b64_tr_b16 a[118:119], v8 offset:47360
    ds_read_b64_tr_b16 a[120:121], v8 offset:160
    ds_read_b64_tr_b16 a[122:123], v8 offset:1312
    ds_read_b64_tr_b16 a[124:125], v8 offset:9376
    ds_read_b64_tr_b16 a[126:127], v8 offset:10528
    ds_read_b64_tr_b16 a[128:129], v8 offset:18592
    ds_read_b64_tr_b16 a[130:131], v8 offset:19744
    ds_read_b64_tr_b16 a[132:133], v8 offset:27808
    ds_read_b64_tr_b16 a[134:135], v8 offset:28960
    ds_read_b64_tr_b16 a[136:137], v8 offset:37024
    ds_read_b64_tr_b16 a[138:139], v8 offset:38176
    ds_read_b64_tr_b16 a[140:141], v8 offset:46240
    ds_read_b64_tr_b16 a[142:143], v8 offset:47392
    ds_read_b64_tr_b16 a[144:145], v8 offset:192
    ds_read_b64_tr_b16 a[146:147], v8 offset:1344
    ds_read_b64_tr_b16 a[148:149], v8 offset:9408
    ds_read_b64_tr_b16 a[150:151], v8 offset:10560
    ds_read_b64_tr_b16 a[152:153], v8 offset:18624
    ds_read_b64_tr_b16 a[154:155], v8 offset:19776
    ds_read_b64_tr_b16 a[156:157], v8 offset:27840
    ds_read_b64_tr_b16 a[158:159], v8 offset:28992
    ds_read_b64_tr_b16 a[160:161], v8 offset:37056
    ds_read_b64_tr_b16 a[162:163], v8 offset:38208
    ds_read_b64_tr_b16 a[164:165], v8 offset:46272
    ds_read_b64_tr_b16 a[166:167], v8 offset:47424
    ds_read_b64_tr_b16 a[168:169], v8 offset:224
    ds_read_b64_tr_b16 a[170:171], v8 offset:1376
    ds_read_b64_tr_b16 a[172:173], v8 offset:9440
    ds_read_b64_tr_b16 a[174:175], v8 offset:10592
    ds_read_b64_tr_b16 a[176:177], v8 offset:18656
    ds_read_b64_tr_b16 a[178:179], v8 offset:19808
    ds_read_b64_tr_b16 a[180:181], v8 offset:27872
    ds_read_b64_tr_b16 a[182:183], v8 offset:29024
    ds_read_b64_tr_b16 a[184:185], v8 offset:37088
    ds_read_b64_tr_b16 a[186:187], v8 offset:38240
    ds_read_b64_tr_b16 a[188:189], v8 offset:46304
    ds_read_b64_tr_b16 a[190:191], v8 offset:47456
    s_mul_i32 s52, s48, 819200
    s_mul_i32 s45, s33, 204800
    s_add_u32 s52, s52, s45
    s_lshl_b32 s45, s49, 13
    s_add_u32 s52, s52, s45
    s_add_u32 s52, s52, 24117248
    s_waitcnt lgkmcnt(0)
    s_add_u32 s45, s51, 393216
    buffer_load_dwordx4 v[160:163], v9, s[16:19], s45 offen offset:0
    buffer_load_dwordx4 v[164:167], v9, s[16:19], s45 offen offset:64
    buffer_load_dwordx4 v[168:171], v9, s[16:19], s45 offen offset:128
    buffer_load_dwordx4 v[172:175], v9, s[16:19], s45 offen offset:192
    buffer_load_dwordx4 v[176:179], v9, s[16:19], s45 offen offset:256
    buffer_load_dwordx4 v[180:183], v9, s[16:19], s45 offen offset:320
    s_add_u32 s45, s51, 442368
    buffer_load_dwordx4 v[184:187], v9, s[16:19], s45 offen offset:0
    buffer_load_dwordx4 v[188:191], v9, s[16:19], s45 offen offset:64
    buffer_load_dwordx4 v[192:195], v9, s[16:19], s45 offen offset:128
    buffer_load_dwordx4 v[196:199], v9, s[16:19], s45 offen offset:192
    buffer_load_dwordx4 v[200:203], v9, s[16:19], s45 offen offset:256
    buffer_load_dwordx4 v[204:207], v9, s[16:19], s45 offen offset:320
    s_waitcnt vmcnt(12)
    v_mfma_f32_16x16x32_bf16 v[16:19], v[112:115], a[0:3], 0
    v_mfma_f32_16x16x32_bf16 v[20:23], v[112:115], a[24:27], 0
    v_mfma_f32_16x16x32_bf16 v[24:27], v[112:115], a[48:51], 0
    v_mfma_f32_16x16x32_bf16 v[28:31], v[112:115], a[72:75], 0
    v_mfma_f32_16x16x32_bf16 v[32:35], v[112:115], a[96:99], 0
    v_mfma_f32_16x16x32_bf16 v[36:39], v[112:115], a[120:123], 0
    v_mfma_f32_16x16x32_bf16 v[40:43], v[112:115], a[144:147], 0
    v_mfma_f32_16x16x32_bf16 v[44:47], v[112:115], a[168:171], 0
    v_mfma_f32_16x16x32_bf16 v[48:51], v[136:139], a[0:3], 0
    v_mfma_f32_16x16x32_bf16 v[52:55], v[136:139], a[24:27], 0
    v_mfma_f32_16x16x32_bf16 v[56:59], v[136:139], a[48:51], 0
    v_mfma_f32_16x16x32_bf16 v[60:63], v[136:139], a[72:75], 0
    v_mfma_f32_16x16x32_bf16 v[64:67], v[136:139], a[96:99], 0
    v_mfma_f32_16x16x32_bf16 v[68:71], v[136:139], a[120:123], 0
    v_mfma_f32_16x16x32_bf16 v[72:75], v[136:139], a[144:147], 0
    v_mfma_f32_16x16x32_bf16 v[76:79], v[136:139], a[168:171], 0
    v_mfma_f32_16x16x32_bf16 v[16:19], v[116:119], a[4:7], v[16:19]
    v_mfma_f32_16x16x32_bf16 v[20:23], v[116:119], a[28:31], v[20:23]
    v_mfma_f32_16x16x32_bf16 v[24:27], v[116:119], a[52:55], v[24:27]
    v_mfma_f32_16x16x32_bf16 v[28:31], v[116:119], a[76:79], v[28:31]
    v_mfma_f32_16x16x32_bf16 v[32:35], v[116:119], a[100:103], v[32:35]
    v_mfma_f32_16x16x32_bf16 v[36:39], v[116:119], a[124:127], v[36:39]
    v_mfma_f32_16x16x32_bf16 v[40:43], v[116:119], a[148:151], v[40:43]
    v_mfma_f32_16x16x32_bf16 v[44:47], v[116:119], a[172:175], v[44:47]
    v_mfma_f32_16x16x32_bf16 v[48:51], v[140:143], a[4:7], v[48:51]
    v_mfma_f32_16x16x32_bf16 v[52:55], v[140:143], a[28:31], v[52:55]
    v_mfma_f32_16x16x32_bf16 v[56:59], v[140:143], a[52:55], v[56:59]
    v_mfma_f32_16x16x32_bf16 v[60:63], v[140:143], a[76:79], v[60:63]
    v_mfma_f32_16x16x32_bf16 v[64:67], v[140:143], a[100:103], v[64:67]
    v_mfma_f32_16x16x32_bf16 v[68:71], v[140:143], a[124:127], v[68:71]
    v_mfma_f32_16x16x32_bf16 v[72:75], v[140:143], a[148:151], v[72:75]
    v_mfma_f32_16x16x32_bf16 v[76:79], v[140:143], a[172:175], v[76:79]
    v_mfma_f32_16x16x32_bf16 v[16:19], v[120:123], a[8:11], v[16:19]
    v_mfma_f32_16x16x32_bf16 v[20:23], v[120:123], a[32:35], v[20:23]
    v_mfma_f32_16x16x32_bf16 v[24:27], v[120:123], a[56:59], v[24:27]
    v_mfma_f32_16x16x32_bf16 v[28:31], v[120:123], a[80:83], v[28:31]
    v_mfma_f32_16x16x32_bf16 v[32:35], v[120:123], a[104:107], v[32:35]
    v_mfma_f32_16x16x32_bf16 v[36:39], v[120:123], a[128:131], v[36:39]
    v_mfma_f32_16x16x32_bf16 v[40:43], v[120:123], a[152:155], v[40:43]
    v_mfma_f32_16x16x32_bf16 v[44:47], v[120:123], a[176:179], v[44:47]
    v_mfma_f32_16x16x32_bf16 v[48:51], v[144:147], a[8:11], v[48:51]
    v_mfma_f32_16x16x32_bf16 v[52:55], v[144:147], a[32:35], v[52:55]
    v_mfma_f32_16x16x32_bf16 v[56:59], v[144:147], a[56:59], v[56:59]
    v_mfma_f32_16x16x32_bf16 v[60:63], v[144:147], a[80:83], v[60:63]
    v_mfma_f32_16x16x32_bf16 v[64:67], v[144:147], a[104:107], v[64:67]
    v_mfma_f32_16x16x32_bf16 v[68:71], v[144:147], a[128:131], v[68:71]
    v_mfma_f32_16x16x32_bf16 v[72:75], v[144:147], a[152:155], v[72:75]
    v_mfma_f32_16x16x32_bf16 v[76:79], v[144:147], a[176:179], v[76:79]
    v_mfma_f32_16x16x32_bf16 v[16:19], v[124:127], a[12:15], v[16:19]
    v_mfma_f32_16x16x32_bf16 v[20:23], v[124:127], a[36:39], v[20:23]
    v_mfma_f32_16x16x32_bf16 v[24:27], v[124:127], a[60:63], v[24:27]
    v_mfma_f32_16x16x32_bf16 v[28:31], v[124:127], a[84:87], v[28:31]
    v_mfma_f32_16x16x32_bf16 v[32:35], v[124:127], a[108:111], v[32:35]
    v_mfma_f32_16x16x32_bf16 v[36:39], v[124:127], a[132:135], v[36:39]
    v_mfma_f32_16x16x32_bf16 v[40:43], v[124:127], a[156:159], v[40:43]
    v_mfma_f32_16x16x32_bf16 v[44:47], v[124:127], a[180:183], v[44:47]
    v_mfma_f32_16x16x32_bf16 v[48:51], v[148:151], a[12:15], v[48:51]
    v_mfma_f32_16x16x32_bf16 v[52:55], v[148:151], a[36:39], v[52:55]
    v_mfma_f32_16x16x32_bf16 v[56:59], v[148:151], a[60:63], v[56:59]
    v_mfma_f32_16x16x32_bf16 v[60:63], v[148:151], a[84:87], v[60:63]
    v_mfma_f32_16x16x32_bf16 v[64:67], v[148:151], a[108:111], v[64:67]
    v_mfma_f32_16x16x32_bf16 v[68:71], v[148:151], a[132:135], v[68:71]
    v_mfma_f32_16x16x32_bf16 v[72:75], v[148:151], a[156:159], v[72:75]
    v_mfma_f32_16x16x32_bf16 v[76:79], v[148:151], a[180:183], v[76:79]
    v_mfma_f32_16x16x32_bf16 v[16:19], v[128:131], a[16:19], v[16:19]
    v_mfma_f32_16x16x32_bf16 v[20:23], v[128:131], a[40:43], v[20:23]
    v_mfma_f32_16x16x32_bf16 v[24:27], v[128:131], a[64:67], v[24:27]
    v_mfma_f32_16x16x32_bf16 v[28:31], v[128:131], a[88:91], v[28:31]
    v_mfma_f32_16x16x32_bf16 v[32:35], v[128:131], a[112:115], v[32:35]
    v_mfma_f32_16x16x32_bf16 v[36:39], v[128:131], a[136:139], v[36:39]
    v_mfma_f32_16x16x32_bf16 v[40:43], v[128:131], a[160:163], v[40:43]
    v_mfma_f32_16x16x32_bf16 v[44:47], v[128:131], a[184:187], v[44:47]
    v_mfma_f32_16x16x32_bf16 v[48:51], v[152:155], a[16:19], v[48:51]
    v_mfma_f32_16x16x32_bf16 v[52:55], v[152:155], a[40:43], v[52:55]
    v_mfma_f32_16x16x32_bf16 v[56:59], v[152:155], a[64:67], v[56:59]
    v_mfma_f32_16x16x32_bf16 v[60:63], v[152:155], a[88:91], v[60:63]
    v_mfma_f32_16x16x32_bf16 v[64:67], v[152:155], a[112:115], v[64:67]
    v_mfma_f32_16x16x32_bf16 v[68:71], v[152:155], a[136:139], v[68:71]
    v_mfma_f32_16x16x32_bf16 v[72:75], v[152:155], a[160:163], v[72:75]
    v_mfma_f32_16x16x32_bf16 v[76:79], v[152:155], a[184:187], v[76:79]
    v_mfma_f32_16x16x32_bf16 v[16:19], v[132:135], a[20:23], v[16:19]
    v_mfma_f32_16x16x32_bf16 v[20:23], v[132:135], a[44:47], v[20:23]
    v_mfma_f32_16x16x32_bf16 v[24:27], v[132:135], a[68:71], v[24:27]
    v_mfma_f32_16x16x32_bf16 v[28:31], v[132:135], a[92:95], v[28:31]
    v_mfma_f32_16x16x32_bf16 v[32:35], v[132:135], a[116:119], v[32:35]
    v_mfma_f32_16x16x32_bf16 v[36:39], v[132:135], a[140:143], v[36:39]
    v_mfma_f32_16x16x32_bf16 v[40:43], v[132:135], a[164:167], v[40:43]
    v_mfma_f32_16x16x32_bf16 v[44:47], v[132:135], a[188:191], v[44:47]
    v_mfma_f32_16x16x32_bf16 v[48:51], v[156:159], a[20:23], v[48:51]
    v_mfma_f32_16x16x32_bf16 v[52:55], v[156:159], a[44:47], v[52:55]
    v_mfma_f32_16x16x32_bf16 v[56:59], v[156:159], a[68:71], v[56:59]
    v_mfma_f32_16x16x32_bf16 v[60:63], v[156:159], a[92:95], v[60:63]
    v_mfma_f32_16x16x32_bf16 v[64:67], v[156:159], a[116:119], v[64:67]
    v_mfma_f32_16x16x32_bf16 v[68:71], v[156:159], a[140:143], v[68:71]
    v_mfma_f32_16x16x32_bf16 v[72:75], v[156:159], a[164:167], v[72:75]
    v_mfma_f32_16x16x32_bf16 v[76:79], v[156:159], a[188:191], v[76:79]
    v_cvt_pk_bf16_f32 v208, v16, v17
    v_cvt_pk_bf16_f32 v209, v18, v19
    v_cvt_pk_bf16_f32 v210, v48, v49
    v_cvt_pk_bf16_f32 v211, v50, v51
    s_add_u32 s45, s52, 0
    buffer_store_dwordx4 v[208:211], v10, s[8:11], s45 offen sc1
    v_cvt_pk_bf16_f32 v212, v20, v21
    v_cvt_pk_bf16_f32 v213, v22, v23
    v_cvt_pk_bf16_f32 v214, v52, v53
    v_cvt_pk_bf16_f32 v215, v54, v55
    s_add_u32 s45, s52, 1024
    buffer_store_dwordx4 v[212:215], v10, s[8:11], s45 offen sc1
    v_cvt_pk_bf16_f32 v216, v24, v25
    v_cvt_pk_bf16_f32 v217, v26, v27
    v_cvt_pk_bf16_f32 v218, v56, v57
    v_cvt_pk_bf16_f32 v219, v58, v59
    s_add_u32 s45, s52, 2048
    buffer_store_dwordx4 v[216:219], v10, s[8:11], s45 offen sc1
    v_cvt_pk_bf16_f32 v220, v28, v29
    v_cvt_pk_bf16_f32 v221, v30, v31
    v_cvt_pk_bf16_f32 v222, v60, v61
    v_cvt_pk_bf16_f32 v223, v62, v63
    s_add_u32 s45, s52, 3072
    buffer_store_dwordx4 v[220:223], v10, s[8:11], s45 offen sc1
    v_cvt_pk_bf16_f32 v224, v32, v33
    v_cvt_pk_bf16_f32 v225, v34, v35
    v_cvt_pk_bf16_f32 v226, v64, v65
    v_cvt_pk_bf16_f32 v227, v66, v67
    s_add_u32 s45, s52, 4096
    buffer_store_dwordx4 v[224:227], v10, s[8:11], s45 offen sc1
    v_cvt_pk_bf16_f32 v228, v36, v37
    v_cvt_pk_bf16_f32 v229, v38, v39
    v_cvt_pk_bf16_f32 v230, v68, v69
    v_cvt_pk_bf16_f32 v231, v70, v71
    s_add_u32 s45, s52, 5120
    buffer_store_dwordx4 v[228:231], v10, s[8:11], s45 offen sc1
    v_cvt_pk_bf16_f32 v232, v40, v41
    v_cvt_pk_bf16_f32 v233, v42, v43
    v_cvt_pk_bf16_f32 v234, v72, v73
    v_cvt_pk_bf16_f32 v235, v74, v75
    s_add_u32 s45, s52, 6144
    buffer_store_dwordx4 v[232:235], v10, s[8:11], s45 offen sc1
    v_cvt_pk_bf16_f32 v236, v44, v45
    v_cvt_pk_bf16_f32 v237, v46, v47
    v_cvt_pk_bf16_f32 v238, v76, v77
    v_cvt_pk_bf16_f32 v239, v78, v79
    s_add_u32 s45, s52, 7168
    buffer_store_dwordx4 v[236:239], v10, s[8:11], s45 offen sc1
    s_add_u32 s45, s51, 786432
    buffer_load_dwordx4 v[112:115], v9, s[16:19], s45 offen offset:0
    buffer_load_dwordx4 v[116:119], v9, s[16:19], s45 offen offset:64
    buffer_load_dwordx4 v[120:123], v9, s[16:19], s45 offen offset:128
    buffer_load_dwordx4 v[124:127], v9, s[16:19], s45 offen offset:192
    buffer_load_dwordx4 v[128:131], v9, s[16:19], s45 offen offset:256
    buffer_load_dwordx4 v[132:135], v9, s[16:19], s45 offen offset:320
    s_add_u32 s45, s51, 835584
    buffer_load_dwordx4 v[136:139], v9, s[16:19], s45 offen offset:0
    buffer_load_dwordx4 v[140:143], v9, s[16:19], s45 offen offset:64
    buffer_load_dwordx4 v[144:147], v9, s[16:19], s45 offen offset:128
    buffer_load_dwordx4 v[148:151], v9, s[16:19], s45 offen offset:192
    buffer_load_dwordx4 v[152:155], v9, s[16:19], s45 offen offset:256
    buffer_load_dwordx4 v[156:159], v9, s[16:19], s45 offen offset:320
    s_waitcnt vmcnt(20)
    v_mfma_f32_16x16x32_bf16 v[16:19], v[160:163], a[0:3], 0
    v_mfma_f32_16x16x32_bf16 v[20:23], v[160:163], a[24:27], 0
    v_mfma_f32_16x16x32_bf16 v[24:27], v[160:163], a[48:51], 0
    v_mfma_f32_16x16x32_bf16 v[28:31], v[160:163], a[72:75], 0
    v_mfma_f32_16x16x32_bf16 v[32:35], v[160:163], a[96:99], 0
    v_mfma_f32_16x16x32_bf16 v[36:39], v[160:163], a[120:123], 0
    v_mfma_f32_16x16x32_bf16 v[40:43], v[160:163], a[144:147], 0
    v_mfma_f32_16x16x32_bf16 v[44:47], v[160:163], a[168:171], 0
    v_mfma_f32_16x16x32_bf16 v[48:51], v[184:187], a[0:3], 0
    v_mfma_f32_16x16x32_bf16 v[52:55], v[184:187], a[24:27], 0
    v_mfma_f32_16x16x32_bf16 v[56:59], v[184:187], a[48:51], 0
    v_mfma_f32_16x16x32_bf16 v[60:63], v[184:187], a[72:75], 0
    v_mfma_f32_16x16x32_bf16 v[64:67], v[184:187], a[96:99], 0
    v_mfma_f32_16x16x32_bf16 v[68:71], v[184:187], a[120:123], 0
    v_mfma_f32_16x16x32_bf16 v[72:75], v[184:187], a[144:147], 0
    v_mfma_f32_16x16x32_bf16 v[76:79], v[184:187], a[168:171], 0
    v_mfma_f32_16x16x32_bf16 v[16:19], v[164:167], a[4:7], v[16:19]
    v_mfma_f32_16x16x32_bf16 v[20:23], v[164:167], a[28:31], v[20:23]
    v_mfma_f32_16x16x32_bf16 v[24:27], v[164:167], a[52:55], v[24:27]
    v_mfma_f32_16x16x32_bf16 v[28:31], v[164:167], a[76:79], v[28:31]
    v_mfma_f32_16x16x32_bf16 v[32:35], v[164:167], a[100:103], v[32:35]
    v_mfma_f32_16x16x32_bf16 v[36:39], v[164:167], a[124:127], v[36:39]
    v_mfma_f32_16x16x32_bf16 v[40:43], v[164:167], a[148:151], v[40:43]
    v_mfma_f32_16x16x32_bf16 v[44:47], v[164:167], a[172:175], v[44:47]
    v_mfma_f32_16x16x32_bf16 v[48:51], v[188:191], a[4:7], v[48:51]
    v_mfma_f32_16x16x32_bf16 v[52:55], v[188:191], a[28:31], v[52:55]
    v_mfma_f32_16x16x32_bf16 v[56:59], v[188:191], a[52:55], v[56:59]
    v_mfma_f32_16x16x32_bf16 v[60:63], v[188:191], a[76:79], v[60:63]
    v_mfma_f32_16x16x32_bf16 v[64:67], v[188:191], a[100:103], v[64:67]
    v_mfma_f32_16x16x32_bf16 v[68:71], v[188:191], a[124:127], v[68:71]
    v_mfma_f32_16x16x32_bf16 v[72:75], v[188:191], a[148:151], v[72:75]
    v_mfma_f32_16x16x32_bf16 v[76:79], v[188:191], a[172:175], v[76:79]
    v_mfma_f32_16x16x32_bf16 v[16:19], v[168:171], a[8:11], v[16:19]
    v_mfma_f32_16x16x32_bf16 v[20:23], v[168:171], a[32:35], v[20:23]
    v_mfma_f32_16x16x32_bf16 v[24:27], v[168:171], a[56:59], v[24:27]
    v_mfma_f32_16x16x32_bf16 v[28:31], v[168:171], a[80:83], v[28:31]
    v_mfma_f32_16x16x32_bf16 v[32:35], v[168:171], a[104:107], v[32:35]
    v_mfma_f32_16x16x32_bf16 v[36:39], v[168:171], a[128:131], v[36:39]
    v_mfma_f32_16x16x32_bf16 v[40:43], v[168:171], a[152:155], v[40:43]
    v_mfma_f32_16x16x32_bf16 v[44:47], v[168:171], a[176:179], v[44:47]
    v_mfma_f32_16x16x32_bf16 v[48:51], v[192:195], a[8:11], v[48:51]
    v_mfma_f32_16x16x32_bf16 v[52:55], v[192:195], a[32:35], v[52:55]
    v_mfma_f32_16x16x32_bf16 v[56:59], v[192:195], a[56:59], v[56:59]
    v_mfma_f32_16x16x32_bf16 v[60:63], v[192:195], a[80:83], v[60:63]
    v_mfma_f32_16x16x32_bf16 v[64:67], v[192:195], a[104:107], v[64:67]
    v_mfma_f32_16x16x32_bf16 v[68:71], v[192:195], a[128:131], v[68:71]
    v_mfma_f32_16x16x32_bf16 v[72:75], v[192:195], a[152:155], v[72:75]
    v_mfma_f32_16x16x32_bf16 v[76:79], v[192:195], a[176:179], v[76:79]
    v_mfma_f32_16x16x32_bf16 v[16:19], v[172:175], a[12:15], v[16:19]
    v_mfma_f32_16x16x32_bf16 v[20:23], v[172:175], a[36:39], v[20:23]
    v_mfma_f32_16x16x32_bf16 v[24:27], v[172:175], a[60:63], v[24:27]
    v_mfma_f32_16x16x32_bf16 v[28:31], v[172:175], a[84:87], v[28:31]
    v_mfma_f32_16x16x32_bf16 v[32:35], v[172:175], a[108:111], v[32:35]
    v_mfma_f32_16x16x32_bf16 v[36:39], v[172:175], a[132:135], v[36:39]
    v_mfma_f32_16x16x32_bf16 v[40:43], v[172:175], a[156:159], v[40:43]
    v_mfma_f32_16x16x32_bf16 v[44:47], v[172:175], a[180:183], v[44:47]
    v_mfma_f32_16x16x32_bf16 v[48:51], v[196:199], a[12:15], v[48:51]
    v_mfma_f32_16x16x32_bf16 v[52:55], v[196:199], a[36:39], v[52:55]
    v_mfma_f32_16x16x32_bf16 v[56:59], v[196:199], a[60:63], v[56:59]
    v_mfma_f32_16x16x32_bf16 v[60:63], v[196:199], a[84:87], v[60:63]
    v_mfma_f32_16x16x32_bf16 v[64:67], v[196:199], a[108:111], v[64:67]
    v_mfma_f32_16x16x32_bf16 v[68:71], v[196:199], a[132:135], v[68:71]
    v_mfma_f32_16x16x32_bf16 v[72:75], v[196:199], a[156:159], v[72:75]
    v_mfma_f32_16x16x32_bf16 v[76:79], v[196:199], a[180:183], v[76:79]
    v_mfma_f32_16x16x32_bf16 v[16:19], v[176:179], a[16:19], v[16:19]
    v_mfma_f32_16x16x32_bf16 v[20:23], v[176:179], a[40:43], v[20:23]
    v_mfma_f32_16x16x32_bf16 v[24:27], v[176:179], a[64:67], v[24:27]
    v_mfma_f32_16x16x32_bf16 v[28:31], v[176:179], a[88:91], v[28:31]
    v_mfma_f32_16x16x32_bf16 v[32:35], v[176:179], a[112:115], v[32:35]
    v_mfma_f32_16x16x32_bf16 v[36:39], v[176:179], a[136:139], v[36:39]
    v_mfma_f32_16x16x32_bf16 v[40:43], v[176:179], a[160:163], v[40:43]
    v_mfma_f32_16x16x32_bf16 v[44:47], v[176:179], a[184:187], v[44:47]
    v_mfma_f32_16x16x32_bf16 v[48:51], v[200:203], a[16:19], v[48:51]
    v_mfma_f32_16x16x32_bf16 v[52:55], v[200:203], a[40:43], v[52:55]
    v_mfma_f32_16x16x32_bf16 v[56:59], v[200:203], a[64:67], v[56:59]
    v_mfma_f32_16x16x32_bf16 v[60:63], v[200:203], a[88:91], v[60:63]
    v_mfma_f32_16x16x32_bf16 v[64:67], v[200:203], a[112:115], v[64:67]
    v_mfma_f32_16x16x32_bf16 v[68:71], v[200:203], a[136:139], v[68:71]
    v_mfma_f32_16x16x32_bf16 v[72:75], v[200:203], a[160:163], v[72:75]
    v_mfma_f32_16x16x32_bf16 v[76:79], v[200:203], a[184:187], v[76:79]
    v_mfma_f32_16x16x32_bf16 v[16:19], v[180:183], a[20:23], v[16:19]
    v_mfma_f32_16x16x32_bf16 v[20:23], v[180:183], a[44:47], v[20:23]
    v_mfma_f32_16x16x32_bf16 v[24:27], v[180:183], a[68:71], v[24:27]
    v_mfma_f32_16x16x32_bf16 v[28:31], v[180:183], a[92:95], v[28:31]
    v_mfma_f32_16x16x32_bf16 v[32:35], v[180:183], a[116:119], v[32:35]
    v_mfma_f32_16x16x32_bf16 v[36:39], v[180:183], a[140:143], v[36:39]
    v_mfma_f32_16x16x32_bf16 v[40:43], v[180:183], a[164:167], v[40:43]
    v_mfma_f32_16x16x32_bf16 v[44:47], v[180:183], a[188:191], v[44:47]
    v_mfma_f32_16x16x32_bf16 v[48:51], v[204:207], a[20:23], v[48:51]
    v_mfma_f32_16x16x32_bf16 v[52:55], v[204:207], a[44:47], v[52:55]
    v_mfma_f32_16x16x32_bf16 v[56:59], v[204:207], a[68:71], v[56:59]
    v_mfma_f32_16x16x32_bf16 v[60:63], v[204:207], a[92:95], v[60:63]
    v_mfma_f32_16x16x32_bf16 v[64:67], v[204:207], a[116:119], v[64:67]
    v_mfma_f32_16x16x32_bf16 v[68:71], v[204:207], a[140:143], v[68:71]
    v_mfma_f32_16x16x32_bf16 v[72:75], v[204:207], a[164:167], v[72:75]
    v_mfma_f32_16x16x32_bf16 v[76:79], v[204:207], a[188:191], v[76:79]
    v_cvt_pk_bf16_f32 v208, v16, v17
    v_cvt_pk_bf16_f32 v209, v18, v19
    v_cvt_pk_bf16_f32 v210, v48, v49
    v_cvt_pk_bf16_f32 v211, v50, v51
    s_add_u32 s45, s52, 40960
    buffer_store_dwordx4 v[208:211], v10, s[8:11], s45 offen sc1
    v_cvt_pk_bf16_f32 v212, v20, v21
    v_cvt_pk_bf16_f32 v213, v22, v23
    v_cvt_pk_bf16_f32 v214, v52, v53
    v_cvt_pk_bf16_f32 v215, v54, v55
    s_add_u32 s45, s52, 41984
    buffer_store_dwordx4 v[212:215], v10, s[8:11], s45 offen sc1
    v_cvt_pk_bf16_f32 v216, v24, v25
    v_cvt_pk_bf16_f32 v217, v26, v27
    v_cvt_pk_bf16_f32 v218, v56, v57
    v_cvt_pk_bf16_f32 v219, v58, v59
    s_add_u32 s45, s52, 43008
    buffer_store_dwordx4 v[216:219], v10, s[8:11], s45 offen sc1
    v_cvt_pk_bf16_f32 v220, v28, v29
    v_cvt_pk_bf16_f32 v221, v30, v31
    v_cvt_pk_bf16_f32 v222, v60, v61
    v_cvt_pk_bf16_f32 v223, v62, v63
    s_add_u32 s45, s52, 44032
    buffer_store_dwordx4 v[220:223], v10, s[8:11], s45 offen sc1
    v_cvt_pk_bf16_f32 v224, v32, v33
    v_cvt_pk_bf16_f32 v225, v34, v35
    v_cvt_pk_bf16_f32 v226, v64, v65
    v_cvt_pk_bf16_f32 v227, v66, v67
    s_add_u32 s45, s52, 45056
    buffer_store_dwordx4 v[224:227], v10, s[8:11], s45 offen sc1
    v_cvt_pk_bf16_f32 v228, v36, v37
    v_cvt_pk_bf16_f32 v229, v38, v39
    v_cvt_pk_bf16_f32 v230, v68, v69
    v_cvt_pk_bf16_f32 v231, v70, v71
    s_add_u32 s45, s52, 46080
    buffer_store_dwordx4 v[228:231], v10, s[8:11], s45 offen sc1
    v_cvt_pk_bf16_f32 v232, v40, v41
    v_cvt_pk_bf16_f32 v233, v42, v43
    v_cvt_pk_bf16_f32 v234, v72, v73
    v_cvt_pk_bf16_f32 v235, v74, v75
    s_add_u32 s45, s52, 47104
    buffer_store_dwordx4 v[232:235], v10, s[8:11], s45 offen sc1
    v_cvt_pk_bf16_f32 v236, v44, v45
    v_cvt_pk_bf16_f32 v237, v46, v47
    v_cvt_pk_bf16_f32 v238, v76, v77
    v_cvt_pk_bf16_f32 v239, v78, v79
    s_add_u32 s45, s52, 48128
    buffer_store_dwordx4 v[236:239], v10, s[8:11], s45 offen sc1
    s_add_u32 s45, s51, 1179648
    buffer_load_dwordx4 v[160:163], v9, s[16:19], s45 offen offset:0
    buffer_load_dwordx4 v[164:167], v9, s[16:19], s45 offen offset:64
    buffer_load_dwordx4 v[168:171], v9, s[16:19], s45 offen offset:128
    buffer_load_dwordx4 v[172:175], v9, s[16:19], s45 offen offset:192
    buffer_load_dwordx4 v[176:179], v9, s[16:19], s45 offen offset:256
    buffer_load_dwordx4 v[180:183], v9, s[16:19], s45 offen offset:320
    s_add_u32 s45, s51, 1228800
    buffer_load_dwordx4 v[184:187], v9, s[16:19], s45 offen offset:0
    buffer_load_dwordx4 v[188:191], v9, s[16:19], s45 offen offset:64
    buffer_load_dwordx4 v[192:195], v9, s[16:19], s45 offen offset:128
    buffer_load_dwordx4 v[196:199], v9, s[16:19], s45 offen offset:192
    buffer_load_dwordx4 v[200:203], v9, s[16:19], s45 offen offset:256
    buffer_load_dwordx4 v[204:207], v9, s[16:19], s45 offen offset:320
    s_waitcnt vmcnt(20)
    v_mfma_f32_16x16x32_bf16 v[16:19], v[112:115], a[0:3], 0
    v_mfma_f32_16x16x32_bf16 v[20:23], v[112:115], a[24:27], 0
    v_mfma_f32_16x16x32_bf16 v[24:27], v[112:115], a[48:51], 0
    v_mfma_f32_16x16x32_bf16 v[28:31], v[112:115], a[72:75], 0
    v_mfma_f32_16x16x32_bf16 v[32:35], v[112:115], a[96:99], 0
    v_mfma_f32_16x16x32_bf16 v[36:39], v[112:115], a[120:123], 0
    v_mfma_f32_16x16x32_bf16 v[40:43], v[112:115], a[144:147], 0
    v_mfma_f32_16x16x32_bf16 v[44:47], v[112:115], a[168:171], 0
    v_mfma_f32_16x16x32_bf16 v[48:51], v[136:139], a[0:3], 0
    v_mfma_f32_16x16x32_bf16 v[52:55], v[136:139], a[24:27], 0
    v_mfma_f32_16x16x32_bf16 v[56:59], v[136:139], a[48:51], 0
    v_mfma_f32_16x16x32_bf16 v[60:63], v[136:139], a[72:75], 0
    v_mfma_f32_16x16x32_bf16 v[64:67], v[136:139], a[96:99], 0
    v_mfma_f32_16x16x32_bf16 v[68:71], v[136:139], a[120:123], 0
    v_mfma_f32_16x16x32_bf16 v[72:75], v[136:139], a[144:147], 0
    v_mfma_f32_16x16x32_bf16 v[76:79], v[136:139], a[168:171], 0
    v_mfma_f32_16x16x32_bf16 v[16:19], v[116:119], a[4:7], v[16:19]
    v_mfma_f32_16x16x32_bf16 v[20:23], v[116:119], a[28:31], v[20:23]
    v_mfma_f32_16x16x32_bf16 v[24:27], v[116:119], a[52:55], v[24:27]
    v_mfma_f32_16x16x32_bf16 v[28:31], v[116:119], a[76:79], v[28:31]
    v_mfma_f32_16x16x32_bf16 v[32:35], v[116:119], a[100:103], v[32:35]
    v_mfma_f32_16x16x32_bf16 v[36:39], v[116:119], a[124:127], v[36:39]
    v_mfma_f32_16x16x32_bf16 v[40:43], v[116:119], a[148:151], v[40:43]
    v_mfma_f32_16x16x32_bf16 v[44:47], v[116:119], a[172:175], v[44:47]
    v_mfma_f32_16x16x32_bf16 v[48:51], v[140:143], a[4:7], v[48:51]
    v_mfma_f32_16x16x32_bf16 v[52:55], v[140:143], a[28:31], v[52:55]
    v_mfma_f32_16x16x32_bf16 v[56:59], v[140:143], a[52:55], v[56:59]
    v_mfma_f32_16x16x32_bf16 v[60:63], v[140:143], a[76:79], v[60:63]
    v_mfma_f32_16x16x32_bf16 v[64:67], v[140:143], a[100:103], v[64:67]
    v_mfma_f32_16x16x32_bf16 v[68:71], v[140:143], a[124:127], v[68:71]
    v_mfma_f32_16x16x32_bf16 v[72:75], v[140:143], a[148:151], v[72:75]
    v_mfma_f32_16x16x32_bf16 v[76:79], v[140:143], a[172:175], v[76:79]
    v_mfma_f32_16x16x32_bf16 v[16:19], v[120:123], a[8:11], v[16:19]
    v_mfma_f32_16x16x32_bf16 v[20:23], v[120:123], a[32:35], v[20:23]
    v_mfma_f32_16x16x32_bf16 v[24:27], v[120:123], a[56:59], v[24:27]
    v_mfma_f32_16x16x32_bf16 v[28:31], v[120:123], a[80:83], v[28:31]
    v_mfma_f32_16x16x32_bf16 v[32:35], v[120:123], a[104:107], v[32:35]
    v_mfma_f32_16x16x32_bf16 v[36:39], v[120:123], a[128:131], v[36:39]
    v_mfma_f32_16x16x32_bf16 v[40:43], v[120:123], a[152:155], v[40:43]
    v_mfma_f32_16x16x32_bf16 v[44:47], v[120:123], a[176:179], v[44:47]
    v_mfma_f32_16x16x32_bf16 v[48:51], v[144:147], a[8:11], v[48:51]
    v_mfma_f32_16x16x32_bf16 v[52:55], v[144:147], a[32:35], v[52:55]
    v_mfma_f32_16x16x32_bf16 v[56:59], v[144:147], a[56:59], v[56:59]
    v_mfma_f32_16x16x32_bf16 v[60:63], v[144:147], a[80:83], v[60:63]
    v_mfma_f32_16x16x32_bf16 v[64:67], v[144:147], a[104:107], v[64:67]
    v_mfma_f32_16x16x32_bf16 v[68:71], v[144:147], a[128:131], v[68:71]
    v_mfma_f32_16x16x32_bf16 v[72:75], v[144:147], a[152:155], v[72:75]
    v_mfma_f32_16x16x32_bf16 v[76:79], v[144:147], a[176:179], v[76:79]
    v_mfma_f32_16x16x32_bf16 v[16:19], v[124:127], a[12:15], v[16:19]
    v_mfma_f32_16x16x32_bf16 v[20:23], v[124:127], a[36:39], v[20:23]
    v_mfma_f32_16x16x32_bf16 v[24:27], v[124:127], a[60:63], v[24:27]
    v_mfma_f32_16x16x32_bf16 v[28:31], v[124:127], a[84:87], v[28:31]
    v_mfma_f32_16x16x32_bf16 v[32:35], v[124:127], a[108:111], v[32:35]
    v_mfma_f32_16x16x32_bf16 v[36:39], v[124:127], a[132:135], v[36:39]
    v_mfma_f32_16x16x32_bf16 v[40:43], v[124:127], a[156:159], v[40:43]
    v_mfma_f32_16x16x32_bf16 v[44:47], v[124:127], a[180:183], v[44:47]
    v_mfma_f32_16x16x32_bf16 v[48:51], v[148:151], a[12:15], v[48:51]
    v_mfma_f32_16x16x32_bf16 v[52:55], v[148:151], a[36:39], v[52:55]
    v_mfma_f32_16x16x32_bf16 v[56:59], v[148:151], a[60:63], v[56:59]
    v_mfma_f32_16x16x32_bf16 v[60:63], v[148:151], a[84:87], v[60:63]
    v_mfma_f32_16x16x32_bf16 v[64:67], v[148:151], a[108:111], v[64:67]
    v_mfma_f32_16x16x32_bf16 v[68:71], v[148:151], a[132:135], v[68:71]
    v_mfma_f32_16x16x32_bf16 v[72:75], v[148:151], a[156:159], v[72:75]
    v_mfma_f32_16x16x32_bf16 v[76:79], v[148:151], a[180:183], v[76:79]
    v_mfma_f32_16x16x32_bf16 v[16:19], v[128:131], a[16:19], v[16:19]
    v_mfma_f32_16x16x32_bf16 v[20:23], v[128:131], a[40:43], v[20:23]
    v_mfma_f32_16x16x32_bf16 v[24:27], v[128:131], a[64:67], v[24:27]
    v_mfma_f32_16x16x32_bf16 v[28:31], v[128:131], a[88:91], v[28:31]
    v_mfma_f32_16x16x32_bf16 v[32:35], v[128:131], a[112:115], v[32:35]
    v_mfma_f32_16x16x32_bf16 v[36:39], v[128:131], a[136:139], v[36:39]
    v_mfma_f32_16x16x32_bf16 v[40:43], v[128:131], a[160:163], v[40:43]
    v_mfma_f32_16x16x32_bf16 v[44:47], v[128:131], a[184:187], v[44:47]
    v_mfma_f32_16x16x32_bf16 v[48:51], v[152:155], a[16:19], v[48:51]
    v_mfma_f32_16x16x32_bf16 v[52:55], v[152:155], a[40:43], v[52:55]
    v_mfma_f32_16x16x32_bf16 v[56:59], v[152:155], a[64:67], v[56:59]
    v_mfma_f32_16x16x32_bf16 v[60:63], v[152:155], a[88:91], v[60:63]
    v_mfma_f32_16x16x32_bf16 v[64:67], v[152:155], a[112:115], v[64:67]
    v_mfma_f32_16x16x32_bf16 v[68:71], v[152:155], a[136:139], v[68:71]
    v_mfma_f32_16x16x32_bf16 v[72:75], v[152:155], a[160:163], v[72:75]
    v_mfma_f32_16x16x32_bf16 v[76:79], v[152:155], a[184:187], v[76:79]
    v_mfma_f32_16x16x32_bf16 v[16:19], v[132:135], a[20:23], v[16:19]
    v_mfma_f32_16x16x32_bf16 v[20:23], v[132:135], a[44:47], v[20:23]
    v_mfma_f32_16x16x32_bf16 v[24:27], v[132:135], a[68:71], v[24:27]
    v_mfma_f32_16x16x32_bf16 v[28:31], v[132:135], a[92:95], v[28:31]
    v_mfma_f32_16x16x32_bf16 v[32:35], v[132:135], a[116:119], v[32:35]
    v_mfma_f32_16x16x32_bf16 v[36:39], v[132:135], a[140:143], v[36:39]
    v_mfma_f32_16x16x32_bf16 v[40:43], v[132:135], a[164:167], v[40:43]
    v_mfma_f32_16x16x32_bf16 v[44:47], v[132:135], a[188:191], v[44:47]
    v_mfma_f32_16x16x32_bf16 v[48:51], v[156:159], a[20:23], v[48:51]
    v_mfma_f32_16x16x32_bf16 v[52:55], v[156:159], a[44:47], v[52:55]
    v_mfma_f32_16x16x32_bf16 v[56:59], v[156:159], a[68:71], v[56:59]
    v_mfma_f32_16x16x32_bf16 v[60:63], v[156:159], a[92:95], v[60:63]
    v_mfma_f32_16x16x32_bf16 v[64:67], v[156:159], a[116:119], v[64:67]
    v_mfma_f32_16x16x32_bf16 v[68:71], v[156:159], a[140:143], v[68:71]
    v_mfma_f32_16x16x32_bf16 v[72:75], v[156:159], a[164:167], v[72:75]
    v_mfma_f32_16x16x32_bf16 v[76:79], v[156:159], a[188:191], v[76:79]
    v_cvt_pk_bf16_f32 v208, v16, v17
    v_cvt_pk_bf16_f32 v209, v18, v19
    v_cvt_pk_bf16_f32 v210, v48, v49
    v_cvt_pk_bf16_f32 v211, v50, v51
    s_add_u32 s45, s52, 81920
    buffer_store_dwordx4 v[208:211], v10, s[8:11], s45 offen sc1
    v_cvt_pk_bf16_f32 v212, v20, v21
    v_cvt_pk_bf16_f32 v213, v22, v23
    v_cvt_pk_bf16_f32 v214, v52, v53
    v_cvt_pk_bf16_f32 v215, v54, v55
    s_add_u32 s45, s52, 82944
    buffer_store_dwordx4 v[212:215], v10, s[8:11], s45 offen sc1
    v_cvt_pk_bf16_f32 v216, v24, v25
    v_cvt_pk_bf16_f32 v217, v26, v27
    v_cvt_pk_bf16_f32 v218, v56, v57
    v_cvt_pk_bf16_f32 v219, v58, v59
    s_add_u32 s45, s52, 83968
    buffer_store_dwordx4 v[216:219], v10, s[8:11], s45 offen sc1
    v_cvt_pk_bf16_f32 v220, v28, v29
    v_cvt_pk_bf16_f32 v221, v30, v31
    v_cvt_pk_bf16_f32 v222, v60, v61
    v_cvt_pk_bf16_f32 v223, v62, v63
    s_add_u32 s45, s52, 84992
    buffer_store_dwordx4 v[220:223], v10, s[8:11], s45 offen sc1
    v_cvt_pk_bf16_f32 v224, v32, v33
    v_cvt_pk_bf16_f32 v225, v34, v35
    v_cvt_pk_bf16_f32 v226, v64, v65
    v_cvt_pk_bf16_f32 v227, v66, v67
    s_add_u32 s45, s52, 86016
    buffer_store_dwordx4 v[224:227], v10, s[8:11], s45 offen sc1
    v_cvt_pk_bf16_f32 v228, v36, v37
    v_cvt_pk_bf16_f32 v229, v38, v39
    v_cvt_pk_bf16_f32 v230, v68, v69
    v_cvt_pk_bf16_f32 v231, v70, v71
    s_add_u32 s45, s52, 87040
    buffer_store_dwordx4 v[228:231], v10, s[8:11], s45 offen sc1
    v_cvt_pk_bf16_f32 v232, v40, v41
    v_cvt_pk_bf16_f32 v233, v42, v43
    v_cvt_pk_bf16_f32 v234, v72, v73
    v_cvt_pk_bf16_f32 v235, v74, v75
    s_add_u32 s45, s52, 88064
    buffer_store_dwordx4 v[232:235], v10, s[8:11], s45 offen sc1
    v_cvt_pk_bf16_f32 v236, v44, v45
    v_cvt_pk_bf16_f32 v237, v46, v47
    v_cvt_pk_bf16_f32 v238, v76, v77
    v_cvt_pk_bf16_f32 v239, v78, v79
    s_add_u32 s45, s52, 89088
    buffer_store_dwordx4 v[236:239], v10, s[8:11], s45 offen sc1
    s_add_u32 s45, s51, 1572864
    buffer_load_dwordx4 v[112:115], v9, s[16:19], s45 offen offset:0
    buffer_load_dwordx4 v[116:119], v9, s[16:19], s45 offen offset:64
    buffer_load_dwordx4 v[120:123], v9, s[16:19], s45 offen offset:128
    buffer_load_dwordx4 v[124:127], v9, s[16:19], s45 offen offset:192
    buffer_load_dwordx4 v[128:131], v9, s[16:19], s45 offen offset:256
    buffer_load_dwordx4 v[132:135], v9, s[16:19], s45 offen offset:320
    s_add_u32 s45, s51, 1622016
    buffer_load_dwordx4 v[136:139], v9, s[16:19], s45 offen offset:0
    buffer_load_dwordx4 v[140:143], v9, s[16:19], s45 offen offset:64
    buffer_load_dwordx4 v[144:147], v9, s[16:19], s45 offen offset:128
    buffer_load_dwordx4 v[148:151], v9, s[16:19], s45 offen offset:192
    buffer_load_dwordx4 v[152:155], v9, s[16:19], s45 offen offset:256
    buffer_load_dwordx4 v[156:159], v9, s[16:19], s45 offen offset:320
    s_waitcnt vmcnt(20)
    v_mfma_f32_16x16x32_bf16 v[16:19], v[160:163], a[0:3], 0
    v_mfma_f32_16x16x32_bf16 v[20:23], v[160:163], a[24:27], 0
    v_mfma_f32_16x16x32_bf16 v[24:27], v[160:163], a[48:51], 0
    v_mfma_f32_16x16x32_bf16 v[28:31], v[160:163], a[72:75], 0
    v_mfma_f32_16x16x32_bf16 v[32:35], v[160:163], a[96:99], 0
    v_mfma_f32_16x16x32_bf16 v[36:39], v[160:163], a[120:123], 0
    v_mfma_f32_16x16x32_bf16 v[40:43], v[160:163], a[144:147], 0
    v_mfma_f32_16x16x32_bf16 v[44:47], v[160:163], a[168:171], 0
    v_mfma_f32_16x16x32_bf16 v[48:51], v[184:187], a[0:3], 0
    v_mfma_f32_16x16x32_bf16 v[52:55], v[184:187], a[24:27], 0
    v_mfma_f32_16x16x32_bf16 v[56:59], v[184:187], a[48:51], 0
    v_mfma_f32_16x16x32_bf16 v[60:63], v[184:187], a[72:75], 0
    v_mfma_f32_16x16x32_bf16 v[64:67], v[184:187], a[96:99], 0
    v_mfma_f32_16x16x32_bf16 v[68:71], v[184:187], a[120:123], 0
    v_mfma_f32_16x16x32_bf16 v[72:75], v[184:187], a[144:147], 0
    v_mfma_f32_16x16x32_bf16 v[76:79], v[184:187], a[168:171], 0
    v_mfma_f32_16x16x32_bf16 v[16:19], v[164:167], a[4:7], v[16:19]
    v_mfma_f32_16x16x32_bf16 v[20:23], v[164:167], a[28:31], v[20:23]
    v_mfma_f32_16x16x32_bf16 v[24:27], v[164:167], a[52:55], v[24:27]
    v_mfma_f32_16x16x32_bf16 v[28:31], v[164:167], a[76:79], v[28:31]
    v_mfma_f32_16x16x32_bf16 v[32:35], v[164:167], a[100:103], v[32:35]
    v_mfma_f32_16x16x32_bf16 v[36:39], v[164:167], a[124:127], v[36:39]
    v_mfma_f32_16x16x32_bf16 v[40:43], v[164:167], a[148:151], v[40:43]
    v_mfma_f32_16x16x32_bf16 v[44:47], v[164:167], a[172:175], v[44:47]
    v_mfma_f32_16x16x32_bf16 v[48:51], v[188:191], a[4:7], v[48:51]
    v_mfma_f32_16x16x32_bf16 v[52:55], v[188:191], a[28:31], v[52:55]
    v_mfma_f32_16x16x32_bf16 v[56:59], v[188:191], a[52:55], v[56:59]
    v_mfma_f32_16x16x32_bf16 v[60:63], v[188:191], a[76:79], v[60:63]
    v_mfma_f32_16x16x32_bf16 v[64:67], v[188:191], a[100:103], v[64:67]
    v_mfma_f32_16x16x32_bf16 v[68:71], v[188:191], a[124:127], v[68:71]
    v_mfma_f32_16x16x32_bf16 v[72:75], v[188:191], a[148:151], v[72:75]
    v_mfma_f32_16x16x32_bf16 v[76:79], v[188:191], a[172:175], v[76:79]
    v_mfma_f32_16x16x32_bf16 v[16:19], v[168:171], a[8:11], v[16:19]
    v_mfma_f32_16x16x32_bf16 v[20:23], v[168:171], a[32:35], v[20:23]
    v_mfma_f32_16x16x32_bf16 v[24:27], v[168:171], a[56:59], v[24:27]
    v_mfma_f32_16x16x32_bf16 v[28:31], v[168:171], a[80:83], v[28:31]
    v_mfma_f32_16x16x32_bf16 v[32:35], v[168:171], a[104:107], v[32:35]
    v_mfma_f32_16x16x32_bf16 v[36:39], v[168:171], a[128:131], v[36:39]
    v_mfma_f32_16x16x32_bf16 v[40:43], v[168:171], a[152:155], v[40:43]
    v_mfma_f32_16x16x32_bf16 v[44:47], v[168:171], a[176:179], v[44:47]
    v_mfma_f32_16x16x32_bf16 v[48:51], v[192:195], a[8:11], v[48:51]
    v_mfma_f32_16x16x32_bf16 v[52:55], v[192:195], a[32:35], v[52:55]
    v_mfma_f32_16x16x32_bf16 v[56:59], v[192:195], a[56:59], v[56:59]
    v_mfma_f32_16x16x32_bf16 v[60:63], v[192:195], a[80:83], v[60:63]
    v_mfma_f32_16x16x32_bf16 v[64:67], v[192:195], a[104:107], v[64:67]
    v_mfma_f32_16x16x32_bf16 v[68:71], v[192:195], a[128:131], v[68:71]
    v_mfma_f32_16x16x32_bf16 v[72:75], v[192:195], a[152:155], v[72:75]
    v_mfma_f32_16x16x32_bf16 v[76:79], v[192:195], a[176:179], v[76:79]
    v_mfma_f32_16x16x32_bf16 v[16:19], v[172:175], a[12:15], v[16:19]
    v_mfma_f32_16x16x32_bf16 v[20:23], v[172:175], a[36:39], v[20:23]
    v_mfma_f32_16x16x32_bf16 v[24:27], v[172:175], a[60:63], v[24:27]
    v_mfma_f32_16x16x32_bf16 v[28:31], v[172:175], a[84:87], v[28:31]
    v_mfma_f32_16x16x32_bf16 v[32:35], v[172:175], a[108:111], v[32:35]
    v_mfma_f32_16x16x32_bf16 v[36:39], v[172:175], a[132:135], v[36:39]
    v_mfma_f32_16x16x32_bf16 v[40:43], v[172:175], a[156:159], v[40:43]
    v_mfma_f32_16x16x32_bf16 v[44:47], v[172:175], a[180:183], v[44:47]
    v_mfma_f32_16x16x32_bf16 v[48:51], v[196:199], a[12:15], v[48:51]
    v_mfma_f32_16x16x32_bf16 v[52:55], v[196:199], a[36:39], v[52:55]
    v_mfma_f32_16x16x32_bf16 v[56:59], v[196:199], a[60:63], v[56:59]
    v_mfma_f32_16x16x32_bf16 v[60:63], v[196:199], a[84:87], v[60:63]
    v_mfma_f32_16x16x32_bf16 v[64:67], v[196:199], a[108:111], v[64:67]
    v_mfma_f32_16x16x32_bf16 v[68:71], v[196:199], a[132:135], v[68:71]
    v_mfma_f32_16x16x32_bf16 v[72:75], v[196:199], a[156:159], v[72:75]
    v_mfma_f32_16x16x32_bf16 v[76:79], v[196:199], a[180:183], v[76:79]
    v_mfma_f32_16x16x32_bf16 v[16:19], v[176:179], a[16:19], v[16:19]
    v_mfma_f32_16x16x32_bf16 v[20:23], v[176:179], a[40:43], v[20:23]
    v_mfma_f32_16x16x32_bf16 v[24:27], v[176:179], a[64:67], v[24:27]
    v_mfma_f32_16x16x32_bf16 v[28:31], v[176:179], a[88:91], v[28:31]
    v_mfma_f32_16x16x32_bf16 v[32:35], v[176:179], a[112:115], v[32:35]
    v_mfma_f32_16x16x32_bf16 v[36:39], v[176:179], a[136:139], v[36:39]
    v_mfma_f32_16x16x32_bf16 v[40:43], v[176:179], a[160:163], v[40:43]
    v_mfma_f32_16x16x32_bf16 v[44:47], v[176:179], a[184:187], v[44:47]
    v_mfma_f32_16x16x32_bf16 v[48:51], v[200:203], a[16:19], v[48:51]
    v_mfma_f32_16x16x32_bf16 v[52:55], v[200:203], a[40:43], v[52:55]
    v_mfma_f32_16x16x32_bf16 v[56:59], v[200:203], a[64:67], v[56:59]
    v_mfma_f32_16x16x32_bf16 v[60:63], v[200:203], a[88:91], v[60:63]
    v_mfma_f32_16x16x32_bf16 v[64:67], v[200:203], a[112:115], v[64:67]
    v_mfma_f32_16x16x32_bf16 v[68:71], v[200:203], a[136:139], v[68:71]
    v_mfma_f32_16x16x32_bf16 v[72:75], v[200:203], a[160:163], v[72:75]
    v_mfma_f32_16x16x32_bf16 v[76:79], v[200:203], a[184:187], v[76:79]
    v_mfma_f32_16x16x32_bf16 v[16:19], v[180:183], a[20:23], v[16:19]
    v_mfma_f32_16x16x32_bf16 v[20:23], v[180:183], a[44:47], v[20:23]
    v_mfma_f32_16x16x32_bf16 v[24:27], v[180:183], a[68:71], v[24:27]
    v_mfma_f32_16x16x32_bf16 v[28:31], v[180:183], a[92:95], v[28:31]
    v_mfma_f32_16x16x32_bf16 v[32:35], v[180:183], a[116:119], v[32:35]
    v_mfma_f32_16x16x32_bf16 v[36:39], v[180:183], a[140:143], v[36:39]
    v_mfma_f32_16x16x32_bf16 v[40:43], v[180:183], a[164:167], v[40:43]
    v_mfma_f32_16x16x32_bf16 v[44:47], v[180:183], a[188:191], v[44:47]
    v_mfma_f32_16x16x32_bf16 v[48:51], v[204:207], a[20:23], v[48:51]
    v_mfma_f32_16x16x32_bf16 v[52:55], v[204:207], a[44:47], v[52:55]
    v_mfma_f32_16x16x32_bf16 v[56:59], v[204:207], a[68:71], v[56:59]
    v_mfma_f32_16x16x32_bf16 v[60:63], v[204:207], a[92:95], v[60:63]
    v_mfma_f32_16x16x32_bf16 v[64:67], v[204:207], a[116:119], v[64:67]
    v_mfma_f32_16x16x32_bf16 v[68:71], v[204:207], a[140:143], v[68:71]
    v_mfma_f32_16x16x32_bf16 v[72:75], v[204:207], a[164:167], v[72:75]
    v_mfma_f32_16x16x32_bf16 v[76:79], v[204:207], a[188:191], v[76:79]
    v_cvt_pk_bf16_f32 v208, v16, v17
    v_cvt_pk_bf16_f32 v209, v18, v19
    v_cvt_pk_bf16_f32 v210, v48, v49
    v_cvt_pk_bf16_f32 v211, v50, v51
    s_add_u32 s45, s52, 122880
    buffer_store_dwordx4 v[208:211], v10, s[8:11], s45 offen sc1
    v_cvt_pk_bf16_f32 v212, v20, v21
    v_cvt_pk_bf16_f32 v213, v22, v23
    v_cvt_pk_bf16_f32 v214, v52, v53
    v_cvt_pk_bf16_f32 v215, v54, v55
    s_add_u32 s45, s52, 123904
    buffer_store_dwordx4 v[212:215], v10, s[8:11], s45 offen sc1
    v_cvt_pk_bf16_f32 v216, v24, v25
    v_cvt_pk_bf16_f32 v217, v26, v27
    v_cvt_pk_bf16_f32 v218, v56, v57
    v_cvt_pk_bf16_f32 v219, v58, v59
    s_add_u32 s45, s52, 124928
    buffer_store_dwordx4 v[216:219], v10, s[8:11], s45 offen sc1
    v_cvt_pk_bf16_f32 v220, v28, v29
    v_cvt_pk_bf16_f32 v221, v30, v31
    v_cvt_pk_bf16_f32 v222, v60, v61
    v_cvt_pk_bf16_f32 v223, v62, v63
    s_add_u32 s45, s52, 125952
    buffer_store_dwordx4 v[220:223], v10, s[8:11], s45 offen sc1
    v_cvt_pk_bf16_f32 v224, v32, v33
    v_cvt_pk_bf16_f32 v225, v34, v35
    v_cvt_pk_bf16_f32 v226, v64, v65
    v_cvt_pk_bf16_f32 v227, v66, v67
    s_add_u32 s45, s52, 126976
    buffer_store_dwordx4 v[224:227], v10, s[8:11], s45 offen sc1
    v_cvt_pk_bf16_f32 v228, v36, v37
    v_cvt_pk_bf16_f32 v229, v38, v39
    v_cvt_pk_bf16_f32 v230, v68, v69
    v_cvt_pk_bf16_f32 v231, v70, v71
    s_add_u32 s45, s52, 128000
    buffer_store_dwordx4 v[228:231], v10, s[8:11], s45 offen sc1
    v_cvt_pk_bf16_f32 v232, v40, v41
    v_cvt_pk_bf16_f32 v233, v42, v43
    v_cvt_pk_bf16_f32 v234, v72, v73
    v_cvt_pk_bf16_f32 v235, v74, v75
    s_add_u32 s45, s52, 129024
    buffer_store_dwordx4 v[232:235], v10, s[8:11], s45 offen sc1
    v_cvt_pk_bf16_f32 v236, v44, v45
    v_cvt_pk_bf16_f32 v237, v46, v47
    v_cvt_pk_bf16_f32 v238, v76, v77
    v_cvt_pk_bf16_f32 v239, v78, v79
    s_add_u32 s45, s52, 130048
    buffer_store_dwordx4 v[236:239], v10, s[8:11], s45 offen sc1
    s_waitcnt vmcnt(8)
    v_mfma_f32_16x16x32_bf16 v[16:19], v[112:115], a[0:3], 0
    v_mfma_f32_16x16x32_bf16 v[20:23], v[112:115], a[24:27], 0
    v_mfma_f32_16x16x32_bf16 v[24:27], v[112:115], a[48:51], 0
    v_mfma_f32_16x16x32_bf16 v[28:31], v[112:115], a[72:75], 0
    v_mfma_f32_16x16x32_bf16 v[32:35], v[112:115], a[96:99], 0
    v_mfma_f32_16x16x32_bf16 v[36:39], v[112:115], a[120:123], 0
    v_mfma_f32_16x16x32_bf16 v[40:43], v[112:115], a[144:147], 0
    v_mfma_f32_16x16x32_bf16 v[44:47], v[112:115], a[168:171], 0
    v_mfma_f32_16x16x32_bf16 v[48:51], v[136:139], a[0:3], 0
    v_mfma_f32_16x16x32_bf16 v[52:55], v[136:139], a[24:27], 0
    v_mfma_f32_16x16x32_bf16 v[56:59], v[136:139], a[48:51], 0
    v_mfma_f32_16x16x32_bf16 v[60:63], v[136:139], a[72:75], 0
    v_mfma_f32_16x16x32_bf16 v[64:67], v[136:139], a[96:99], 0
    v_mfma_f32_16x16x32_bf16 v[68:71], v[136:139], a[120:123], 0
    v_mfma_f32_16x16x32_bf16 v[72:75], v[136:139], a[144:147], 0
    v_mfma_f32_16x16x32_bf16 v[76:79], v[136:139], a[168:171], 0
    v_mfma_f32_16x16x32_bf16 v[16:19], v[116:119], a[4:7], v[16:19]
    v_mfma_f32_16x16x32_bf16 v[20:23], v[116:119], a[28:31], v[20:23]
    v_mfma_f32_16x16x32_bf16 v[24:27], v[116:119], a[52:55], v[24:27]
    v_mfma_f32_16x16x32_bf16 v[28:31], v[116:119], a[76:79], v[28:31]
    v_mfma_f32_16x16x32_bf16 v[32:35], v[116:119], a[100:103], v[32:35]
    v_mfma_f32_16x16x32_bf16 v[36:39], v[116:119], a[124:127], v[36:39]
    v_mfma_f32_16x16x32_bf16 v[40:43], v[116:119], a[148:151], v[40:43]
    v_mfma_f32_16x16x32_bf16 v[44:47], v[116:119], a[172:175], v[44:47]
    v_mfma_f32_16x16x32_bf16 v[48:51], v[140:143], a[4:7], v[48:51]
    v_mfma_f32_16x16x32_bf16 v[52:55], v[140:143], a[28:31], v[52:55]
    v_mfma_f32_16x16x32_bf16 v[56:59], v[140:143], a[52:55], v[56:59]
    v_mfma_f32_16x16x32_bf16 v[60:63], v[140:143], a[76:79], v[60:63]
    v_mfma_f32_16x16x32_bf16 v[64:67], v[140:143], a[100:103], v[64:67]
    v_mfma_f32_16x16x32_bf16 v[68:71], v[140:143], a[124:127], v[68:71]
    v_mfma_f32_16x16x32_bf16 v[72:75], v[140:143], a[148:151], v[72:75]
    v_mfma_f32_16x16x32_bf16 v[76:79], v[140:143], a[172:175], v[76:79]
    v_mfma_f32_16x16x32_bf16 v[16:19], v[120:123], a[8:11], v[16:19]
    v_mfma_f32_16x16x32_bf16 v[20:23], v[120:123], a[32:35], v[20:23]
    v_mfma_f32_16x16x32_bf16 v[24:27], v[120:123], a[56:59], v[24:27]
    v_mfma_f32_16x16x32_bf16 v[28:31], v[120:123], a[80:83], v[28:31]
    v_mfma_f32_16x16x32_bf16 v[32:35], v[120:123], a[104:107], v[32:35]
    v_mfma_f32_16x16x32_bf16 v[36:39], v[120:123], a[128:131], v[36:39]
    v_mfma_f32_16x16x32_bf16 v[40:43], v[120:123], a[152:155], v[40:43]
    v_mfma_f32_16x16x32_bf16 v[44:47], v[120:123], a[176:179], v[44:47]
    v_mfma_f32_16x16x32_bf16 v[48:51], v[144:147], a[8:11], v[48:51]
    v_mfma_f32_16x16x32_bf16 v[52:55], v[144:147], a[32:35], v[52:55]
    v_mfma_f32_16x16x32_bf16 v[56:59], v[144:147], a[56:59], v[56:59]
    v_mfma_f32_16x16x32_bf16 v[60:63], v[144:147], a[80:83], v[60:63]
    v_mfma_f32_16x16x32_bf16 v[64:67], v[144:147], a[104:107], v[64:67]
    v_mfma_f32_16x16x32_bf16 v[68:71], v[144:147], a[128:131], v[68:71]
    v_mfma_f32_16x16x32_bf16 v[72:75], v[144:147], a[152:155], v[72:75]
    v_mfma_f32_16x16x32_bf16 v[76:79], v[144:147], a[176:179], v[76:79]
    v_mfma_f32_16x16x32_bf16 v[16:19], v[124:127], a[12:15], v[16:19]
    v_mfma_f32_16x16x32_bf16 v[20:23], v[124:127], a[36:39], v[20:23]
    v_mfma_f32_16x16x32_bf16 v[24:27], v[124:127], a[60:63], v[24:27]
    v_mfma_f32_16x16x32_bf16 v[28:31], v[124:127], a[84:87], v[28:31]
    v_mfma_f32_16x16x32_bf16 v[32:35], v[124:127], a[108:111], v[32:35]
    v_mfma_f32_16x16x32_bf16 v[36:39], v[124:127], a[132:135], v[36:39]
    v_mfma_f32_16x16x32_bf16 v[40:43], v[124:127], a[156:159], v[40:43]
    v_mfma_f32_16x16x32_bf16 v[44:47], v[124:127], a[180:183], v[44:47]
    v_mfma_f32_16x16x32_bf16 v[48:51], v[148:151], a[12:15], v[48:51]
    v_mfma_f32_16x16x32_bf16 v[52:55], v[148:151], a[36:39], v[52:55]
    v_mfma_f32_16x16x32_bf16 v[56:59], v[148:151], a[60:63], v[56:59]
    v_mfma_f32_16x16x32_bf16 v[60:63], v[148:151], a[84:87], v[60:63]
    v_mfma_f32_16x16x32_bf16 v[64:67], v[148:151], a[108:111], v[64:67]
    v_mfma_f32_16x16x32_bf16 v[68:71], v[148:151], a[132:135], v[68:71]
    v_mfma_f32_16x16x32_bf16 v[72:75], v[148:151], a[156:159], v[72:75]
    v_mfma_f32_16x16x32_bf16 v[76:79], v[148:151], a[180:183], v[76:79]
    v_mfma_f32_16x16x32_bf16 v[16:19], v[128:131], a[16:19], v[16:19]
    v_mfma_f32_16x16x32_bf16 v[20:23], v[128:131], a[40:43], v[20:23]
    v_mfma_f32_16x16x32_bf16 v[24:27], v[128:131], a[64:67], v[24:27]
    v_mfma_f32_16x16x32_bf16 v[28:31], v[128:131], a[88:91], v[28:31]
    v_mfma_f32_16x16x32_bf16 v[32:35], v[128:131], a[112:115], v[32:35]
    v_mfma_f32_16x16x32_bf16 v[36:39], v[128:131], a[136:139], v[36:39]
    v_mfma_f32_16x16x32_bf16 v[40:43], v[128:131], a[160:163], v[40:43]
    v_mfma_f32_16x16x32_bf16 v[44:47], v[128:131], a[184:187], v[44:47]
    v_mfma_f32_16x16x32_bf16 v[48:51], v[152:155], a[16:19], v[48:51]
    v_mfma_f32_16x16x32_bf16 v[52:55], v[152:155], a[40:43], v[52:55]
    v_mfma_f32_16x16x32_bf16 v[56:59], v[152:155], a[64:67], v[56:59]
    v_mfma_f32_16x16x32_bf16 v[60:63], v[152:155], a[88:91], v[60:63]
    v_mfma_f32_16x16x32_bf16 v[64:67], v[152:155], a[112:115], v[64:67]
    v_mfma_f32_16x16x32_bf16 v[68:71], v[152:155], a[136:139], v[68:71]
    v_mfma_f32_16x16x32_bf16 v[72:75], v[152:155], a[160:163], v[72:75]
    v_mfma_f32_16x16x32_bf16 v[76:79], v[152:155], a[184:187], v[76:79]
    v_mfma_f32_16x16x32_bf16 v[16:19], v[132:135], a[20:23], v[16:19]
    v_mfma_f32_16x16x32_bf16 v[20:23], v[132:135], a[44:47], v[20:23]
    v_mfma_f32_16x16x32_bf16 v[24:27], v[132:135], a[68:71], v[24:27]
    v_mfma_f32_16x16x32_bf16 v[28:31], v[132:135], a[92:95], v[28:31]
    v_mfma_f32_16x16x32_bf16 v[32:35], v[132:135], a[116:119], v[32:35]
    v_mfma_f32_16x16x32_bf16 v[36:39], v[132:135], a[140:143], v[36:39]
    v_mfma_f32_16x16x32_bf16 v[40:43], v[132:135], a[164:167], v[40:43]
    v_mfma_f32_16x16x32_bf16 v[44:47], v[132:135], a[188:191], v[44:47]
    v_mfma_f32_16x16x32_bf16 v[48:51], v[156:159], a[20:23], v[48:51]
    v_mfma_f32_16x16x32_bf16 v[52:55], v[156:159], a[44:47], v[52:55]
    v_mfma_f32_16x16x32_bf16 v[56:59], v[156:159], a[68:71], v[56:59]
    v_mfma_f32_16x16x32_bf16 v[60:63], v[156:159], a[92:95], v[60:63]
    v_mfma_f32_16x16x32_bf16 v[64:67], v[156:159], a[116:119], v[64:67]
    v_mfma_f32_16x16x32_bf16 v[68:71], v[156:159], a[140:143], v[68:71]
    v_mfma_f32_16x16x32_bf16 v[72:75], v[156:159], a[164:167], v[72:75]
    v_mfma_f32_16x16x32_bf16 v[76:79], v[156:159], a[188:191], v[76:79]
    v_cvt_pk_bf16_f32 v208, v16, v17
    v_cvt_pk_bf16_f32 v209, v18, v19
    v_cvt_pk_bf16_f32 v210, v48, v49
    v_cvt_pk_bf16_f32 v211, v50, v51
    s_add_u32 s45, s52, 163840
    buffer_store_dwordx4 v[208:211], v10, s[8:11], s45 offen sc1
    v_cvt_pk_bf16_f32 v212, v20, v21
    v_cvt_pk_bf16_f32 v213, v22, v23
    v_cvt_pk_bf16_f32 v214, v52, v53
    v_cvt_pk_bf16_f32 v215, v54, v55
    s_add_u32 s45, s52, 164864
    buffer_store_dwordx4 v[212:215], v10, s[8:11], s45 offen sc1
    v_cvt_pk_bf16_f32 v216, v24, v25
    v_cvt_pk_bf16_f32 v217, v26, v27
    v_cvt_pk_bf16_f32 v218, v56, v57
    v_cvt_pk_bf16_f32 v219, v58, v59
    s_add_u32 s45, s52, 165888
    buffer_store_dwordx4 v[216:219], v10, s[8:11], s45 offen sc1
    v_cvt_pk_bf16_f32 v220, v28, v29
    v_cvt_pk_bf16_f32 v221, v30, v31
    v_cvt_pk_bf16_f32 v222, v60, v61
    v_cvt_pk_bf16_f32 v223, v62, v63
    s_add_u32 s45, s52, 166912
    buffer_store_dwordx4 v[220:223], v10, s[8:11], s45 offen sc1
    v_cvt_pk_bf16_f32 v224, v32, v33
    v_cvt_pk_bf16_f32 v225, v34, v35
    v_cvt_pk_bf16_f32 v226, v64, v65
    v_cvt_pk_bf16_f32 v227, v66, v67
    s_add_u32 s45, s52, 167936
    buffer_store_dwordx4 v[224:227], v10, s[8:11], s45 offen sc1
    v_cvt_pk_bf16_f32 v228, v36, v37
    v_cvt_pk_bf16_f32 v229, v38, v39
    v_cvt_pk_bf16_f32 v230, v68, v69
    v_cvt_pk_bf16_f32 v231, v70, v71
    s_add_u32 s45, s52, 168960
    buffer_store_dwordx4 v[228:231], v10, s[8:11], s45 offen sc1
    v_cvt_pk_bf16_f32 v232, v40, v41
    v_cvt_pk_bf16_f32 v233, v42, v43
    v_cvt_pk_bf16_f32 v234, v72, v73
    v_cvt_pk_bf16_f32 v235, v74, v75
    s_add_u32 s45, s52, 169984
    buffer_store_dwordx4 v[232:235], v10, s[8:11], s45 offen sc1
    v_cvt_pk_bf16_f32 v236, v44, v45
    v_cvt_pk_bf16_f32 v237, v46, v47
    v_cvt_pk_bf16_f32 v238, v76, v77
    v_cvt_pk_bf16_f32 v239, v78, v79
    s_add_u32 s45, s52, 171008
    buffer_store_dwordx4 v[236:239], v10, s[8:11], s45 offen sc1
    s_waitcnt vmcnt(0)
    s_barrier
    s_cmp_lg_u32 s33, 0
    s_cbranch_scc1 FF_36
    s_lshl_b32 s45, s49, 7
    s_lshl_b32 s46, s48, 2
    s_add_u32 s45, s45, s46
    s_add_u32 s45, s45, 0
    v_mov_b32 v1, 1
    v_mov_b32 v2, s45
    s_mov_b64 exec, 1
    buffer_store_dword v1, v2, s[8:11], 0 offen sc1
    s_mov_b64 exec, -1
FF_36:
    s_lshr_b32 s50, s32, 4
    s_cmp_lg_u32 s33, 0
    s_cbranch_scc1 FW_37
    v_mov_b32 v2, 4
    s_movk_i32 s45, 254
PL_38:
    buffer_load_dword v1, v2, s[28:31], 0 offen sc1
    s_waitcnt vmcnt(0)
    v_cmp_gt_u32 vcc, s45, v1
    s_cbranch_vccz PD_39
    s_sub_u32 s35, s35, 1
    s_cbranch_scc1 TO_40
    s_branch PL_38
PD_39:
    v_and_b32 v2, 31, v0
    v_lshlrev_b32 v2, 2, v2
    s_lshl_b32 s45, s50, 7
    s_add_u32 s45, s45, 0
    s_mov_b32 s46, 1
PL_41:
    buffer_load_dword v1, v2, s[8:11], s45 offen sc1
    s_waitcnt vmcnt(0)
    v_cmp_gt_u32 vcc, s46, v1
    s_cbranch_vccz PD_42
    s_sub_u32 s35, s35, 1
    s_cbranch_scc1 TO_43
    s_branch PL_41
PD_42:
FW_37:
    s_barrier
    v_and_b32 v16, 7, v0
    v_lshrrev_b32 v17, 1, v16
    v_and_b32 v16, 1, v16
    v_lshl_add_u32 v16, v17, 2, v16
    v_add_u32 v16, s59, v16
    v_bfe_u32 v17, v0, 3, 1
    v_mul_u32_u24 v17, 12800, v17
    v_add_u32 v16, v16, v17
    v_lshlrev_b32 v16, 6, v16
    v_lshrrev_b32 v17, 4, v0
    v_lshl_add_u32 v16, v17, 4, v16
    s_mul_i32 s50, s33, 6553600
    s_add_u32 s50, s50, 24117248
    v_lshrrev_b32 v1, 4, v0
    v_and_b32 v2, 15, v0
    v_mul_u32_u24 v2, 1280, v2
    v_lshl_add_u32 v4, v1, 4, v2
    s_mul_i32 s45, s33, 320
    v_add_u32 v4, s45, v4
    v_lshlrev_b32 v5, 4, v0
    s_mul_i32 s52, s33, 10240
    s_mul_i32 s45, s34, 40960
    s_and_b32 s46, s34, 1
    s_mul_i32 s46, s46, 40960
    s_add_u32 s46, s46, s52
    s_add_u32 m0, s46, 0
    s_add_u32 s47, s45, 0
    buffer_load_dwordx4 v4, s[12:15], s47 offen lds
    s_add_u32 m0, s46, 1024
    s_add_u32 s47, s45, 20480
    buffer_load_dwordx4 v4, s[12:15], s47 offen lds
    s_add_u32 m0, s46, 2048
    s_add_u32 s47, s45, 64
    buffer_load_dwordx4 v4, s[12:15], s47 offen lds
    s_add_u32 m0, s46, 3072
    s_add_u32 s47, s45, 20544
    buffer_load_dwordx4 v4, s[12:15], s47 offen lds
    s_add_u32 m0, s46, 4096
    s_add_u32 s47, s45, 128
    buffer_load_dwordx4 v4, s[12:15], s47 offen lds
    s_add_u32 m0, s46, 5120
    s_add_u32 s47, s45, 20608
    buffer_load_dwordx4 v4, s[12:15], s47 offen lds
    s_add_u32 m0, s46, 6144
    s_add_u32 s47, s45, 192
    buffer_load_dwordx4 v4, s[12:15], s47 offen lds
    s_add_u32 m0, s46, 7168
    s_add_u32 s47, s45, 20672
    buffer_load_dwordx4 v4, s[12:15], s47 offen lds
    s_add_u32 m0, s46, 8192
    s_add_u32 s47, s45, 256
    buffer_load_dwordx4 v4, s[12:15], s47 offen lds
    s_add_u32 m0, s46, 9216
    s_add_u32 s47, s45, 20736
    buffer_load_dwordx4 v4, s[12:15], s47 offen lds
    s_add_u32 s45, s50, 0
    buffer_load_dwordx4 a[0:3], v16, s[8:11], s45 offen sc1
    s_add_u32 s45, s50, 1638400
    buffer_load_dwordx4 a[80:83], v16, s[8:11], s45 offen sc1
    s_add_u32 s45, s50, 3276800
    buffer_load_dwordx4 a[160:163], v16, s[8:11], s45 offen sc1
    s_add_u32 s45, s50, 4915200
    buffer_load_dwordx4 a[240:243], v16, s[8:11], s45 offen sc1
    s_add_u32 s45, s50, 40960
    buffer_load_dwordx4 a[4:7], v16, s[8:11], s45 offen sc1
    s_add_u32 s45, s50, 1679360
    buffer_load_dwordx4 a[84:87], v16, s[8:11], s45 offen sc1
    s_add_u32 s45, s50, 3317760
    buffer_load_dwordx4 a[164:167], v16, s[8:11], s45 offen sc1
    s_add_u32 s45, s50, 4956160
    buffer_load_dwordx4 a[244:247], v16, s[8:11], s45 offen sc1
    s_add_u32 s45, s50, 81920
    buffer_load_dwordx4 a[8:11], v16, s[8:11], s45 offen sc1
    s_add_u32 s45, s50, 1720320
    buffer_load_dwordx4 a[88:91], v16, s[8:11], s45 offen sc1
    s_add_u32 s45, s50, 3358720
    buffer_load_dwordx4 a[168:171], v16, s[8:11], s45 offen sc1
    s_add_u32 s45, s50, 4997120
    buffer_load_dwordx4 a[248:251], v16, s[8:11], s45 offen sc1
    s_add_u32 s45, s50, 122880
    buffer_load_dwordx4 a[12:15], v16, s[8:11], s45 offen sc1
    s_add_u32 s45, s50, 1761280
    buffer_load_dwordx4 a[92:95], v16, s[8:11], s45 offen sc1
    s_add_u32 s45, s50, 3399680
    buffer_load_dwordx4 a[172:175], v16, s[8:11], s45 offen sc1
    s_add_u32 s45, s50, 5038080
    buffer_load_dwordx4 a[252:255], v16, s[8:11], s45 offen sc1
    s_add_u32 s45, s50, 163840
    buffer_load_dwordx4 a[16:19], v16, s[8:11], s45 offen sc1
    s_add_u32 s45, s50, 1802240
    buffer_load_dwordx4 a[96:99], v16, s[8:11], s45 offen sc1
    s_add_u32 s45, s50, 3440640
    buffer_load_dwordx4 a[176:179], v16, s[8:11], s45 offen sc1
    s_add_u32 s45, s50, 5079040
    buffer_load_dwordx4 v[192:195], v16, s[8:11], s45 offen sc1
    s_add_u32 s45, s50, 204800
    buffer_load_dwordx4 a[20:23], v16, s[8:11], s45 offen sc1
    s_add_u32 s45, s50, 1843200
    buffer_load_dwordx4 a[100:103], v16, s[8:11], s45 offen sc1
    s_add_u32 s45, s50, 3481600
    buffer_load_dwordx4 a[180:183], v16, s[8:11], s45 offen sc1
    s_add_u32 s45, s50, 5120000
    buffer_load_dwordx4 v[196:199], v16, s[8:11], s45 offen sc1
    s_add_u32 s45, s50, 245760
    buffer_load_dwordx4 a[24:27], v16, s[8:11], s45 offen sc1
    s_add_u32 s45, s50, 1884160
    buffer_load_dwordx4 a[104:107], v16, s[8:11], s45 offen sc1
    s_add_u32 s45, s50, 3522560
    buffer_load_dwordx4 a[184:187], v16, s[8:11], s45 offen sc1
    s_add_u32 s45, s50, 5160960
    buffer_load_dwordx4 v[200:203], v16, s[8:11], s45 offen sc1
    s_add_u32 s45, s50, 286720
    buffer_load_dwordx4 a[28:31], v16, s[8:11], s45 offen sc1
    s_add_u32 s45, s50, 1925120
    buffer_load_dwordx4 a[108:111], v16, s[8:11], s45 offen sc1
    s_add_u32 s45, s50, 3563520
    buffer_load_dwordx4 a[188:191], v16, s[8:11], s45 offen sc1
    s_add_u32 s45, s50, 5201920
    buffer_load_dwordx4 v[204:207], v16, s[8:11], s45 offen sc1
    s_add_u32 s45, s50, 327680
    buffer_load_dwordx4 a[32:35], v16, s[8:11], s45 offen sc1
    s_add_u32 s45, s50, 1966080
    buffer_load_dwordx4 a[112:115], v16, s[8:11], s45 offen sc1
    s_add_u32 s45, s50, 3604480
    buffer_load_dwordx4 a[192:195], v16, s[8:11], s45 offen sc1
    s_add_u32 s45, s50, 5242880
    buffer_load_dwordx4 v[208:211], v16, s[8:11], s45 offen sc1
    s_add_u32 s45, s50, 368640
    buffer_load_dwordx4 a[36:39], v16, s[8:11], s45 offen sc1
    s_add_u32 s45, s50, 2007040
    buffer_load_dwordx4 a[116:119], v16, s[8:11], s45 offen sc1
    s_add_u32 s45, s50, 3645440
    buffer_load_dwordx4 a[196:199], v16, s[8:11], s45 offen sc1
    s_add_u32 s45, s50, 5283840
    buffer_load_dwordx4 v[212:215], v16, s[8:11], s45 offen sc1
    s_add_u32 s45, s50, 409600
    buffer_load_dwordx4 a[40:43], v16, s[8:11], s45 offen sc1
    s_add_u32 s45, s50, 2048000
    buffer_load_dwordx4 a[120:123], v16, s[8:11], s45 offen sc1
    s_add_u32 s45, s50, 3686400
    buffer_load_dwordx4 a[200:203], v16, s[8:11], s45 offen sc1
    s_add_u32 s45, s50, 5324800
    buffer_load_dwordx4 v[216:219], v16, s[8:11], s45 offen sc1
    s_add_u32 s45, s50, 450560
    buffer_load_dwordx4 a[44:47], v16, s[8:11], s45 offen sc1
    s_add_u32 s45, s50, 2088960
    buffer_load_dwordx4 a[124:127], v16, s[8:11], s45 offen sc1
    s_add_u32 s45, s50, 3727360
    buffer_load_dwordx4 a[204:207], v16, s[8:11], s45 offen sc1
    s_add_u32 s45, s50, 5365760
    buffer_load_dwordx4 v[220:223], v16, s[8:11], s45 offen sc1
    s_add_u32 s45, s50, 491520
    buffer_load_dwordx4 a[48:51], v16, s[8:11], s45 offen sc1
    s_add_u32 s45, s50, 2129920
    buffer_load_dwordx4 a[128:131], v16, s[8:11], s45 offen sc1
    s_add_u32 s45, s50, 3768320
    buffer_load_dwordx4 a[208:211], v16, s[8:11], s45 offen sc1
    s_add_u32 s45, s50, 5406720
    buffer_load_dwordx4 v[224:227], v16, s[8:11], s45 offen sc1
    s_add_u32 s45, s50, 532480
    buffer_load_dwordx4 a[52:55], v16, s[8:11], s45 offen sc1
    s_add_u32 s45, s50, 2170880
    buffer_load_dwordx4 a[132:135], v16, s[8:11], s45 offen sc1
    s_add_u32 s45, s50, 3809280
    buffer_load_dwordx4 a[212:215], v16, s[8:11], s45 offen sc1
    s_add_u32 s45, s50, 5447680
    buffer_load_dwordx4 v[228:231], v16, s[8:11], s45 offen sc1
    s_add_u32 s45, s50, 573440
    buffer_load_dwordx4 a[56:59], v16, s[8:11], s45 offen sc1
    s_add_u32 s45, s50, 2211840
    buffer_load_dwordx4 a[136:139], v16, s[8:11], s45 offen sc1
    s_add_u32 s45, s50, 3850240
    buffer_load_dwordx4 a[216:219], v16, s[8:11], s45 offen sc1
    s_add_u32 s45, s50, 5488640
    buffer_load_dwordx4 v[232:235], v16, s[8:11], s45 offen sc1
    s_add_u32 s45, s50, 614400
    buffer_load_dwordx4 a[60:63], v16, s[8:11], s45 offen sc1
    s_add_u32 s45, s50, 2252800
    buffer_load_dwordx4 a[140:143], v16, s[8:11], s45 offen sc1
    s_add_u32 s45, s50, 3891200
    buffer_load_dwordx4 a[220:223], v16, s[8:11], s45 offen sc1
    s_add_u32 s45, s50, 5529600
    buffer_load_dwordx4 v[236:239], v16, s[8:11], s45 offen sc1
    s_add_u32 s45, s50, 655360
    buffer_load_dwordx4 a[64:67], v16, s[8:11], s45 offen sc1
    s_add_u32 s45, s50, 2293760
    buffer_load_dwordx4 a[144:147], v16, s[8:11], s45 offen sc1
    s_add_u32 s45, s50, 3932160
    buffer_load_dwordx4 a[224:227], v16, s[8:11], s45 offen sc1
    s_add_u32 s45, s50, 5570560
    buffer_load_dwordx4 v[240:243], v16, s[8:11], s45 offen sc1
    s_add_u32 s45, s50, 696320
    buffer_load_dwordx4 a[68:71], v16, s[8:11], s45 offen sc1
    s_add_u32 s45, s50, 2334720
    buffer_load_dwordx4 a[148:151], v16, s[8:11], s45 offen sc1
    s_add_u32 s45, s50, 3973120
    buffer_load_dwordx4 a[228:231], v16, s[8:11], s45 offen sc1
    s_add_u32 s45, s50, 5611520
    buffer_load_dwordx4 v[244:247], v16, s[8:11], s45 offen sc1
    s_add_u32 s45, s50, 737280
    buffer_load_dwordx4 a[72:75], v16, s[8:11], s45 offen sc1
    s_add_u32 s45, s50, 2375680
    buffer_load_dwordx4 a[152:155], v16, s[8:11], s45 offen sc1
    s_add_u32 s45, s50, 4014080
    buffer_load_dwordx4 a[232:235], v16, s[8:11], s45 offen sc1
    s_add_u32 s45, s50, 5652480
    buffer_load_dwordx4 v[248:251], v16, s[8:11], s45 offen sc1
    s_add_u32 s45, s50, 778240
    buffer_load_dwordx4 a[76:79], v16, s[8:11], s45 offen sc1
    s_add_u32 s45, s50, 2416640
    buffer_load_dwordx4 a[156:159], v16, s[8:11], s45 offen sc1
    s_add_u32 s45, s50, 4055040
    buffer_load_dwordx4 a[236:239], v16, s[8:11], s45 offen sc1
    s_add_u32 s45, s50, 5693440
    buffer_load_dwordx4 v[252:255], v16, s[8:11], s45 offen sc1
    s_lshl_b32 s53, s33, 10
    s_cmp_lt_u32 s33, 2
    s_cselect_b32 s54, 2, 1
    s_lshl_b32 s54, s54, 12
    v_lshlrev_b32 v7, 4, v0
    v_add_u32 v14, 81920, v7
    v_add_u32 v12, s53, v14
    v_add_u32 v13, s54, v12
    s_add_u32 s53, s53, 131072
    v_and_b32 v1, 8, v0
    v_cmp_eq_u32 vcc, 0, v1
    v_mov_b32 v11, 0xeeee
    v_mov_b32 v1, 0x4444
    v_cndmask_b32 v11, v11, v1, vcc
    v_lshrrev_b32 v1, 5, v0
    s_lshl_b32 s45, s33, 1
    v_add_u32 v1, s45, v1
    v_lshlrev_b32 v1, 8, v1
    v_and_b32 v2, 7, v0
    v_lshl_add_u32 v1, v2, 5, v1
    v_bfe_u32 v2, v0, 4, 1
    v_lshl_add_u32 v1, v2, 4, v1
    v_add_u32 v8, 92160, v1
    v_lshrrev_b32 v1, 4, v0
    v_lshlrev_b32 v1, 9, v1
    v_and_b32 v2, 15, v0
    v_lshl_add_u32 v1, v2, 4, v1
    v_add_u32 v9, 92160, v1
    v_bfe_u32 v1, v0, 1, 3
    v_lshlrev_b32 v1, 4, v1
    s_lshl_b32 s45, s32, 7
    v_add_u32 v10, s45, v1
    s_lshl_b32 s55, s33, 12
    s_add_u32 s55, s55, 786432
    s_mov_b32 s66, 0xff00ff
    s_mov_b32 s67, 0xff00ff00
    s_mov_b32 s68, 0x5555
    s_mov_b32 s69, 0x0
    s_waitcnt vmcnt(0)
    s_barrier
R2L_44:
    s_add_u32 s45, s34, 1
    s_and_b32 s64, s45, 1
    s_mul_i32 s64, s64, 40960
    s_add_u32 s64, s64, s52
    s_min_u32 s45, s45, 63
    s_mul_i32 s63, s45, 40960
    s_and_b32 s45, s34, 1
    s_mul_i32 s45, s45, 40960
    v_add_u32 v6, s45, v5
    s_mul_i32 s56, s34, 10240
    s_add_u32 s56, s56, s53
    s_add_u32 s57, s56, 4096
    s_add_u32 s58, s56, s54
    s_mul_i32 s65, s34, 20480
    s_lshl_b32 s45, s33, 10
    s_add_u32 s70, s65, s45
    s_add_u32 s70, s70, 802816
    s_add_u32 s65, s65, s55
    ds_read_b128 v[48:51], v6 offset:0
    ds_read_b128 v[52:55], v6 offset:1024
    ds_read_b128 v[56:59], v6 offset:2048
    ds_read_b128 v[60:63], v6 offset:3072
    s_waitcnt lgkmcnt(2)
    v_mfma_f32_16x16x32_bf16 v[16:19], v[48:51], a[0:3], 0
    ds_read_b128 v[64:67], v6 offset:4096
    v_mfma_f32_16x16x32_bf16 v[32:35], v[52:55], a[0:3], 0
    ds_read_b128 v[68:71], v6 offset:5120
    v_mfma_f32_16x16x32_bf16 v[20:23], v[48:51], a[80:83], 0
    v_mfma_f32_16x16x32_bf16 v[36:39], v[52:55], a[80:83], 0
    s_add_u32 m0, s64, 0
    s_add_u32 s47, s63, 0
    buffer_load_dwordx4 v4, s[12:15], s47 offen lds
    v_mfma_f32_16x16x32_bf16 v[24:27], v[48:51], a[160:163], 0
    v_mfma_f32_16x16x32_bf16 v[40:43], v[52:55], a[160:163], 0
    v_mfma_f32_16x16x32_bf16 v[28:31], v[48:51], a[240:243], 0
    v_mfma_f32_16x16x32_bf16 v[44:47], v[52:55], a[240:243], 0
    s_waitcnt lgkmcnt(2)
    v_mfma_f32_16x16x32_bf16 v[16:19], v[56:59], a[4:7], v[16:19]
    v_mov_b32 v92, 0
    ds_read_b128 v[48:51], v6 offset:6144
    v_mfma_f32_16x16x32_bf16 v[32:35], v[60:63], a[4:7], v[32:35]
    v_mov_b32 v93, 0
    ds_read_b128 v[52:55], v6 offset:7168
    v_mfma_f32_16x16x32_bf16 v[20:23], v[56:59], a[84:87], v[20:23]
    v_mov_b32 v94, 0
    v_mfma_f32_16x16x32_bf16 v[36:39], v[60:63], a[84:87], v[36:39]
    v_mov_b32 v95, 0
    s_add_u32 m0, s64, 1024
    s_add_u32 s47, s63, 20480
    buffer_load_dwordx4 v4, s[12:15], s47 offen lds
    v_mfma_f32_16x16x32_bf16 v[24:27], v[56:59], a[164:167], v[24:27]
    v_mov_b32 v96, 0
    v_mfma_f32_16x16x32_bf16 v[40:43], v[60:63], a[164:167], v[40:43]
    v_mov_b32 v97, 0
    v_mfma_f32_16x16x32_bf16 v[28:31], v[56:59], a[244:247], v[28:31]
    v_mov_b32 v98, 0
    v_mfma_f32_16x16x32_bf16 v[44:47], v[60:63], a[244:247], v[44:47]
    v_mov_b32 v99, 0
    s_waitcnt lgkmcnt(2)
    v_mfma_f32_16x16x32_bf16 v[16:19], v[64:67], a[8:11], v[16:19]
    v_mov_b32 v100, 0
    ds_read_b128 v[56:59], v6 offset:8192
    v_mfma_f32_16x16x32_bf16 v[32:35], v[68:71], a[8:11], v[32:35]
    v_mov_b32 v101, 0
    ds_read_b128 v[60:63], v6 offset:9216
    v_mfma_f32_16x16x32_bf16 v[20:23], v[64:67], a[88:91], v[20:23]
    v_mov_b32 v102, 0
    v_mfma_f32_16x16x32_bf16 v[36:39], v[68:71], a[88:91], v[36:39]
    v_mov_b32 v103, 0
    v_mfma_f32_16x16x32_bf16 v[24:27], v[64:67], a[168:171], v[24:27]
    v_mov_b32 v104, 0
    v_mfma_f32_16x16x32_bf16 v[40:43], v[68:71], a[168:171], v[40:43]
    v_mov_b32 v105, 0
    v_mfma_f32_16x16x32_bf16 v[28:31], v[64:67], a[248:251], v[28:31]
    v_mov_b32 v106, 0
    v_mfma_f32_16x16x32_bf16 v[44:47], v[68:71], a[248:251], v[44:47]
    v_mov_b32 v107, 0
    s_waitcnt lgkmcnt(2)
    v_mfma_f32_16x16x32_bf16 v[16:19], v[48:51], a[12:15], v[16:19]
    ds_read_b128 v[64:67], v6 offset:10240
    v_mfma_f32_16x16x32_bf16 v[32:35], v[52:55], a[12:15], v[32:35]
    ds_read_b128 v[68:71], v6 offset:11264
    v_mfma_f32_16x16x32_bf16 v[20:23], v[48:51], a[92:95], v[20:23]
    v_mfma_f32_16x16x32_bf16 v[36:39], v[52:55], a[92:95], v[36:39]
    s_add_u32 m0, s64, 2048
    s_add_u32 s47, s63, 64
    buffer_load_dwordx4 v4, s[12:15], s47 offen lds
    v_mfma_f32_16x16x32_bf16 v[24:27], v[48:51], a[172:175], v[24:27]
    v_mfma_f32_16x16x32_bf16 v[40:43], v[52:55], a[172:175], v[40:43]
    v_mfma_f32_16x16x32_bf16 v[28:31], v[48:51], a[252:255], v[28:31]
    v_mfma_f32_16x16x32_bf16 v[44:47], v[52:55], a[252:255], v[44:47]
    s_waitcnt lgkmcnt(2)
    v_mfma_f32_16x16x32_bf16 v[16:19], v[56:59], a[16:19], v[16:19]
    ds_read_b128 v[48:51], v6 offset:12288
    v_mfma_f32_16x16x32_bf16 v[32:35], v[60:63], a[16:19], v[32:35]
    ds_read_b128 v[52:55], v6 offset:13312
    v_mfma_f32_16x16x32_bf16 v[20:23], v[56:59], a[96:99], v[20:23]
    v_mfma_f32_16x16x32_bf16 v[36:39], v[60:63], a[96:99], v[36:39]
    s_add_u32 m0, s64, 3072
    s_add_u32 s47, s63, 20544
    buffer_load_dwordx4 v4, s[12:15], s47 offen lds
    v_mfma_f32_16x16x32_bf16 v[24:27], v[56:59], a[176:179], v[24:27]
    v_mfma_f32_16x16x32_bf16 v[40:43], v[60:63], a[176:179], v[40:43]
    v_mfma_f32_16x16x32_bf16 v[28:31], v[56:59], v[192:195], v[28:31]
    v_mfma_f32_16x16x32_bf16 v[44:47], v[60:63], v[192:195], v[44:47]
    s_waitcnt lgkmcnt(2)
    v_mfma_f32_16x16x32_bf16 v[16:19], v[64:67], a[20:23], v[16:19]
    ds_read_b128 v[56:59], v6 offset:14336
    v_mfma_f32_16x16x32_bf16 v[32:35], v[68:71], a[20:23], v[32:35]
    ds_read_b128 v[60:63], v6 offset:15360
    v_mfma_f32_16x16x32_bf16 v[20:23], v[64:67], a[100:103], v[20:23]
    v_mfma_f32_16x16x32_bf16 v[36:39], v[68:71], a[100:103], v[36:39]
    v_mfma_f32_16x16x32_bf16 v[24:27], v[64:67], a[180:183], v[24:27]
    v_mfma_f32_16x16x32_bf16 v[40:43], v[68:71], a[180:183], v[40:43]
    v_mfma_f32_16x16x32_bf16 v[28:31], v[64:67], v[196:199], v[28:31]
    v_mfma_f32_16x16x32_bf16 v[44:47], v[68:71], v[196:199], v[44:47]
    s_waitcnt lgkmcnt(2)
    v_mfma_f32_16x16x32_bf16 v[16:19], v[48:51], a[24:27], v[16:19]
    ds_read_b128 v[64:67], v6 offset:16384
    v_mfma_f32_16x16x32_bf16 v[32:35], v[52:55], a[24:27], v[32:35]
    ds_read_b128 v[68:71], v6 offset:17408
    v_mfma_f32_16x16x32_bf16 v[20:23], v[48:51], a[104:107], v[20:23]
    v_mfma_f32_16x16x32_bf16 v[36:39], v[52:55], a[104:107], v[36:39]
    s_add_u32 m0, s64, 4096
    s_add_u32 s47, s63, 128
    buffer_load_dwordx4 v4, s[12:15], s47 offen lds
    v_mfma_f32_16x16x32_bf16 v[24:27], v[48:51], a[184:187], v[24:27]
    v_mfma_f32_16x16x32_bf16 v[40:43], v[52:55], a[184:187], v[40:43]
    v_mfma_f32_16x16x32_bf16 v[28:31], v[48:51], v[200:203], v[28:31]
    v_mfma_f32_16x16x32_bf16 v[44:47], v[52:55], v[200:203], v[44:47]
    s_waitcnt lgkmcnt(2)
    v_mfma_f32_16x16x32_bf16 v[16:19], v[56:59], a[28:31], v[16:19]
    ds_read_b128 v[48:51], v6 offset:18432
    v_mfma_f32_16x16x32_bf16 v[32:35], v[60:63], a[28:31], v[32:35]
    ds_read_b128 v[52:55], v6 offset:19456
    v_mfma_f32_16x16x32_bf16 v[20:23], v[56:59], a[108:111], v[20:23]
    v_mfma_f32_16x16x32_bf16 v[36:39], v[60:63], a[108:111], v[36:39]
    s_add_u32 m0, s64, 5120
    s_add_u32 s47, s63, 20608
    buffer_load_dwordx4 v4, s[12:15], s47 offen lds
    v_mfma_f32_16x16x32_bf16 v[24:27], v[56:59], a[188:191], v[24:27]
    v_mfma_f32_16x16x32_bf16 v[40:43], v[60:63], a[188:191], v[40:43]
    buffer_load_dwordx4 v[80:83], v7, s[8:11], s56 offen sc1
    v_mfma_f32_16x16x32_bf16 v[28:31], v[56:59], v[204:207], v[28:31]
    v_mfma_f32_16x16x32_bf16 v[44:47], v[60:63], v[204:207], v[44:47]
    s_waitcnt lgkmcnt(2)
    v_mfma_f32_16x16x32_bf16 v[16:19], v[64:67], a[32:35], v[16:19]
    ds_read_b128 v[56:59], v6 offset:20480
    v_mfma_f32_16x16x32_bf16 v[32:35], v[68:71], a[32:35], v[32:35]
    ds_read_b128 v[60:63], v6 offset:21504
    v_mfma_f32_16x16x32_bf16 v[20:23], v[64:67], a[112:115], v[20:23]
    v_mfma_f32_16x16x32_bf16 v[36:39], v[68:71], a[112:115], v[36:39]
    v_mfma_f32_16x16x32_bf16 v[24:27], v[64:67], a[192:195], v[24:27]
    v_mfma_f32_16x16x32_bf16 v[40:43], v[68:71], a[192:195], v[40:43]
    buffer_load_dwordx4 v[84:87], v7, s[8:11], s57 offen sc1
    v_mfma_f32_16x16x32_bf16 v[28:31], v[64:67], v[208:211], v[28:31]
    v_mfma_f32_16x16x32_bf16 v[44:47], v[68:71], v[208:211], v[44:47]
    s_waitcnt lgkmcnt(2)
    v_mfma_f32_16x16x32_bf16 v[16:19], v[48:51], a[36:39], v[16:19]
    ds_read_b128 v[64:67], v6 offset:22528
    v_mfma_f32_16x16x32_bf16 v[32:35], v[52:55], a[36:39], v[32:35]
    ds_read_b128 v[68:71], v6 offset:23552
    v_mfma_f32_16x16x32_bf16 v[20:23], v[48:51], a[116:119], v[20:23]
    v_mfma_f32_16x16x32_bf16 v[36:39], v[52:55], a[116:119], v[36:39]
    s_add_u32 m0, s64, 6144
    s_add_u32 s47, s63, 192
    buffer_load_dwordx4 v4, s[12:15], s47 offen lds
    v_mfma_f32_16x16x32_bf16 v[24:27], v[48:51], a[196:199], v[24:27]
    v_mfma_f32_16x16x32_bf16 v[40:43], v[52:55], a[196:199], v[40:43]
    buffer_load_dwordx4 v[88:91], v7, s[8:11], s58 offen sc1
    v_mfma_f32_16x16x32_bf16 v[28:31], v[48:51], v[212:215], v[28:31]
    v_mfma_f32_16x16x32_bf16 v[44:47], v[52:55], v[212:215], v[44:47]
    s_waitcnt lgkmcnt(2)
    v_mfma_f32_16x16x32_bf16 v[16:19], v[56:59], a[40:43], v[16:19]
    ds_read_b128 v[48:51], v6 offset:24576
    v_mfma_f32_16x16x32_bf16 v[32:35], v[60:63], a[40:43], v[32:35]
    ds_read_b128 v[52:55], v6 offset:25600
    v_mfma_f32_16x16x32_bf16 v[20:23], v[56:59], a[120:123], v[20:23]
    v_mfma_f32_16x16x32_bf16 v[36:39], v[60:63], a[120:123], v[36:39]
    s_add_u32 m0, s64, 7168
    s_add_u32 s47, s63, 20672
    buffer_load_dwordx4 v4, s[12:15], s47 offen lds
    v_mfma_f32_16x16x32_bf16 v[24:27], v[56:59], a[200:203], v[24:27]
    v_mfma_f32_16x16x32_bf16 v[40:43], v[60:63], a[200:203], v[40:43]
    v_mfma_f32_16x16x32_bf16 v[28:31], v[56:59], v[216:219], v[28:31]
    v_mfma_f32_16x16x32_bf16 v[44:47], v[60:63], v[216:219], v[44:47]
    s_waitcnt lgkmcnt(2)
    v_mfma_f32_16x16x32_bf16 v[16:19], v[64:67], a[44:47], v[16:19]
    ds_read_b128 v[56:59], v6 offset:26624
    v_mfma_f32_16x16x32_bf16 v[32:35], v[68:71], a[44:47], v[32:35]
    ds_read_b128 v[60:63], v6 offset:27648
    v_mfma_f32_16x16x32_bf16 v[20:23], v[64:67], a[124:127], v[20:23]
    v_mfma_f32_16x16x32_bf16 v[36:39], v[68:71], a[124:127], v[36:39]
    v_mfma_f32_16x16x32_bf16 v[24:27], v[64:67], a[204:207], v[24:27]
    v_mfma_f32_16x16x32_bf16 v[40:43], v[68:71], a[204:207], v[40:43]
    v_mfma_f32_16x16x32_bf16 v[28:31], v[64:67], v[220:223], v[28:31]
    v_mfma_f32_16x16x32_bf16 v[44:47], v[68:71], v[220:223], v[44:47]
    s_waitcnt lgkmcnt(2)
    v_mfma_f32_16x16x32_bf16 v[16:19], v[48:51], a[48:51], v[16:19]
    ds_read_b128 v[64:67], v6 offset:28672
    v_mfma_f32_16x16x32_bf16 v[32:35], v[52:55], a[48:51], v[32:35]
    ds_read_b128 v[68:71], v6 offset:29696
    v_mfma_f32_16x16x32_bf16 v[20:23], v[48:51], a[128:131], v[20:23]
    v_mfma_f32_16x16x32_bf16 v[36:39], v[52:55], a[128:131], v[36:39]
    s_add_u32 m0, s64, 8192
    s_add_u32 s47, s63, 256
    buffer_load_dwordx4 v4, s[12:15], s47 offen lds
    v_mfma_f32_16x16x32_bf16 v[24:27], v[48:51], a[208:211], v[24:27]
    v_mfma_f32_16x16x32_bf16 v[40:43], v[52:55], a[208:211], v[40:43]
    v_mfma_f32_16x16x32_bf16 v[28:31], v[48:51], v[224:227], v[28:31]
    v_mfma_f32_16x16x32_bf16 v[44:47], v[52:55], v[224:227], v[44:47]
    s_waitcnt lgkmcnt(2)
    v_mfma_f32_16x16x32_bf16 v[16:19], v[56:59], a[52:55], v[16:19]
    ds_read_b128 v[48:51], v6 offset:30720
    v_mfma_f32_16x16x32_bf16 v[32:35], v[60:63], a[52:55], v[32:35]
    ds_read_b128 v[52:55], v6 offset:31744
    v_mfma_f32_16x16x32_bf16 v[20:23], v[56:59], a[132:135], v[20:23]
    v_mfma_f32_16x16x32_bf16 v[36:39], v[60:63], a[132:135], v[36:39]
    s_add_u32 m0, s64, 9216
    s_add_u32 s47, s63, 20736
    buffer_load_dwordx4 v4, s[12:15], s47 offen lds
    v_mfma_f32_16x16x32_bf16 v[24:27], v[56:59], a[212:215], v[24:27]
    v_mfma_f32_16x16x32_bf16 v[40:43], v[60:63], a[212:215], v[40:43]
    v_mfma_f32_16x16x32_bf16 v[28:31], v[56:59], v[228:231], v[28:31]
    v_mfma_f32_16x16x32_bf16 v[44:47], v[60:63], v[228:231], v[44:47]
    s_waitcnt lgkmcnt(2)
    v_mfma_f32_16x16x32_bf16 v[16:19], v[64:67], a[56:59], v[16:19]
    ds_read_b128 v[56:59], v6 offset:32768
    v_mfma_f32_16x16x32_bf16 v[32:35], v[68:71], a[56:59], v[32:35]
    ds_read_b128 v[60:63], v6 offset:33792
    v_mfma_f32_16x16x32_bf16 v[20:23], v[64:67], a[136:139], v[20:23]
    v_mfma_f32_16x16x32_bf16 v[36:39], v[68:71], a[136:139], v[36:39]
    v_mfma_f32_16x16x32_bf16 v[24:27], v[64:67], a[216:219], v[24:27]
    v_mfma_f32_16x16x32_bf16 v[40:43], v[68:71], a[216:219], v[40:43]
    v_mfma_f32_16x16x32_bf16 v[28:31], v[64:67], v[232:235], v[28:31]
    v_mfma_f32_16x16x32_bf16 v[44:47], v[68:71], v[232:235], v[44:47]
    s_waitcnt lgkmcnt(2)
    v_mfma_f32_16x16x32_bf16 v[16:19], v[48:51], a[60:63], v[16:19]
    ds_read_b128 v[64:67], v6 offset:34816
    v_mfma_f32_16x16x32_bf16 v[32:35], v[52:55], a[60:63], v[32:35]
    ds_read_b128 v[68:71], v6 offset:35840
    v_mfma_f32_16x16x32_bf16 v[20:23], v[48:51], a[140:143], v[20:23]
    v_mfma_f32_16x16x32_bf16 v[36:39], v[52:55], a[140:143], v[36:39]
    v_mfma_f32_16x16x32_bf16 v[24:27], v[48:51], a[220:223], v[24:27]
    v_mfma_f32_16x16x32_bf16 v[40:43], v[52:55], a[220:223], v[40:43]
    v_mfma_f32_16x16x32_bf16 v[28:31], v[48:51], v[236:239], v[28:31]
    v_mfma_f32_16x16x32_bf16 v[44:47], v[52:55], v[236:239], v[44:47]
    s_waitcnt lgkmcnt(2)
    v_mfma_f32_16x16x32_bf16 v[16:19], v[56:59], a[64:67], v[16:19]
    ds_read_b128 v[48:51], v6 offset:36864
    v_mfma_f32_16x16x32_bf16 v[32:35], v[60:63], a[64:67], v[32:35]
    ds_read_b128 v[52:55], v6 offset:37888
    v_mfma_f32_16x16x32_bf16 v[20:23], v[56:59], a[144:147], v[20:23]
    v_mfma_f32_16x16x32_bf16 v[36:39], v[60:63], a[144:147], v[36:39]
    v_mfma_f32_16x16x32_bf16 v[24:27], v[56:59], a[224:227], v[24:27]
    v_mfma_f32_16x16x32_bf16 v[40:43], v[60:63], a[224:227], v[40:43]
    v_mfma_f32_16x16x32_bf16 v[28:31], v[56:59], v[240:243], v[28:31]
    v_mfma_f32_16x16x32_bf16 v[44:47], v[60:63], v[240:243], v[44:47]
    s_waitcnt lgkmcnt(2)
    s_waitcnt vmcnt(3)
    v_mfma_f32_16x16x32_bf16 v[16:19], v[64:67], a[68:71], v[16:19]
    v_max3_u32 v1, v80, v81, v82
    ds_read_b128 v[56:59], v6 offset:38912
    v_mfma_f32_16x16x32_bf16 v[32:35], v[68:71], a[68:71], v[32:35]
    v_max3_u32 v2, v86, v87, v88
    ds_read_b128 v[60:63], v6 offset:39936
    v_mfma_f32_16x16x32_bf16 v[20:23], v[64:67], a[148:151], v[20:23]
    v_max3_u32 v1, v1, v83, v84
    v_mfma_f32_16x16x32_bf16 v[36:39], v[68:71], a[148:151], v[36:39]
    v_max3_u32 v2, v2, v89, v90
    v_mfma_f32_16x16x32_bf16 v[24:27], v[64:67], a[228:231], v[24:27]
    v_max_u32 v1, v1, v85
    v_mfma_f32_16x16x32_bf16 v[40:43], v[68:71], a[228:231], v[40:43]
    v_max_u32 v2, v2, v91
    v_mfma_f32_16x16x32_bf16 v[28:31], v[64:67], v[244:247], v[28:31]
    v_max_u32 v1, v1, v2
    v_mfma_f32_16x16x32_bf16 v[44:47], v[68:71], v[244:247], v[44:47]
    v_cmp_eq_u32 vcc, -1, v1
    s_cbranch_vccz MO_46
MS_45:
    s_sub_u32 s35, s35, 1
    s_cbranch_scc1 TO_47
    buffer_load_dwordx4 v[80:83], v7, s[8:11], s56 offen sc1
    buffer_load_dwordx4 v[84:87], v7, s[8:11], s57 offen sc1
    buffer_load_dwordx4 v[88:91], v7, s[8:11], s58 offen sc1
    s_waitcnt vmcnt(0)
    v_max3_u32 v1, v80, v81, v82
    v_max3_u32 v2, v86, v87, v88
    v_max3_u32 v1, v1, v83, v84
    v_max3_u32 v2, v2, v89, v90
    v_max_u32 v1, v1, v85
    v_max_u32 v2, v2, v91
    v_max_u32 v1, v1, v2
    v_cmp_eq_u32 vcc, -1, v1
    s_cbranch_vccnz MS_45
MO_46:
    ds_write_b128 v12, v[80:83]
    ds_write_b128 v12, v[84:87] offset:4096
    ds_write_b128 v13, v[88:91]
    s_waitcnt lgkmcnt(5)
    v_mfma_f32_16x16x32_bf16 v[16:19], v[48:51], a[72:75], v[16:19]
    v_mfma_f32_16x16x32_bf16 v[32:35], v[52:55], a[72:75], v[32:35]
    v_mfma_f32_16x16x32_bf16 v[20:23], v[48:51], a[152:155], v[20:23]
    v_mfma_f32_16x16x32_bf16 v[36:39], v[52:55], a[152:155], v[36:39]
    v_mfma_f32_16x16x32_bf16 v[24:27], v[48:51], a[232:235], v[24:27]
    v_mfma_f32_16x16x32_bf16 v[40:43], v[52:55], a[232:235], v[40:43]
    v_mfma_f32_16x16x32_bf16 v[28:31], v[48:51], v[248:251], v[28:31]
    v_mfma_f32_16x16x32_bf16 v[44:47], v[52:55], v[248:251], v[44:47]
    s_waitcnt lgkmcnt(3)
    s_waitcnt lgkmcnt(0)
    s_barrier
    ds_read_b128 v[108:111], v14 offset:0
    ds_read_b128 v[112:115], v14 offset:1024
    v_mfma_f32_16x16x32_bf16 v[16:19], v[56:59], a[76:79], v[16:19]
    v_mfma_f32_16x16x32_bf16 v[32:35], v[60:63], a[76:79], v[32:35]
    v_mfma_f32_16x16x32_bf16 v[20:23], v[56:59], a[156:159], v[20:23]
    v_mfma_f32_16x16x32_bf16 v[36:39], v[60:63], a[156:159], v[36:39]
    v_mfma_f32_16x16x32_bf16 v[24:27], v[56:59], a[236:239], v[24:27]
    v_mfma_f32_16x16x32_bf16 v[40:43], v[60:63], a[236:239], v[40:43]
    v_mfma_f32_16x16x32_bf16 v[28:31], v[56:59], v[252:255], v[28:31]
    v_mfma_f32_16x16x32_bf16 v[44:47], v[60:63], v[252:255], v[44:47]
    ds_read_b128 v[116:119], v14 offset:2048
    s_waitcnt lgkmcnt(2)
    v_smfmac_f32_16x16x64_bf16 v[92:95], v[108:111], a[0:7], v11
    v_smfmac_f32_16x16x64_bf16 v[96:99], v[108:111], a[80:87], v11
    v_smfmac_f32_16x16x64_bf16 v[100:103], v[108:111], a[160:167], v11
    v_smfmac_f32_16x16x64_bf16 v[104:107], v[108:111], a[240:247], v11
    ds_read_b128 v[108:111], v14 offset:3072
    s_waitcnt lgkmcnt(2)
    v_smfmac_f32_16x16x64_bf16 v[92:95], v[112:115], a[8:15], v11
    v_cvt_pk_bf16_f32 v64, v16, v17
    v_smfmac_f32_16x16x64_bf16 v[96:99], v[112:115], a[88:95], v11
    v_cvt_pk_bf16_f32 v65, v18, v19
    v_smfmac_f32_16x16x64_bf16 v[100:103], v[112:115], a[168:175], v11
    v_cvt_pk_bf16_f32 v66, v32, v33
    v_smfmac_f32_16x16x64_bf16 v[104:107], v[112:115], a[248:255], v11
    v_cvt_pk_bf16_f32 v67, v34, v35
    ds_read_b128 v[112:115], v14 offset:4096
    s_waitcnt lgkmcnt(2)
    v_smfmac_f32_16x16x64_bf16 v[92:95], v[116:119], a[16:23], v11
    v_cvt_pk_bf16_f32 v68, v20, v21
    v_smfmac_f32_16x16x64_bf16 v[96:99], v[116:119], a[96:103], v11
    v_cvt_pk_bf16_f32 v69, v22, v23
    v_smfmac_f32_16x16x64_bf16 v[100:103], v[116:119], a[176:183], v11
    v_cvt_pk_bf16_f32 v70, v36, v37
    v_smfmac_f32_16x16x64_bf16 v[104:107], v[116:119], v[192:199], v11
    v_cvt_pk_bf16_f32 v71, v38, v39
    ds_read_b128 v[116:119], v14 offset:5120
    s_waitcnt lgkmcnt(2)
    v_smfmac_f32_16x16x64_bf16 v[92:95], v[108:111], a[24:31], v11
    v_cvt_pk_bf16_f32 v72, v24, v25
    v_smfmac_f32_16x16x64_bf16 v[96:99], v[108:111], a[104:111], v11
    v_cvt_pk_bf16_f32 v73, v26, v27
    v_smfmac_f32_16x16x64_bf16 v[100:103], v[108:111], a[184:191], v11
    v_cvt_pk_bf16_f32 v74, v40, v41
    v_smfmac_f32_16x16x64_bf16 v[104:107], v[108:111], v[200:207], v11
    v_cvt_pk_bf16_f32 v75, v42, v43
    ds_read_b128 v[108:111], v14 offset:6144
    s_waitcnt lgkmcnt(2)
    v_smfmac_f32_16x16x64_bf16 v[92:95], v[112:115], a[32:39], v11
    v_cvt_pk_bf16_f32 v76, v28, v29
    v_smfmac_f32_16x16x64_bf16 v[96:99], v[112:115], a[112:119], v11
    v_cvt_pk_bf16_f32 v77, v30, v31
    v_smfmac_f32_16x16x64_bf16 v[100:103], v[112:115], a[192:199], v11
    v_cvt_pk_bf16_f32 v78, v44, v45
    v_smfmac_f32_16x16x64_bf16 v[104:107], v[112:115], v[208:215], v11
    v_cvt_pk_bf16_f32 v79, v46, v47
    ds_read_b128 v[112:115], v14 offset:7168
    s_waitcnt lgkmcnt(2)
    v_smfmac_f32_16x16x64_bf16 v[92:95], v[116:119], a[40:47], v11
    v_smfmac_f32_16x16x64_bf16 v[96:99], v[116:119], a[120:127], v11
    v_smfmac_f32_16x16x64_bf16 v[100:103], v[116:119], a[200:207], v11
    v_smfmac_f32_16x16x64_bf16 v[104:107], v[116:119], v[216:223], v11
    ds_read_b128 v[116:119], v14 offset:8192
    s_waitcnt lgkmcnt(2)
    v_smfmac_f32_16x16x64_bf16 v[92:95], v[108:111], a[48:55], v11
    v_smfmac_f32_16x16x64_bf16 v[96:99], v[108:111], a[128:135], v11
    v_smfmac_f32_16x16x64_bf16 v[100:103], v[108:111], a[208:215], v11
    v_smfmac_f32_16x16x64_bf16 v[104:107], v[108:111], v[224:231], v11
    ds_read_b128 v[108:111], v14 offset:9216
    s_waitcnt lgkmcnt(2)
    v_smfmac_f32_16x16x64_bf16 v[92:95], v[112:115], a[56:63], v11
    v_smfmac_f32_16x16x64_bf16 v[96:99], v[112:115], a[136:143], v11
    v_smfmac_f32_16x16x64_bf16 v[100:103], v[112:115], a[216:223], v11
    v_smfmac_f32_16x16x64_bf16 v[104:107], v[112:115], v[232:239], v11
    s_waitcnt lgkmcnt(1)
    v_smfmac_f32_16x16x64_bf16 v[92:95], v[116:119], a[64:71], v11
    v_smfmac_f32_16x16x64_bf16 v[96:99], v[116:119], a[144:151], v11
    v_smfmac_f32_16x16x64_bf16 v[100:103], v[116:119], a[224:231], v11
    v_smfmac_f32_16x16x64_bf16 v[104:107], v[116:119], v[240:247], v11
    s_waitcnt lgkmcnt(0)
    v_smfmac_f32_16x16x64_bf16 v[92:95], v[108:111], a[72:79], v11
    v_smfmac_f32_16x16x64_bf16 v[96:99], v[108:111], a[152:159], v11
    v_smfmac_f32_16x16x64_bf16 v[100:103], v[108:111], a[232:239], v11
    v_smfmac_f32_16x16x64_bf16 v[104:107], v[108:111], v[248:255], v11
    s_nop 5
    v_permlane32_swap_b32 v92, v96
    s_nop 0
    v_permlane32_swap_b32 v100, v104
    v_permlane32_swap_b32 v93, v97
    v_permlane32_swap_b32 v101, v105
    v_permlane32_swap_b32 v94, v98
    v_permlane32_swap_b32 v102, v106
    v_permlane32_swap_b32 v95, v99
    v_permlane32_swap_b32 v103, v107
    v_add_f32 v92, v92, v96
    v_add_f32 v100, v100, v104
    v_add_f32 v93, v93, v97
    v_add_f32 v101, v101, v105
    v_add_f32 v94, v94, v98
    v_add_f32 v102, v102, v106
    v_add_f32 v95, v95, v99
    v_add_f32 v103, v103, v107
    v_cvt_pk_bf16_f32 v120, v92, v93
    v_cvt_pk_bf16_f32 v122, v100, v101
    v_cvt_pk_bf16_f32 v121, v94, v95
    v_cvt_pk_bf16_f32 v123, v102, v103
    v_permlane16_swap_b32 v120, v122
    s_nop 0
    v_permlane16_swap_b32 v121, v123
    buffer_load_dwordx4 v[124:127], v7, s[8:11], s65 offen offset:0 sc0 sc1
    buffer_load_dwordx4 v[128:131], v7, s[8:11], s65 offen offset:1024 sc0 sc1
    buffer_load_dwordx4 v[132:135], v7, s[8:11], s65 offen offset:2048 sc0 sc1
    buffer_load_dwordx4 v[136:139], v7, s[8:11], s65 offen offset:3072 sc0 sc1
    buffer_load_dwordx4 v[140:143], v7, s[8:11], s70 offen sc0 sc1
    s_branch PC_49
PL_48:
    buffer_load_dwordx4 v[124:127], v7, s[8:11], s65 offen offset:0 sc0 sc1
    buffer_load_dwordx4 v[128:131], v7, s[8:11], s65 offen offset:1024 sc0 sc1
    buffer_load_dwordx4 v[132:135], v7, s[8:11], s65 offen offset:2048 sc0 sc1
    buffer_load_dwordx4 v[136:139], v7, s[8:11], s65 offen offset:3072 sc0 sc1
    buffer_load_dwordx4 v[140:143], v7, s[8:11], s70 offen sc0 sc1
PC_49:
    s_waitcnt vmcnt(0)
    v_mfma_f32_16x16x32_bf16 v[144:147], v[64:67], v[124:127], 0
    v_max3_u32 v1, v124, v125, v126
    v_max3_u32 v2, v134, v135, v136
    v_max3_u32 v1, v1, v127, v128
    v_mfma_f32_16x16x32_bf16 v[144:147], v[68:71], v[128:131], v[144:147]
    v_max3_u32 v2, v2, v137, v138
    v_max3_u32 v1, v1, v129, v130
    v_max3_u32 v2, v2, v139, v140
    v_mfma_f32_16x16x32_bf16 v[144:147], v[72:75], v[132:135], v[144:147]
    v_max3_u32 v1, v1, v131, v132
    v_max3_u32 v2, v2, v141, v142
    v_max_u32 v1, v1, v133
    v_mfma_f32_16x16x32_bf16 v[144:147], v[76:79], v[136:139], v[144:147]
    v_max_u32 v2, v2, v143
    v_max_u32 v1, v1, v2
    v_cmp_eq_u32 vcc, -1, v1
    v_mfma_f32_16x16x32_bf16 v[144:147], v[120:123], v[140:143], v[144:147]
    s_nop 2
    s_cbranch_vccz PD_50
    s_sub_u32 s35, s35, 1
    s_cbranch_scc1 TO_51
    s_branch PL_48
PD_50:
    s_mov_b64 exec, s[66:67]
    s_nop 2
    ds_write_b128 v8, v[144:147]
    s_mov_b64 exec, -1
    s_add_u32 s34, s34, 1
    s_waitcnt lgkmcnt(0)
    s_barrier
    s_cmp_lg_u32 s33, 0
    s_cbranch_scc1 R2N_52
    ds_read_b128 v[148:151], v9
    ds_read_b128 v[152:155], v9 offset:256
    s_mul_i32 s45, s34, 10240
    s_add_u32 s45, s45, 131072
    s_waitcnt lgkmcnt(0)
    v_add_f32 v148, v148, v152
    v_add_f32 v149, v149, v153
    v_add_f32 v150, v150, v154
    v_add_f32 v151, v151, v155
    s_nop 0
    v_permlane32_swap_b32 v148, v150
    v_permlane32_swap_b32 v149, v151
    v_add_f32 v148, v148, v150
    v_add_f32 v149, v149, v151
    v_mov_b32 v150, v148
    v_mov_b32 v151, v149
    s_nop 0
    v_permlane16_swap_b32 v148, v150
    v_permlane16_swap_b32 v149, v151
    v_add_f32 v148, v148, v150
    v_add_f32 v149, v149, v151
    v_cvt_pk_bf16_f32 v148, v148, v149
    v_min_u32 v148, -2, v148
    v_mov_b32 v149, v148
    s_nop 1
    v_permlane32_swap_b32 v148, v149
    s_nop 1
    v_mov_b32_dpp v150, v148 quad_perm:[1,0,3,2] row_mask:0xf bank_mask:0xf
    v_mov_b32_dpp v151, v149 quad_perm:[1,0,3,2] row_mask:0xf bank_mask:0xf
    s_mov_b64 exec, s[68:69]
    buffer_store_dwordx4 v[148:151], v10, s[8:11], s45 offen sc1
    s_mov_b64 exec, -1
R2N_52:
    s_cmp_lt_u32 s34, 63
    s_cbranch_scc1 R2L_44
    s_waitcnt vmcnt(0)
    s_endpgm
L_R3:
    s_cmp_ge_u32 s32, 40
    s_cselect_b32 s65, 1, 0
    s_mul_i32 s45, s65, 40
    s_sub_u32 s66, s32, s45
    s_lshr_b32 s45, s66, 2
    s_lshl_b32 s45, s45, 7
    s_and_b32 s46, s66, 3
    s_lshl_b32 s47, s65, 2
    s_add_u32 s46, s46, s47
    s_lshl_b32 s46, s46, 2
    s_add_u32 s45, s45, s46
    s_lshl_b32 s46, s33, 5
    s_add_u32 s45, s45, s46
    s_add_u32 s67, s45, 8704
    s_cmp_ge_u32 s33, 2
    s_cbranch_scc1 R3R_53
    v_mov_b32 v1, 0
    v_mov_b32 v2, s67
    s_mov_b64 exec, 1
    buffer_store_dword v1, v2, s[8:11], 0 offen sc1
    s_mov_b64 exec, -1
R3R_53:
    s_add_u32 s59, s32, 80
    s_cmp_lg_u32 s33, 0
    s_cbranch_scc1 FR_54
    s_mul_i32 s48, s59, 52429
    s_lshr_b32 s48, s48, 18
    s_mul_i32 s45, s48, 5
    s_sub_u32 s45, s59, s45
    s_lshl_b32 s45, s45, 7
    s_lshl_b32 s46, s48, 2
    s_add_u32 s45, s45, s46
    s_add_u32 s45, s45, 0
    v_mov_b32 v1, 0
    v_mov_b32 v2, s45
    s_mov_b64 exec, 1
    buffer_store_dword v1, v2, s[8:11], 0 offen sc1
    s_mov_b64 exec, -1
FR_54:
    s_waitcnt vmcnt(0) lgkmcnt(0)
    s_barrier
    s_cmp_lg_u32 s33, 0
    s_cbranch_scc1 SI_55
    v_mov_b32 v1, 1
    v_mov_b32 v2, 4
    s_mov_b64 exec, 1
    buffer_atomic_add v1, v2, s[28:31], 0 offen sc1
    s_mov_b64 exec, -1
SI_55:
    s_mul_i32 s48, s59, 52429
    s_lshr_b32 s48, s48, 18
    s_mul_i32 s45, s48, 5
    s_sub_u32 s49, s59, s45
    s_load_dwordx2 s[4:5], s[0:1], 32
    s_waitcnt lgkmcnt(0)
    s_mov_b32 s16, s4
    s_mov_b32 s17, s5
    s_mov_b32 s18, 7864320
    s_mov_b32 s19, 0x20000
    s_load_dwordx2 s[4:5], s[0:1], 40
    s_waitcnt lgkmcnt(0)
    s_mov_b32 s20, s4
    s_mov_b32 s21, s5
    s_mov_b32 s22, 7864320
    s_mov_b32 s23, 0x20000
    v_lshrrev_b32 v2, 4, v0
    v_and_b32 v3, 15, v0
    v_mul_u32_u24 v4, 1280, v2
    v_lshl_add_u32 v6, v3, 4, v4
    v_mul_u32_u24 v4, 288, v2
    v_lshl_add_u32 v7, v3, 4, v4
    s_mul_i32 s45, s33, 13824
    v_add_u32 v7, s45, v7
    v_bfe_u32 v4, v0, 2, 2
    v_lshl_add_u32 v4, v2, 3, v4
    v_mul_u32_u24 v4, 288, v4
    v_and_b32 v11, 3, v0
    v_lshl_add_u32 v8, v11, 3, v4
    v_lshrrev_b32 v4, 2, v3
    v_lshl_add_u32 v4, v4, 3, v11
    v_mul_u32_u24 v4, 12288, v4
    v_lshl_add_u32 v9, v2, 4, v4
    v_lshlrev_b32 v4, 6, v3
    v_lshl_add_u32 v10, v2, 4, v4
    s_mul_i32 s50, s48, 245760
    s_mul_i32 s45, s33, 61440
    s_add_u32 s50, s50, s45
    s_lshl_b32 s45, s49, 8
    s_add_u32 s50, s50, s45
    s_add_u32 s45, s50, 0
    buffer_load_dwordx4 v[64:67], v6, s[20:23], s45 offen
    s_add_u32 s45, s50, 5120
    buffer_load_dwordx4 v[68:71], v6, s[20:23], s45 offen
    s_add_u32 s45, s50, 10240
    buffer_load_dwordx4 v[72:75], v6, s[20:23], s45 offen
    s_add_u32 s45, s50, 15360
    buffer_load_dwordx4 v[76:79], v6, s[20:23], s45 offen
    s_add_u32 s45, s50, 20480
    buffer_load_dwordx4 v[80:83], v6, s[20:23], s45 offen
    s_add_u32 s45, s50, 25600
    buffer_load_dwordx4 v[84:87], v6, s[20:23], s45 offen
    s_add_u32 s45, s50, 30720
    buffer_load_dwordx4 v[88:91], v6, s[20:23], s45 offen
    s_add_u32 s45, s50, 35840
    buffer_load_dwordx4 v[92:95], v6, s[20:23], s45 offen
    s_add_u32 s45, s50, 40960
    buffer_load_dwordx4 v[96:99], v6, s[20:23], s45 offen
    s_add_u32 s45, s50, 46080
    buffer_load_dwordx4 v[100:103], v6, s[20:23], s45 offen
    s_add_u32 s45, s50, 51200
    buffer_load_dwordx4 v[104:107], v6, s[20:23], s45 offen
    s_add_u32 s45, s50, 56320
    buffer_load_dwordx4 v[108:111], v6, s[20:23], s45 offen
    s_mul_i32 s51, s33, 1966080
    s_mul_i32 s45, s48, 384
    s_add_u32 s51, s51, s45
    s_add_u32 s45, s51, 0
    buffer_load_dwordx4 v[112:115], v9, s[16:19], s45 offen offset:0
    buffer_load_dwordx4 v[116:119], v9, s[16:19], s45 offen offset:64
    buffer_load_dwordx4 v[120:123], v9, s[16:19], s45 offen offset:128
    buffer_load_dwordx4 v[124:127], v9, s[16:19], s45 offen offset:192
    buffer_load_dwordx4 v[128:131], v9, s[16:19], s45 offen offset:256
    buffer_load_dwordx4 v[132:135], v9, s[16:19], s45 offen offset:320
    s_add_u32 s45, s51, 49152
    buffer_load_dwordx4 v[136:139], v9, s[16:19], s45 offen offset:0
    buffer_load_dwordx4 v[140:143], v9, s[16:19], s45 offen offset:64
    buffer_load_dwordx4 v[144:147], v9, s[16:19], s45 offen offset:128
    buffer_load_dwordx4 v[148:151], v9, s[16:19], s45 offen offset:192
    buffer_load_dwordx4 v[152:155], v9, s[16:19], s45 offen offset:256
    buffer_load_dwordx4 v[156:159], v9, s[16:19], s45 offen offset:320
    s_waitcnt vmcnt(23)
    ds_write_b128 v7, v[64:67] offset:0
    s_waitcnt vmcnt(22)
    ds_write_b128 v7, v[68:71] offset:1152
    s_waitcnt vmcnt(21)
    ds_write_b128 v7, v[72:75] offset:2304
    s_waitcnt vmcnt(20)
    ds_write_b128 v7, v[76:79] offset:3456
    s_waitcnt vmcnt(19)
    ds_write_b128 v7, v[80:83] offset:4608
    s_waitcnt vmcnt(18)
    ds_write_b128 v7, v[84:87] offset:5760
    s_waitcnt vmcnt(17)
    ds_write_b128 v7, v[88:91] offset:6912
    s_waitcnt vmcnt(16)
    ds_write_b128 v7, v[92:95] offset:8064
    s_waitcnt vmcnt(15)
    ds_write_b128 v7, v[96:99] offset:9216
    s_waitcnt vmcnt(14)
    ds_write_b128 v7, v[100:103] offset:10368
    s_waitcnt vmcnt(13)
    ds_write_b128 v7, v[104:107] offset:11520
    s_waitcnt vmcnt(12)
    ds_write_b128 v7, v[108:111] offset:12672
    s_waitcnt lgkmcnt(0)
    s_barrier
    ds_read_b64_tr_b16 a[0:1], v8 offset:0
    ds_read_b64_tr_b16 a[2:3], v8 offset:1152
    ds_read_b64_tr_b16 a[4:5], v8 offset:9216
    ds_read_b64_tr_b16 a[6:7], v8 offset:10368
    ds_read_b64_tr_b16 a[8:9], v8 offset:18432
    ds_read_b64_tr_b16 a[10:11], v8 offset:19584
    ds_read_b64_tr_b16 a[12:13], v8 offset:27648
    ds_read_b64_tr_b16 a[14:15], v8 offset:28800
    ds_read_b64_tr_b16 a[16:17], v8 offset:36864
    ds_read_b64_tr_b16 a[18:19], v8 offset:38016
    ds_read_b64_tr_b16 a[20:21], v8 offset:46080
    ds_read_b64_tr_b16 a[22:23], v8 offset:47232
    ds_read_b64_tr_b16 a[24:25], v8 offset:32
    ds_read_b64_tr_b16 a[26:27], v8 offset:1184
    ds_read_b64_tr_b16 a[28:29], v8 offset:9248
    ds_read_b64_tr_b16 a[30:31], v8 offset:10400
    ds_read_b64_tr_b16 a[32:33], v8 offset:18464
    ds_read_b64_tr_b16 a[34:35], v8 offset:19616
    ds_read_b64_tr_b16 a[36:37], v8 offset:27680
    ds_read_b64_tr_b16 a[38:39], v8 offset:28832
    ds_read_b64_tr_b16 a[40:41], v8 offset:36896
    ds_read_b64_tr_b16 a[42:43], v8 offset:38048
    ds_read_b64_tr_b16 a[44:45], v8 offset:46112
    ds_read_b64_tr_b16 a[46:47], v8 offset:47264
    ds_read_b64_tr_b16 a[48:49], v8 offset:64
    ds_read_b64_tr_b16 a[50:51], v8 offset:1216
    ds_read_b64_tr_b16 a[52:53], v8 offset:9280
    ds_read_b64_tr_b16 a[54:55], v8 offset:10432
    ds_read_b64_tr_b16 a[56:57], v8 offset:18496
    ds_read_b64_tr_b16 a[58:59], v8 offset:19648
    ds_read_b64_tr_b16 a[60:61], v8 offset:27712
    ds_read_b64_tr_b16 a[62:63], v8 offset:28864
    ds_read_b64_tr_b16 a[64:65], v8 offset:36928
    ds_read_b64_tr_b16 a[66:67], v8 offset:38080
    ds_read_b64_tr_b16 a[68:69], v8 offset:46144
    ds_read_b64_tr_b16 a[70:71], v8 offset:47296
    ds_read_b64_tr_b16 a[72:73], v8 offset:96
    ds_read_b64_tr_b16 a[74:75], v8 offset:1248
    ds_read_b64_tr_b16 a[76:77], v8 offset:9312
    ds_read_b64_tr_b16 a[78:79], v8 offset:10464
    ds_read_b64_tr_b16 a[80:81], v8 offset:18528
    ds_read_b64_tr_b16 a[82:83], v8 offset:19680
    ds_read_b64_tr_b16 a[84:85], v8 offset:27744
    ds_read_b64_tr_b16 a[86:87], v8 offset:28896
    ds_read_b64_tr_b16 a[88:89], v8 offset:36960
    ds_read_b64_tr_b16 a[90:91], v8 offset:38112
    ds_read_b64_tr_b16 a[92:93], v8 offset:46176
    ds_read_b64_tr_b16 a[94:95], v8 offset:47328
    ds_read_b64_tr_b16 a[96:97], v8 offset:128
    ds_read_b64_tr_b16 a[98:99], v8 offset:1280
    ds_read_b64_tr_b16 a[100:101], v8 offset:9344
    ds_read_b64_tr_b16 a[102:103], v8 offset:10496
    ds_read_b64_tr_b16 a[104:105], v8 offset:18560
    ds_read_b64_tr_b16 a[106:107], v8 offset:19712
    ds_read_b64_tr_b16 a[108:109], v8 offset:27776
    ds_read_b64_tr_b16 a[110:111], v8 offset:28928
    ds_read_b64_tr_b16 a[112:113], v8 offset:36992
    ds_read_b64_tr_b16 a[114:115], v8 offset:38144
    ds_read_b64_tr_b16 a[116:117], v8 offset:46208
    ds_read_b64_tr_b16 a[118:119], v8 offset:47360
    ds_read_b64_tr_b16 a[120:121], v8 offset:160
    ds_read_b64_tr_b16 a[122:123], v8 offset:1312
    ds_read_b64_tr_b16 a[124:125], v8 offset:9376
    ds_read_b64_tr_b16 a[126:127], v8 offset:10528
    ds_read_b64_tr_b16 a[128:129], v8 offset:18592
    ds_read_b64_tr_b16 a[130:131], v8 offset:19744
    ds_read_b64_tr_b16 a[132:133], v8 offset:27808
    ds_read_b64_tr_b16 a[134:135], v8 offset:28960
    ds_read_b64_tr_b16 a[136:137], v8 offset:37024
    ds_read_b64_tr_b16 a[138:139], v8 offset:38176
    ds_read_b64_tr_b16 a[140:141], v8 offset:46240
    ds_read_b64_tr_b16 a[142:143], v8 offset:47392
    ds_read_b64_tr_b16 a[144:145], v8 offset:192
    ds_read_b64_tr_b16 a[146:147], v8 offset:1344
    ds_read_b64_tr_b16 a[148:149], v8 offset:9408
    ds_read_b64_tr_b16 a[150:151], v8 offset:10560
    ds_read_b64_tr_b16 a[152:153], v8 offset:18624
    ds_read_b64_tr_b16 a[154:155], v8 offset:19776
    ds_read_b64_tr_b16 a[156:157], v8 offset:27840
    ds_read_b64_tr_b16 a[158:159], v8 offset:28992
    ds_read_b64_tr_b16 a[160:161], v8 offset:37056
    ds_read_b64_tr_b16 a[162:163], v8 offset:38208
    ds_read_b64_tr_b16 a[164:165], v8 offset:46272
    ds_read_b64_tr_b16 a[166:167], v8 offset:47424
    ds_read_b64_tr_b16 a[168:169], v8 offset:224
    ds_read_b64_tr_b16 a[170:171], v8 offset:1376
    ds_read_b64_tr_b16 a[172:173], v8 offset:9440
    ds_read_b64_tr_b16 a[174:175], v8 offset:10592
    ds_read_b64_tr_b16 a[176:177], v8 offset:18656
    ds_read_b64_tr_b16 a[178:179], v8 offset:19808
    ds_read_b64_tr_b16 a[180:181], v8 offset:27872
    ds_read_b64_tr_b16 a[182:183], v8 offset:29024
    ds_read_b64_tr_b16 a[184:185], v8 offset:37088
    ds_read_b64_tr_b16 a[186:187], v8 offset:38240
    ds_read_b64_tr_b16 a[188:189], v8 offset:46304
    ds_read_b64_tr_b16 a[190:191], v8 offset:47456
    s_mul_i32 s52, s48, 819200
    s_mul_i32 s45, s33, 204800
    s_add_u32 s52, s52, s45
    s_lshl_b32 s45, s49, 13
    s_add_u32 s52, s52, s45
    s_add_u32 s52, s52, 24117248
    s_waitcnt lgkmcnt(0)
    s_add_u32 s45, s51, 393216
    buffer_load_dwordx4 v[160:163], v9, s[16:19], s45 offen offset:0
    buffer_load_dwordx4 v[164:167], v9, s[16:19], s45 offen offset:64
    buffer_load_dwordx4 v[168:171], v9, s[16:19], s45 offen offset:128
    buffer_load_dwordx4 v[172:175], v9, s[16:19], s45 offen offset:192
    buffer_load_dwordx4 v[176:179], v9, s[16:19], s45 offen offset:256
    buffer_load_dwordx4 v[180:183], v9, s[16:19], s45 offen offset:320
    s_add_u32 s45, s51, 442368
    buffer_load_dwordx4 v[184:187], v9, s[16:19], s45 offen offset:0
    buffer_load_dwordx4 v[188:191], v9, s[16:19], s45 offen offset:64
    buffer_load_dwordx4 v[192:195], v9, s[16:19], s45 offen offset:128
    buffer_load_dwordx4 v[196:199], v9, s[16:19], s45 offen offset:192
    buffer_load_dwordx4 v[200:203], v9, s[16:19], s45 offen offset:256
    buffer_load_dwordx4 v[204:207], v9, s[16:19], s45 offen offset:320
    s_waitcnt vmcnt(12)
    v_mfma_f32_16x16x32_bf16 v[16:19], v[112:115], a[0:3], 0
    v_mfma_f32_16x16x32_bf16 v[20:23], v[112:115], a[24:27], 0
    v_mfma_f32_16x16x32_bf16 v[24:27], v[112:115], a[48:51], 0
    v_mfma_f32_16x16x32_bf16 v[28:31], v[112:115], a[72:75], 0
    v_mfma_f32_16x16x32_bf16 v[32:35], v[112:115], a[96:99], 0
    v_mfma_f32_16x16x32_bf16 v[36:39], v[112:115], a[120:123], 0
    v_mfma_f32_16x16x32_bf16 v[40:43], v[112:115], a[144:147], 0
    v_mfma_f32_16x16x32_bf16 v[44:47], v[112:115], a[168:171], 0
    v_mfma_f32_16x16x32_bf16 v[48:51], v[136:139], a[0:3], 0
    v_mfma_f32_16x16x32_bf16 v[52:55], v[136:139], a[24:27], 0
    v_mfma_f32_16x16x32_bf16 v[56:59], v[136:139], a[48:51], 0
    v_mfma_f32_16x16x32_bf16 v[60:63], v[136:139], a[72:75], 0
    v_mfma_f32_16x16x32_bf16 v[64:67], v[136:139], a[96:99], 0
    v_mfma_f32_16x16x32_bf16 v[68:71], v[136:139], a[120:123], 0
    v_mfma_f32_16x16x32_bf16 v[72:75], v[136:139], a[144:147], 0
    v_mfma_f32_16x16x32_bf16 v[76:79], v[136:139], a[168:171], 0
    v_mfma_f32_16x16x32_bf16 v[16:19], v[116:119], a[4:7], v[16:19]
    v_mfma_f32_16x16x32_bf16 v[20:23], v[116:119], a[28:31], v[20:23]
    v_mfma_f32_16x16x32_bf16 v[24:27], v[116:119], a[52:55], v[24:27]
    v_mfma_f32_16x16x32_bf16 v[28:31], v[116:119], a[76:79], v[28:31]
    v_mfma_f32_16x16x32_bf16 v[32:35], v[116:119], a[100:103], v[32:35]
    v_mfma_f32_16x16x32_bf16 v[36:39], v[116:119], a[124:127], v[36:39]
    v_mfma_f32_16x16x32_bf16 v[40:43], v[116:119], a[148:151], v[40:43]
    v_mfma_f32_16x16x32_bf16 v[44:47], v[116:119], a[172:175], v[44:47]
    v_mfma_f32_16x16x32_bf16 v[48:51], v[140:143], a[4:7], v[48:51]
    v_mfma_f32_16x16x32_bf16 v[52:55], v[140:143], a[28:31], v[52:55]
    v_mfma_f32_16x16x32_bf16 v[56:59], v[140:143], a[52:55], v[56:59]
    v_mfma_f32_16x16x32_bf16 v[60:63], v[140:143], a[76:79], v[60:63]
    v_mfma_f32_16x16x32_bf16 v[64:67], v[140:143], a[100:103], v[64:67]
    v_mfma_f32_16x16x32_bf16 v[68:71], v[140:143], a[124:127], v[68:71]
    v_mfma_f32_16x16x32_bf16 v[72:75], v[140:143], a[148:151], v[72:75]
    v_mfma_f32_16x16x32_bf16 v[76:79], v[140:143], a[172:175], v[76:79]
    v_mfma_f32_16x16x32_bf16 v[16:19], v[120:123], a[8:11], v[16:19]
    v_mfma_f32_16x16x32_bf16 v[20:23], v[120:123], a[32:35], v[20:23]
    v_mfma_f32_16x16x32_bf16 v[24:27], v[120:123], a[56:59], v[24:27]
    v_mfma_f32_16x16x32_bf16 v[28:31], v[120:123], a[80:83], v[28:31]
    v_mfma_f32_16x16x32_bf16 v[32:35], v[120:123], a[104:107], v[32:35]
    v_mfma_f32_16x16x32_bf16 v[36:39], v[120:123], a[128:131], v[36:39]
    v_mfma_f32_16x16x32_bf16 v[40:43], v[120:123], a[152:155], v[40:43]
    v_mfma_f32_16x16x32_bf16 v[44:47], v[120:123], a[176:179], v[44:47]
    v_mfma_f32_16x16x32_bf16 v[48:51], v[144:147], a[8:11], v[48:51]
    v_mfma_f32_16x16x32_bf16 v[52:55], v[144:147], a[32:35], v[52:55]
    v_mfma_f32_16x16x32_bf16 v[56:59], v[144:147], a[56:59], v[56:59]
    v_mfma_f32_16x16x32_bf16 v[60:63], v[144:147], a[80:83], v[60:63]
    v_mfma_f32_16x16x32_bf16 v[64:67], v[144:147], a[104:107], v[64:67]
    v_mfma_f32_16x16x32_bf16 v[68:71], v[144:147], a[128:131], v[68:71]
    v_mfma_f32_16x16x32_bf16 v[72:75], v[144:147], a[152:155], v[72:75]
    v_mfma_f32_16x16x32_bf16 v[76:79], v[144:147], a[176:179], v[76:79]
    v_mfma_f32_16x16x32_bf16 v[16:19], v[124:127], a[12:15], v[16:19]
    v_mfma_f32_16x16x32_bf16 v[20:23], v[124:127], a[36:39], v[20:23]
    v_mfma_f32_16x16x32_bf16 v[24:27], v[124:127], a[60:63], v[24:27]
    v_mfma_f32_16x16x32_bf16 v[28:31], v[124:127], a[84:87], v[28:31]
    v_mfma_f32_16x16x32_bf16 v[32:35], v[124:127], a[108:111], v[32:35]
    v_mfma_f32_16x16x32_bf16 v[36:39], v[124:127], a[132:135], v[36:39]
    v_mfma_f32_16x16x32_bf16 v[40:43], v[124:127], a[156:159], v[40:43]
    v_mfma_f32_16x16x32_bf16 v[44:47], v[124:127], a[180:183], v[44:47]
    v_mfma_f32_16x16x32_bf16 v[48:51], v[148:151], a[12:15], v[48:51]
    v_mfma_f32_16x16x32_bf16 v[52:55], v[148:151], a[36:39], v[52:55]
    v_mfma_f32_16x16x32_bf16 v[56:59], v[148:151], a[60:63], v[56:59]
    v_mfma_f32_16x16x32_bf16 v[60:63], v[148:151], a[84:87], v[60:63]
    v_mfma_f32_16x16x32_bf16 v[64:67], v[148:151], a[108:111], v[64:67]
    v_mfma_f32_16x16x32_bf16 v[68:71], v[148:151], a[132:135], v[68:71]
    v_mfma_f32_16x16x32_bf16 v[72:75], v[148:151], a[156:159], v[72:75]
    v_mfma_f32_16x16x32_bf16 v[76:79], v[148:151], a[180:183], v[76:79]
    v_mfma_f32_16x16x32_bf16 v[16:19], v[128:131], a[16:19], v[16:19]
    v_mfma_f32_16x16x32_bf16 v[20:23], v[128:131], a[40:43], v[20:23]
    v_mfma_f32_16x16x32_bf16 v[24:27], v[128:131], a[64:67], v[24:27]
    v_mfma_f32_16x16x32_bf16 v[28:31], v[128:131], a[88:91], v[28:31]
    v_mfma_f32_16x16x32_bf16 v[32:35], v[128:131], a[112:115], v[32:35]
    v_mfma_f32_16x16x32_bf16 v[36:39], v[128:131], a[136:139], v[36:39]
    v_mfma_f32_16x16x32_bf16 v[40:43], v[128:131], a[160:163], v[40:43]
    v_mfma_f32_16x16x32_bf16 v[44:47], v[128:131], a[184:187], v[44:47]
    v_mfma_f32_16x16x32_bf16 v[48:51], v[152:155], a[16:19], v[48:51]
    v_mfma_f32_16x16x32_bf16 v[52:55], v[152:155], a[40:43], v[52:55]
    v_mfma_f32_16x16x32_bf16 v[56:59], v[152:155], a[64:67], v[56:59]
    v_mfma_f32_16x16x32_bf16 v[60:63], v[152:155], a[88:91], v[60:63]
    v_mfma_f32_16x16x32_bf16 v[64:67], v[152:155], a[112:115], v[64:67]
    v_mfma_f32_16x16x32_bf16 v[68:71], v[152:155], a[136:139], v[68:71]
    v_mfma_f32_16x16x32_bf16 v[72:75], v[152:155], a[160:163], v[72:75]
    v_mfma_f32_16x16x32_bf16 v[76:79], v[152:155], a[184:187], v[76:79]
    v_mfma_f32_16x16x32_bf16 v[16:19], v[132:135], a[20:23], v[16:19]
    v_mfma_f32_16x16x32_bf16 v[20:23], v[132:135], a[44:47], v[20:23]
    v_mfma_f32_16x16x32_bf16 v[24:27], v[132:135], a[68:71], v[24:27]
    v_mfma_f32_16x16x32_bf16 v[28:31], v[132:135], a[92:95], v[28:31]
    v_mfma_f32_16x16x32_bf16 v[32:35], v[132:135], a[116:119], v[32:35]
    v_mfma_f32_16x16x32_bf16 v[36:39], v[132:135], a[140:143], v[36:39]
    v_mfma_f32_16x16x32_bf16 v[40:43], v[132:135], a[164:167], v[40:43]
    v_mfma_f32_16x16x32_bf16 v[44:47], v[132:135], a[188:191], v[44:47]
    v_mfma_f32_16x16x32_bf16 v[48:51], v[156:159], a[20:23], v[48:51]
    v_mfma_f32_16x16x32_bf16 v[52:55], v[156:159], a[44:47], v[52:55]
    v_mfma_f32_16x16x32_bf16 v[56:59], v[156:159], a[68:71], v[56:59]
    v_mfma_f32_16x16x32_bf16 v[60:63], v[156:159], a[92:95], v[60:63]
    v_mfma_f32_16x16x32_bf16 v[64:67], v[156:159], a[116:119], v[64:67]
    v_mfma_f32_16x16x32_bf16 v[68:71], v[156:159], a[140:143], v[68:71]
    v_mfma_f32_16x16x32_bf16 v[72:75], v[156:159], a[164:167], v[72:75]
    v_mfma_f32_16x16x32_bf16 v[76:79], v[156:159], a[188:191], v[76:79]
    v_cvt_pk_bf16_f32 v208, v16, v17
    v_cvt_pk_bf16_f32 v209, v18, v19
    v_cvt_pk_bf16_f32 v210, v48, v49
    v_cvt_pk_bf16_f32 v211, v50, v51
    s_add_u32 s45, s52, 0
    buffer_store_dwordx4 v[208:211], v10, s[8:11], s45 offen sc1
    v_cvt_pk_bf16_f32 v212, v20, v21
    v_cvt_pk_bf16_f32 v213, v22, v23
    v_cvt_pk_bf16_f32 v214, v52, v53
    v_cvt_pk_bf16_f32 v215, v54, v55
    s_add_u32 s45, s52, 1024
    buffer_store_dwordx4 v[212:215], v10, s[8:11], s45 offen sc1
    v_cvt_pk_bf16_f32 v216, v24, v25
    v_cvt_pk_bf16_f32 v217, v26, v27
    v_cvt_pk_bf16_f32 v218, v56, v57
    v_cvt_pk_bf16_f32 v219, v58, v59
    s_add_u32 s45, s52, 2048
    buffer_store_dwordx4 v[216:219], v10, s[8:11], s45 offen sc1
    v_cvt_pk_bf16_f32 v220, v28, v29
    v_cvt_pk_bf16_f32 v221, v30, v31
    v_cvt_pk_bf16_f32 v222, v60, v61
    v_cvt_pk_bf16_f32 v223, v62, v63
    s_add_u32 s45, s52, 3072
    buffer_store_dwordx4 v[220:223], v10, s[8:11], s45 offen sc1
    v_cvt_pk_bf16_f32 v224, v32, v33
    v_cvt_pk_bf16_f32 v225, v34, v35
    v_cvt_pk_bf16_f32 v226, v64, v65
    v_cvt_pk_bf16_f32 v227, v66, v67
    s_add_u32 s45, s52, 4096
    buffer_store_dwordx4 v[224:227], v10, s[8:11], s45 offen sc1
    v_cvt_pk_bf16_f32 v228, v36, v37
    v_cvt_pk_bf16_f32 v229, v38, v39
    v_cvt_pk_bf16_f32 v230, v68, v69
    v_cvt_pk_bf16_f32 v231, v70, v71
    s_add_u32 s45, s52, 5120
    buffer_store_dwordx4 v[228:231], v10, s[8:11], s45 offen sc1
    v_cvt_pk_bf16_f32 v232, v40, v41
    v_cvt_pk_bf16_f32 v233, v42, v43
    v_cvt_pk_bf16_f32 v234, v72, v73
    v_cvt_pk_bf16_f32 v235, v74, v75
    s_add_u32 s45, s52, 6144
    buffer_store_dwordx4 v[232:235], v10, s[8:11], s45 offen sc1
    v_cvt_pk_bf16_f32 v236, v44, v45
    v_cvt_pk_bf16_f32 v237, v46, v47
    v_cvt_pk_bf16_f32 v238, v76, v77
    v_cvt_pk_bf16_f32 v239, v78, v79
    s_add_u32 s45, s52, 7168
    buffer_store_dwordx4 v[236:239], v10, s[8:11], s45 offen sc1
    s_add_u32 s45, s51, 786432
    buffer_load_dwordx4 v[112:115], v9, s[16:19], s45 offen offset:0
    buffer_load_dwordx4 v[116:119], v9, s[16:19], s45 offen offset:64
    buffer_load_dwordx4 v[120:123], v9, s[16:19], s45 offen offset:128
    buffer_load_dwordx4 v[124:127], v9, s[16:19], s45 offen offset:192
    buffer_load_dwordx4 v[128:131], v9, s[16:19], s45 offen offset:256
    buffer_load_dwordx4 v[132:135], v9, s[16:19], s45 offen offset:320
    s_add_u32 s45, s51, 835584
    buffer_load_dwordx4 v[136:139], v9, s[16:19], s45 offen offset:0
    buffer_load_dwordx4 v[140:143], v9, s[16:19], s45 offen offset:64
    buffer_load_dwordx4 v[144:147], v9, s[16:19], s45 offen offset:128
    buffer_load_dwordx4 v[148:151], v9, s[16:19], s45 offen offset:192
    buffer_load_dwordx4 v[152:155], v9, s[16:19], s45 offen offset:256
    buffer_load_dwordx4 v[156:159], v9, s[16:19], s45 offen offset:320
    s_waitcnt vmcnt(20)
    v_mfma_f32_16x16x32_bf16 v[16:19], v[160:163], a[0:3], 0
    v_mfma_f32_16x16x32_bf16 v[20:23], v[160:163], a[24:27], 0
    v_mfma_f32_16x16x32_bf16 v[24:27], v[160:163], a[48:51], 0
    v_mfma_f32_16x16x32_bf16 v[28:31], v[160:163], a[72:75], 0
    v_mfma_f32_16x16x32_bf16 v[32:35], v[160:163], a[96:99], 0
    v_mfma_f32_16x16x32_bf16 v[36:39], v[160:163], a[120:123], 0
    v_mfma_f32_16x16x32_bf16 v[40:43], v[160:163], a[144:147], 0
    v_mfma_f32_16x16x32_bf16 v[44:47], v[160:163], a[168:171], 0
    v_mfma_f32_16x16x32_bf16 v[48:51], v[184:187], a[0:3], 0
    v_mfma_f32_16x16x32_bf16 v[52:55], v[184:187], a[24:27], 0
    v_mfma_f32_16x16x32_bf16 v[56:59], v[184:187], a[48:51], 0
    v_mfma_f32_16x16x32_bf16 v[60:63], v[184:187], a[72:75], 0
    v_mfma_f32_16x16x32_bf16 v[64:67], v[184:187], a[96:99], 0
    v_mfma_f32_16x16x32_bf16 v[68:71], v[184:187], a[120:123], 0
    v_mfma_f32_16x16x32_bf16 v[72:75], v[184:187], a[144:147], 0
    v_mfma_f32_16x16x32_bf16 v[76:79], v[184:187], a[168:171], 0
    v_mfma_f32_16x16x32_bf16 v[16:19], v[164:167], a[4:7], v[16:19]
    v_mfma_f32_16x16x32_bf16 v[20:23], v[164:167], a[28:31], v[20:23]
    v_mfma_f32_16x16x32_bf16 v[24:27], v[164:167], a[52:55], v[24:27]
    v_mfma_f32_16x16x32_bf16 v[28:31], v[164:167], a[76:79], v[28:31]
    v_mfma_f32_16x16x32_bf16 v[32:35], v[164:167], a[100:103], v[32:35]
    v_mfma_f32_16x16x32_bf16 v[36:39], v[164:167], a[124:127], v[36:39]
    v_mfma_f32_16x16x32_bf16 v[40:43], v[164:167], a[148:151], v[40:43]
    v_mfma_f32_16x16x32_bf16 v[44:47], v[164:167], a[172:175], v[44:47]
    v_mfma_f32_16x16x32_bf16 v[48:51], v[188:191], a[4:7], v[48:51]
    v_mfma_f32_16x16x32_bf16 v[52:55], v[188:191], a[28:31], v[52:55]
    v_mfma_f32_16x16x32_bf16 v[56:59], v[188:191], a[52:55], v[56:59]
    v_mfma_f32_16x16x32_bf16 v[60:63], v[188:191], a[76:79], v[60:63]
    v_mfma_f32_16x16x32_bf16 v[64:67], v[188:191], a[100:103], v[64:67]
    v_mfma_f32_16x16x32_bf16 v[68:71], v[188:191], a[124:127], v[68:71]
    v_mfma_f32_16x16x32_bf16 v[72:75], v[188:191], a[148:151], v[72:75]
    v_mfma_f32_16x16x32_bf16 v[76:79], v[188:191], a[172:175], v[76:79]
    v_mfma_f32_16x16x32_bf16 v[16:19], v[168:171], a[8:11], v[16:19]
    v_mfma_f32_16x16x32_bf16 v[20:23], v[168:171], a[32:35], v[20:23]
    v_mfma_f32_16x16x32_bf16 v[24:27], v[168:171], a[56:59], v[24:27]
    v_mfma_f32_16x16x32_bf16 v[28:31], v[168:171], a[80:83], v[28:31]
    v_mfma_f32_16x16x32_bf16 v[32:35], v[168:171], a[104:107], v[32:35]
    v_mfma_f32_16x16x32_bf16 v[36:39], v[168:171], a[128:131], v[36:39]
    v_mfma_f32_16x16x32_bf16 v[40:43], v[168:171], a[152:155], v[40:43]
    v_mfma_f32_16x16x32_bf16 v[44:47], v[168:171], a[176:179], v[44:47]
    v_mfma_f32_16x16x32_bf16 v[48:51], v[192:195], a[8:11], v[48:51]
    v_mfma_f32_16x16x32_bf16 v[52:55], v[192:195], a[32:35], v[52:55]
    v_mfma_f32_16x16x32_bf16 v[56:59], v[192:195], a[56:59], v[56:59]
    v_mfma_f32_16x16x32_bf16 v[60:63], v[192:195], a[80:83], v[60:63]
    v_mfma_f32_16x16x32_bf16 v[64:67], v[192:195], a[104:107], v[64:67]
    v_mfma_f32_16x16x32_bf16 v[68:71], v[192:195], a[128:131], v[68:71]
    v_mfma_f32_16x16x32_bf16 v[72:75], v[192:195], a[152:155], v[72:75]
    v_mfma_f32_16x16x32_bf16 v[76:79], v[192:195], a[176:179], v[76:79]
    v_mfma_f32_16x16x32_bf16 v[16:19], v[172:175], a[12:15], v[16:19]
    v_mfma_f32_16x16x32_bf16 v[20:23], v[172:175], a[36:39], v[20:23]
    v_mfma_f32_16x16x32_bf16 v[24:27], v[172:175], a[60:63], v[24:27]
    v_mfma_f32_16x16x32_bf16 v[28:31], v[172:175], a[84:87], v[28:31]
    v_mfma_f32_16x16x32_bf16 v[32:35], v[172:175], a[108:111], v[32:35]
    v_mfma_f32_16x16x32_bf16 v[36:39], v[172:175], a[132:135], v[36:39]
    v_mfma_f32_16x16x32_bf16 v[40:43], v[172:175], a[156:159], v[40:43]
    v_mfma_f32_16x16x32_bf16 v[44:47], v[172:175], a[180:183], v[44:47]
    v_mfma_f32_16x16x32_bf16 v[48:51], v[196:199], a[12:15], v[48:51]
    v_mfma_f32_16x16x32_bf16 v[52:55], v[196:199], a[36:39], v[52:55]
    v_mfma_f32_16x16x32_bf16 v[56:59], v[196:199], a[60:63], v[56:59]
    v_mfma_f32_16x16x32_bf16 v[60:63], v[196:199], a[84:87], v[60:63]
    v_mfma_f32_16x16x32_bf16 v[64:67], v[196:199], a[108:111], v[64:67]
    v_mfma_f32_16x16x32_bf16 v[68:71], v[196:199], a[132:135], v[68:71]
    v_mfma_f32_16x16x32_bf16 v[72:75], v[196:199], a[156:159], v[72:75]
    v_mfma_f32_16x16x32_bf16 v[76:79], v[196:199], a[180:183], v[76:79]
    v_mfma_f32_16x16x32_bf16 v[16:19], v[176:179], a[16:19], v[16:19]
    v_mfma_f32_16x16x32_bf16 v[20:23], v[176:179], a[40:43], v[20:23]
    v_mfma_f32_16x16x32_bf16 v[24:27], v[176:179], a[64:67], v[24:27]
    v_mfma_f32_16x16x32_bf16 v[28:31], v[176:179], a[88:91], v[28:31]
    v_mfma_f32_16x16x32_bf16 v[32:35], v[176:179], a[112:115], v[32:35]
    v_mfma_f32_16x16x32_bf16 v[36:39], v[176:179], a[136:139], v[36:39]
    v_mfma_f32_16x16x32_bf16 v[40:43], v[176:179], a[160:163], v[40:43]
    v_mfma_f32_16x16x32_bf16 v[44:47], v[176:179], a[184:187], v[44:47]
    v_mfma_f32_16x16x32_bf16 v[48:51], v[200:203], a[16:19], v[48:51]
    v_mfma_f32_16x16x32_bf16 v[52:55], v[200:203], a[40:43], v[52:55]
    v_mfma_f32_16x16x32_bf16 v[56:59], v[200:203], a[64:67], v[56:59]
    v_mfma_f32_16x16x32_bf16 v[60:63], v[200:203], a[88:91], v[60:63]
    v_mfma_f32_16x16x32_bf16 v[64:67], v[200:203], a[112:115], v[64:67]
    v_mfma_f32_16x16x32_bf16 v[68:71], v[200:203], a[136:139], v[68:71]
    v_mfma_f32_16x16x32_bf16 v[72:75], v[200:203], a[160:163], v[72:75]
    v_mfma_f32_16x16x32_bf16 v[76:79], v[200:203], a[184:187], v[76:79]
    v_mfma_f32_16x16x32_bf16 v[16:19], v[180:183], a[20:23], v[16:19]
    v_mfma_f32_16x16x32_bf16 v[20:23], v[180:183], a[44:47], v[20:23]
    v_mfma_f32_16x16x32_bf16 v[24:27], v[180:183], a[68:71], v[24:27]
    v_mfma_f32_16x16x32_bf16 v[28:31], v[180:183], a[92:95], v[28:31]
    v_mfma_f32_16x16x32_bf16 v[32:35], v[180:183], a[116:119], v[32:35]
    v_mfma_f32_16x16x32_bf16 v[36:39], v[180:183], a[140:143], v[36:39]
    v_mfma_f32_16x16x32_bf16 v[40:43], v[180:183], a[164:167], v[40:43]
    v_mfma_f32_16x16x32_bf16 v[44:47], v[180:183], a[188:191], v[44:47]
    v_mfma_f32_16x16x32_bf16 v[48:51], v[204:207], a[20:23], v[48:51]
    v_mfma_f32_16x16x32_bf16 v[52:55], v[204:207], a[44:47], v[52:55]
    v_mfma_f32_16x16x32_bf16 v[56:59], v[204:207], a[68:71], v[56:59]
    v_mfma_f32_16x16x32_bf16 v[60:63], v[204:207], a[92:95], v[60:63]
    v_mfma_f32_16x16x32_bf16 v[64:67], v[204:207], a[116:119], v[64:67]
    v_mfma_f32_16x16x32_bf16 v[68:71], v[204:207], a[140:143], v[68:71]
    v_mfma_f32_16x16x32_bf16 v[72:75], v[204:207], a[164:167], v[72:75]
    v_mfma_f32_16x16x32_bf16 v[76:79], v[204:207], a[188:191], v[76:79]
    v_cvt_pk_bf16_f32 v208, v16, v17
    v_cvt_pk_bf16_f32 v209, v18, v19
    v_cvt_pk_bf16_f32 v210, v48, v49
    v_cvt_pk_bf16_f32 v211, v50, v51
    s_add_u32 s45, s52, 40960
    buffer_store_dwordx4 v[208:211], v10, s[8:11], s45 offen sc1
    v_cvt_pk_bf16_f32 v212, v20, v21
    v_cvt_pk_bf16_f32 v213, v22, v23
    v_cvt_pk_bf16_f32 v214, v52, v53
    v_cvt_pk_bf16_f32 v215, v54, v55
    s_add_u32 s45, s52, 41984
    buffer_store_dwordx4 v[212:215], v10, s[8:11], s45 offen sc1
    v_cvt_pk_bf16_f32 v216, v24, v25
    v_cvt_pk_bf16_f32 v217, v26, v27
    v_cvt_pk_bf16_f32 v218, v56, v57
    v_cvt_pk_bf16_f32 v219, v58, v59
    s_add_u32 s45, s52, 43008
    buffer_store_dwordx4 v[216:219], v10, s[8:11], s45 offen sc1
    v_cvt_pk_bf16_f32 v220, v28, v29
    v_cvt_pk_bf16_f32 v221, v30, v31
    v_cvt_pk_bf16_f32 v222, v60, v61
    v_cvt_pk_bf16_f32 v223, v62, v63
    s_add_u32 s45, s52, 44032
    buffer_store_dwordx4 v[220:223], v10, s[8:11], s45 offen sc1
    v_cvt_pk_bf16_f32 v224, v32, v33
    v_cvt_pk_bf16_f32 v225, v34, v35
    v_cvt_pk_bf16_f32 v226, v64, v65
    v_cvt_pk_bf16_f32 v227, v66, v67
    s_add_u32 s45, s52, 45056
    buffer_store_dwordx4 v[224:227], v10, s[8:11], s45 offen sc1
    v_cvt_pk_bf16_f32 v228, v36, v37
    v_cvt_pk_bf16_f32 v229, v38, v39
    v_cvt_pk_bf16_f32 v230, v68, v69
    v_cvt_pk_bf16_f32 v231, v70, v71
    s_add_u32 s45, s52, 46080
    buffer_store_dwordx4 v[228:231], v10, s[8:11], s45 offen sc1
    v_cvt_pk_bf16_f32 v232, v40, v41
    v_cvt_pk_bf16_f32 v233, v42, v43
    v_cvt_pk_bf16_f32 v234, v72, v73
    v_cvt_pk_bf16_f32 v235, v74, v75
    s_add_u32 s45, s52, 47104
    buffer_store_dwordx4 v[232:235], v10, s[8:11], s45 offen sc1
    v_cvt_pk_bf16_f32 v236, v44, v45
    v_cvt_pk_bf16_f32 v237, v46, v47
    v_cvt_pk_bf16_f32 v238, v76, v77
    v_cvt_pk_bf16_f32 v239, v78, v79
    s_add_u32 s45, s52, 48128
    buffer_store_dwordx4 v[236:239], v10, s[8:11], s45 offen sc1
    s_add_u32 s45, s51, 1179648
    buffer_load_dwordx4 v[160:163], v9, s[16:19], s45 offen offset:0
    buffer_load_dwordx4 v[164:167], v9, s[16:19], s45 offen offset:64
    buffer_load_dwordx4 v[168:171], v9, s[16:19], s45 offen offset:128
    buffer_load_dwordx4 v[172:175], v9, s[16:19], s45 offen offset:192
    buffer_load_dwordx4 v[176:179], v9, s[16:19], s45 offen offset:256
    buffer_load_dwordx4 v[180:183], v9, s[16:19], s45 offen offset:320
    s_add_u32 s45, s51, 1228800
    buffer_load_dwordx4 v[184:187], v9, s[16:19], s45 offen offset:0
    buffer_load_dwordx4 v[188:191], v9, s[16:19], s45 offen offset:64
    buffer_load_dwordx4 v[192:195], v9, s[16:19], s45 offen offset:128
    buffer_load_dwordx4 v[196:199], v9, s[16:19], s45 offen offset:192
    buffer_load_dwordx4 v[200:203], v9, s[16:19], s45 offen offset:256
    buffer_load_dwordx4 v[204:207], v9, s[16:19], s45 offen offset:320
    s_waitcnt vmcnt(20)
    v_mfma_f32_16x16x32_bf16 v[16:19], v[112:115], a[0:3], 0
    v_mfma_f32_16x16x32_bf16 v[20:23], v[112:115], a[24:27], 0
    v_mfma_f32_16x16x32_bf16 v[24:27], v[112:115], a[48:51], 0
    v_mfma_f32_16x16x32_bf16 v[28:31], v[112:115], a[72:75], 0
    v_mfma_f32_16x16x32_bf16 v[32:35], v[112:115], a[96:99], 0
    v_mfma_f32_16x16x32_bf16 v[36:39], v[112:115], a[120:123], 0
    v_mfma_f32_16x16x32_bf16 v[40:43], v[112:115], a[144:147], 0
    v_mfma_f32_16x16x32_bf16 v[44:47], v[112:115], a[168:171], 0
    v_mfma_f32_16x16x32_bf16 v[48:51], v[136:139], a[0:3], 0
    v_mfma_f32_16x16x32_bf16 v[52:55], v[136:139], a[24:27], 0
    v_mfma_f32_16x16x32_bf16 v[56:59], v[136:139], a[48:51], 0
    v_mfma_f32_16x16x32_bf16 v[60:63], v[136:139], a[72:75], 0
    v_mfma_f32_16x16x32_bf16 v[64:67], v[136:139], a[96:99], 0
    v_mfma_f32_16x16x32_bf16 v[68:71], v[136:139], a[120:123], 0
    v_mfma_f32_16x16x32_bf16 v[72:75], v[136:139], a[144:147], 0
    v_mfma_f32_16x16x32_bf16 v[76:79], v[136:139], a[168:171], 0
    v_mfma_f32_16x16x32_bf16 v[16:19], v[116:119], a[4:7], v[16:19]
    v_mfma_f32_16x16x32_bf16 v[20:23], v[116:119], a[28:31], v[20:23]
    v_mfma_f32_16x16x32_bf16 v[24:27], v[116:119], a[52:55], v[24:27]
    v_mfma_f32_16x16x32_bf16 v[28:31], v[116:119], a[76:79], v[28:31]
    v_mfma_f32_16x16x32_bf16 v[32:35], v[116:119], a[100:103], v[32:35]
    v_mfma_f32_16x16x32_bf16 v[36:39], v[116:119], a[124:127], v[36:39]
    v_mfma_f32_16x16x32_bf16 v[40:43], v[116:119], a[148:151], v[40:43]
    v_mfma_f32_16x16x32_bf16 v[44:47], v[116:119], a[172:175], v[44:47]
    v_mfma_f32_16x16x32_bf16 v[48:51], v[140:143], a[4:7], v[48:51]
    v_mfma_f32_16x16x32_bf16 v[52:55], v[140:143], a[28:31], v[52:55]
    v_mfma_f32_16x16x32_bf16 v[56:59], v[140:143], a[52:55], v[56:59]
    v_mfma_f32_16x16x32_bf16 v[60:63], v[140:143], a[76:79], v[60:63]
    v_mfma_f32_16x16x32_bf16 v[64:67], v[140:143], a[100:103], v[64:67]
    v_mfma_f32_16x16x32_bf16 v[68:71], v[140:143], a[124:127], v[68:71]
    v_mfma_f32_16x16x32_bf16 v[72:75], v[140:143], a[148:151], v[72:75]
    v_mfma_f32_16x16x32_bf16 v[76:79], v[140:143], a[172:175], v[76:79]
    v_mfma_f32_16x16x32_bf16 v[16:19], v[120:123], a[8:11], v[16:19]
    v_mfma_f32_16x16x32_bf16 v[20:23], v[120:123], a[32:35], v[20:23]
    v_mfma_f32_16x16x32_bf16 v[24:27], v[120:123], a[56:59], v[24:27]
    v_mfma_f32_16x16x32_bf16 v[28:31], v[120:123], a[80:83], v[28:31]
    v_mfma_f32_16x16x32_bf16 v[32:35], v[120:123], a[104:107], v[32:35]
    v_mfma_f32_16x16x32_bf16 v[36:39], v[120:123], a[128:131], v[36:39]
    v_mfma_f32_16x16x32_bf16 v[40:43], v[120:123], a[152:155], v[40:43]
    v_mfma_f32_16x16x32_bf16 v[44:47], v[120:123], a[176:179], v[44:47]
    v_mfma_f32_16x16x32_bf16 v[48:51], v[144:147], a[8:11], v[48:51]
    v_mfma_f32_16x16x32_bf16 v[52:55], v[144:147], a[32:35], v[52:55]
    v_mfma_f32_16x16x32_bf16 v[56:59], v[144:147], a[56:59], v[56:59]
    v_mfma_f32_16x16x32_bf16 v[60:63], v[144:147], a[80:83], v[60:63]
    v_mfma_f32_16x16x32_bf16 v[64:67], v[144:147], a[104:107], v[64:67]
    v_mfma_f32_16x16x32_bf16 v[68:71], v[144:147], a[128:131], v[68:71]
    v_mfma_f32_16x16x32_bf16 v[72:75], v[144:147], a[152:155], v[72:75]
    v_mfma_f32_16x16x32_bf16 v[76:79], v[144:147], a[176:179], v[76:79]
    v_mfma_f32_16x16x32_bf16 v[16:19], v[124:127], a[12:15], v[16:19]
    v_mfma_f32_16x16x32_bf16 v[20:23], v[124:127], a[36:39], v[20:23]
    v_mfma_f32_16x16x32_bf16 v[24:27], v[124:127], a[60:63], v[24:27]
    v_mfma_f32_16x16x32_bf16 v[28:31], v[124:127], a[84:87], v[28:31]
    v_mfma_f32_16x16x32_bf16 v[32:35], v[124:127], a[108:111], v[32:35]
    v_mfma_f32_16x16x32_bf16 v[36:39], v[124:127], a[132:135], v[36:39]
    v_mfma_f32_16x16x32_bf16 v[40:43], v[124:127], a[156:159], v[40:43]
    v_mfma_f32_16x16x32_bf16 v[44:47], v[124:127], a[180:183], v[44:47]
    v_mfma_f32_16x16x32_bf16 v[48:51], v[148:151], a[12:15], v[48:51]
    v_mfma_f32_16x16x32_bf16 v[52:55], v[148:151], a[36:39], v[52:55]
    v_mfma_f32_16x16x32_bf16 v[56:59], v[148:151], a[60:63], v[56:59]
    v_mfma_f32_16x16x32_bf16 v[60:63], v[148:151], a[84:87], v[60:63]
    v_mfma_f32_16x16x32_bf16 v[64:67], v[148:151], a[108:111], v[64:67]
    v_mfma_f32_16x16x32_bf16 v[68:71], v[148:151], a[132:135], v[68:71]
    v_mfma_f32_16x16x32_bf16 v[72:75], v[148:151], a[156:159], v[72:75]
    v_mfma_f32_16x16x32_bf16 v[76:79], v[148:151], a[180:183], v[76:79]
    v_mfma_f32_16x16x32_bf16 v[16:19], v[128:131], a[16:19], v[16:19]
    v_mfma_f32_16x16x32_bf16 v[20:23], v[128:131], a[40:43], v[20:23]
    v_mfma_f32_16x16x32_bf16 v[24:27], v[128:131], a[64:67], v[24:27]
    v_mfma_f32_16x16x32_bf16 v[28:31], v[128:131], a[88:91], v[28:31]
    v_mfma_f32_16x16x32_bf16 v[32:35], v[128:131], a[112:115], v[32:35]
    v_mfma_f32_16x16x32_bf16 v[36:39], v[128:131], a[136:139], v[36:39]
    v_mfma_f32_16x16x32_bf16 v[40:43], v[128:131], a[160:163], v[40:43]
    v_mfma_f32_16x16x32_bf16 v[44:47], v[128:131], a[184:187], v[44:47]
    v_mfma_f32_16x16x32_bf16 v[48:51], v[152:155], a[16:19], v[48:51]
    v_mfma_f32_16x16x32_bf16 v[52:55], v[152:155], a[40:43], v[52:55]
    v_mfma_f32_16x16x32_bf16 v[56:59], v[152:155], a[64:67], v[56:59]
    v_mfma_f32_16x16x32_bf16 v[60:63], v[152:155], a[88:91], v[60:63]
    v_mfma_f32_16x16x32_bf16 v[64:67], v[152:155], a[112:115], v[64:67]
    v_mfma_f32_16x16x32_bf16 v[68:71], v[152:155], a[136:139], v[68:71]
    v_mfma_f32_16x16x32_bf16 v[72:75], v[152:155], a[160:163], v[72:75]
    v_mfma_f32_16x16x32_bf16 v[76:79], v[152:155], a[184:187], v[76:79]
    v_mfma_f32_16x16x32_bf16 v[16:19], v[132:135], a[20:23], v[16:19]
    v_mfma_f32_16x16x32_bf16 v[20:23], v[132:135], a[44:47], v[20:23]
    v_mfma_f32_16x16x32_bf16 v[24:27], v[132:135], a[68:71], v[24:27]
    v_mfma_f32_16x16x32_bf16 v[28:31], v[132:135], a[92:95], v[28:31]
    v_mfma_f32_16x16x32_bf16 v[32:35], v[132:135], a[116:119], v[32:35]
    v_mfma_f32_16x16x32_bf16 v[36:39], v[132:135], a[140:143], v[36:39]
    v_mfma_f32_16x16x32_bf16 v[40:43], v[132:135], a[164:167], v[40:43]
    v_mfma_f32_16x16x32_bf16 v[44:47], v[132:135], a[188:191], v[44:47]
    v_mfma_f32_16x16x32_bf16 v[48:51], v[156:159], a[20:23], v[48:51]
    v_mfma_f32_16x16x32_bf16 v[52:55], v[156:159], a[44:47], v[52:55]
    v_mfma_f32_16x16x32_bf16 v[56:59], v[156:159], a[68:71], v[56:59]
    v_mfma_f32_16x16x32_bf16 v[60:63], v[156:159], a[92:95], v[60:63]
    v_mfma_f32_16x16x32_bf16 v[64:67], v[156:159], a[116:119], v[64:67]
    v_mfma_f32_16x16x32_bf16 v[68:71], v[156:159], a[140:143], v[68:71]
    v_mfma_f32_16x16x32_bf16 v[72:75], v[156:159], a[164:167], v[72:75]
    v_mfma_f32_16x16x32_bf16 v[76:79], v[156:159], a[188:191], v[76:79]
    v_cvt_pk_bf16_f32 v208, v16, v17
    v_cvt_pk_bf16_f32 v209, v18, v19
    v_cvt_pk_bf16_f32 v210, v48, v49
    v_cvt_pk_bf16_f32 v211, v50, v51
    s_add_u32 s45, s52, 81920
    buffer_store_dwordx4 v[208:211], v10, s[8:11], s45 offen sc1
    v_cvt_pk_bf16_f32 v212, v20, v21
    v_cvt_pk_bf16_f32 v213, v22, v23
    v_cvt_pk_bf16_f32 v214, v52, v53
    v_cvt_pk_bf16_f32 v215, v54, v55
    s_add_u32 s45, s52, 82944
    buffer_store_dwordx4 v[212:215], v10, s[8:11], s45 offen sc1
    v_cvt_pk_bf16_f32 v216, v24, v25
    v_cvt_pk_bf16_f32 v217, v26, v27
    v_cvt_pk_bf16_f32 v218, v56, v57
    v_cvt_pk_bf16_f32 v219, v58, v59
    s_add_u32 s45, s52, 83968
    buffer_store_dwordx4 v[216:219], v10, s[8:11], s45 offen sc1
    v_cvt_pk_bf16_f32 v220, v28, v29
    v_cvt_pk_bf16_f32 v221, v30, v31
    v_cvt_pk_bf16_f32 v222, v60, v61
    v_cvt_pk_bf16_f32 v223, v62, v63
    s_add_u32 s45, s52, 84992
    buffer_store_dwordx4 v[220:223], v10, s[8:11], s45 offen sc1
    v_cvt_pk_bf16_f32 v224, v32, v33
    v_cvt_pk_bf16_f32 v225, v34, v35
    v_cvt_pk_bf16_f32 v226, v64, v65
    v_cvt_pk_bf16_f32 v227, v66, v67
    s_add_u32 s45, s52, 86016
    buffer_store_dwordx4 v[224:227], v10, s[8:11], s45 offen sc1
    v_cvt_pk_bf16_f32 v228, v36, v37
    v_cvt_pk_bf16_f32 v229, v38, v39
    v_cvt_pk_bf16_f32 v230, v68, v69
    v_cvt_pk_bf16_f32 v231, v70, v71
    s_add_u32 s45, s52, 87040
    buffer_store_dwordx4 v[228:231], v10, s[8:11], s45 offen sc1
    v_cvt_pk_bf16_f32 v232, v40, v41
    v_cvt_pk_bf16_f32 v233, v42, v43
    v_cvt_pk_bf16_f32 v234, v72, v73
    v_cvt_pk_bf16_f32 v235, v74, v75
    s_add_u32 s45, s52, 88064
    buffer_store_dwordx4 v[232:235], v10, s[8:11], s45 offen sc1
    v_cvt_pk_bf16_f32 v236, v44, v45
    v_cvt_pk_bf16_f32 v237, v46, v47
    v_cvt_pk_bf16_f32 v238, v76, v77
    v_cvt_pk_bf16_f32 v239, v78, v79
    s_add_u32 s45, s52, 89088
    buffer_store_dwordx4 v[236:239], v10, s[8:11], s45 offen sc1
    s_add_u32 s45, s51, 1572864
    buffer_load_dwordx4 v[112:115], v9, s[16:19], s45 offen offset:0
    buffer_load_dwordx4 v[116:119], v9, s[16:19], s45 offen offset:64
    buffer_load_dwordx4 v[120:123], v9, s[16:19], s45 offen offset:128
    buffer_load_dwordx4 v[124:127], v9, s[16:19], s45 offen offset:192
    buffer_load_dwordx4 v[128:131], v9, s[16:19], s45 offen offset:256
    buffer_load_dwordx4 v[132:135], v9, s[16:19], s45 offen offset:320
    s_add_u32 s45, s51, 1622016
    buffer_load_dwordx4 v[136:139], v9, s[16:19], s45 offen offset:0
    buffer_load_dwordx4 v[140:143], v9, s[16:19], s45 offen offset:64
    buffer_load_dwordx4 v[144:147], v9, s[16:19], s45 offen offset:128
    buffer_load_dwordx4 v[148:151], v9, s[16:19], s45 offen offset:192
    buffer_load_dwordx4 v[152:155], v9, s[16:19], s45 offen offset:256
    buffer_load_dwordx4 v[156:159], v9, s[16:19], s45 offen offset:320
    s_waitcnt vmcnt(20)
    v_mfma_f32_16x16x32_bf16 v[16:19], v[160:163], a[0:3], 0
    v_mfma_f32_16x16x32_bf16 v[20:23], v[160:163], a[24:27], 0
    v_mfma_f32_16x16x32_bf16 v[24:27], v[160:163], a[48:51], 0
    v_mfma_f32_16x16x32_bf16 v[28:31], v[160:163], a[72:75], 0
    v_mfma_f32_16x16x32_bf16 v[32:35], v[160:163], a[96:99], 0
    v_mfma_f32_16x16x32_bf16 v[36:39], v[160:163], a[120:123], 0
    v_mfma_f32_16x16x32_bf16 v[40:43], v[160:163], a[144:147], 0
    v_mfma_f32_16x16x32_bf16 v[44:47], v[160:163], a[168:171], 0
    v_mfma_f32_16x16x32_bf16 v[48:51], v[184:187], a[0:3], 0
    v_mfma_f32_16x16x32_bf16 v[52:55], v[184:187], a[24:27], 0
    v_mfma_f32_16x16x32_bf16 v[56:59], v[184:187], a[48:51], 0
    v_mfma_f32_16x16x32_bf16 v[60:63], v[184:187], a[72:75], 0
    v_mfma_f32_16x16x32_bf16 v[64:67], v[184:187], a[96:99], 0
    v_mfma_f32_16x16x32_bf16 v[68:71], v[184:187], a[120:123], 0
    v_mfma_f32_16x16x32_bf16 v[72:75], v[184:187], a[144:147], 0
    v_mfma_f32_16x16x32_bf16 v[76:79], v[184:187], a[168:171], 0
    v_mfma_f32_16x16x32_bf16 v[16:19], v[164:167], a[4:7], v[16:19]
    v_mfma_f32_16x16x32_bf16 v[20:23], v[164:167], a[28:31], v[20:23]
    v_mfma_f32_16x16x32_bf16 v[24:27], v[164:167], a[52:55], v[24:27]
    v_mfma_f32_16x16x32_bf16 v[28:31], v[164:167], a[76:79], v[28:31]
    v_mfma_f32_16x16x32_bf16 v[32:35], v[164:167], a[100:103], v[32:35]
    v_mfma_f32_16x16x32_bf16 v[36:39], v[164:167], a[124:127], v[36:39]
    v_mfma_f32_16x16x32_bf16 v[40:43], v[164:167], a[148:151], v[40:43]
    v_mfma_f32_16x16x32_bf16 v[44:47], v[164:167], a[172:175], v[44:47]
    v_mfma_f32_16x16x32_bf16 v[48:51], v[188:191], a[4:7], v[48:51]
    v_mfma_f32_16x16x32_bf16 v[52:55], v[188:191], a[28:31], v[52:55]
    v_mfma_f32_16x16x32_bf16 v[56:59], v[188:191], a[52:55], v[56:59]
    v_mfma_f32_16x16x32_bf16 v[60:63], v[188:191], a[76:79], v[60:63]
    v_mfma_f32_16x16x32_bf16 v[64:67], v[188:191], a[100:103], v[64:67]
    v_mfma_f32_16x16x32_bf16 v[68:71], v[188:191], a[124:127], v[68:71]
    v_mfma_f32_16x16x32_bf16 v[72:75], v[188:191], a[148:151], v[72:75]
    v_mfma_f32_16x16x32_bf16 v[76:79], v[188:191], a[172:175], v[76:79]
    v_mfma_f32_16x16x32_bf16 v[16:19], v[168:171], a[8:11], v[16:19]
    v_mfma_f32_16x16x32_bf16 v[20:23], v[168:171], a[32:35], v[20:23]
    v_mfma_f32_16x16x32_bf16 v[24:27], v[168:171], a[56:59], v[24:27]
    v_mfma_f32_16x16x32_bf16 v[28:31], v[168:171], a[80:83], v[28:31]
    v_mfma_f32_16x16x32_bf16 v[32:35], v[168:171], a[104:107], v[32:35]
    v_mfma_f32_16x16x32_bf16 v[36:39], v[168:171], a[128:131], v[36:39]
    v_mfma_f32_16x16x32_bf16 v[40:43], v[168:171], a[152:155], v[40:43]
    v_mfma_f32_16x16x32_bf16 v[44:47], v[168:171], a[176:179], v[44:47]
    v_mfma_f32_16x16x32_bf16 v[48:51], v[192:195], a[8:11], v[48:51]
    v_mfma_f32_16x16x32_bf16 v[52:55], v[192:195], a[32:35], v[52:55]
    v_mfma_f32_16x16x32_bf16 v[56:59], v[192:195], a[56:59], v[56:59]
    v_mfma_f32_16x16x32_bf16 v[60:63], v[192:195], a[80:83], v[60:63]
    v_mfma_f32_16x16x32_bf16 v[64:67], v[192:195], a[104:107], v[64:67]
    v_mfma_f32_16x16x32_bf16 v[68:71], v[192:195], a[128:131], v[68:71]
    v_mfma_f32_16x16x32_bf16 v[72:75], v[192:195], a[152:155], v[72:75]
    v_mfma_f32_16x16x32_bf16 v[76:79], v[192:195], a[176:179], v[76:79]
    v_mfma_f32_16x16x32_bf16 v[16:19], v[172:175], a[12:15], v[16:19]
    v_mfma_f32_16x16x32_bf16 v[20:23], v[172:175], a[36:39], v[20:23]
    v_mfma_f32_16x16x32_bf16 v[24:27], v[172:175], a[60:63], v[24:27]
    v_mfma_f32_16x16x32_bf16 v[28:31], v[172:175], a[84:87], v[28:31]
    v_mfma_f32_16x16x32_bf16 v[32:35], v[172:175], a[108:111], v[32:35]
    v_mfma_f32_16x16x32_bf16 v[36:39], v[172:175], a[132:135], v[36:39]
    v_mfma_f32_16x16x32_bf16 v[40:43], v[172:175], a[156:159], v[40:43]
    v_mfma_f32_16x16x32_bf16 v[44:47], v[172:175], a[180:183], v[44:47]
    v_mfma_f32_16x16x32_bf16 v[48:51], v[196:199], a[12:15], v[48:51]
    v_mfma_f32_16x16x32_bf16 v[52:55], v[196:199], a[36:39], v[52:55]
    v_mfma_f32_16x16x32_bf16 v[56:59], v[196:199], a[60:63], v[56:59]
    v_mfma_f32_16x16x32_bf16 v[60:63], v[196:199], a[84:87], v[60:63]
    v_mfma_f32_16x16x32_bf16 v[64:67], v[196:199], a[108:111], v[64:67]
    v_mfma_f32_16x16x32_bf16 v[68:71], v[196:199], a[132:135], v[68:71]
    v_mfma_f32_16x16x32_bf16 v[72:75], v[196:199], a[156:159], v[72:75]
    v_mfma_f32_16x16x32_bf16 v[76:79], v[196:199], a[180:183], v[76:79]
    v_mfma_f32_16x16x32_bf16 v[16:19], v[176:179], a[16:19], v[16:19]
    v_mfma_f32_16x16x32_bf16 v[20:23], v[176:179], a[40:43], v[20:23]
    v_mfma_f32_16x16x32_bf16 v[24:27], v[176:179], a[64:67], v[24:27]
    v_mfma_f32_16x16x32_bf16 v[28:31], v[176:179], a[88:91], v[28:31]
    v_mfma_f32_16x16x32_bf16 v[32:35], v[176:179], a[112:115], v[32:35]
    v_mfma_f32_16x16x32_bf16 v[36:39], v[176:179], a[136:139], v[36:39]
    v_mfma_f32_16x16x32_bf16 v[40:43], v[176:179], a[160:163], v[40:43]
    v_mfma_f32_16x16x32_bf16 v[44:47], v[176:179], a[184:187], v[44:47]
    v_mfma_f32_16x16x32_bf16 v[48:51], v[200:203], a[16:19], v[48:51]
    v_mfma_f32_16x16x32_bf16 v[52:55], v[200:203], a[40:43], v[52:55]
    v_mfma_f32_16x16x32_bf16 v[56:59], v[200:203], a[64:67], v[56:59]
    v_mfma_f32_16x16x32_bf16 v[60:63], v[200:203], a[88:91], v[60:63]
    v_mfma_f32_16x16x32_bf16 v[64:67], v[200:203], a[112:115], v[64:67]
    v_mfma_f32_16x16x32_bf16 v[68:71], v[200:203], a[136:139], v[68:71]
    v_mfma_f32_16x16x32_bf16 v[72:75], v[200:203], a[160:163], v[72:75]
    v_mfma_f32_16x16x32_bf16 v[76:79], v[200:203], a[184:187], v[76:79]
    v_mfma_f32_16x16x32_bf16 v[16:19], v[180:183], a[20:23], v[16:19]
    v_mfma_f32_16x16x32_bf16 v[20:23], v[180:183], a[44:47], v[20:23]
    v_mfma_f32_16x16x32_bf16 v[24:27], v[180:183], a[68:71], v[24:27]
    v_mfma_f32_16x16x32_bf16 v[28:31], v[180:183], a[92:95], v[28:31]
    v_mfma_f32_16x16x32_bf16 v[32:35], v[180:183], a[116:119], v[32:35]
    v_mfma_f32_16x16x32_bf16 v[36:39], v[180:183], a[140:143], v[36:39]
    v_mfma_f32_16x16x32_bf16 v[40:43], v[180:183], a[164:167], v[40:43]
    v_mfma_f32_16x16x32_bf16 v[44:47], v[180:183], a[188:191], v[44:47]
    v_mfma_f32_16x16x32_bf16 v[48:51], v[204:207], a[20:23], v[48:51]
    v_mfma_f32_16x16x32_bf16 v[52:55], v[204:207], a[44:47], v[52:55]
    v_mfma_f32_16x16x32_bf16 v[56:59], v[204:207], a[68:71], v[56:59]
    v_mfma_f32_16x16x32_bf16 v[60:63], v[204:207], a[92:95], v[60:63]
    v_mfma_f32_16x16x32_bf16 v[64:67], v[204:207], a[116:119], v[64:67]
    v_mfma_f32_16x16x32_bf16 v[68:71], v[204:207], a[140:143], v[68:71]
    v_mfma_f32_16x16x32_bf16 v[72:75], v[204:207], a[164:167], v[72:75]
    v_mfma_f32_16x16x32_bf16 v[76:79], v[204:207], a[188:191], v[76:79]
    v_cvt_pk_bf16_f32 v208, v16, v17
    v_cvt_pk_bf16_f32 v209, v18, v19
    v_cvt_pk_bf16_f32 v210, v48, v49
    v_cvt_pk_bf16_f32 v211, v50, v51
    s_add_u32 s45, s52, 122880
    buffer_store_dwordx4 v[208:211], v10, s[8:11], s45 offen sc1
    v_cvt_pk_bf16_f32 v212, v20, v21
    v_cvt_pk_bf16_f32 v213, v22, v23
    v_cvt_pk_bf16_f32 v214, v52, v53
    v_cvt_pk_bf16_f32 v215, v54, v55
    s_add_u32 s45, s52, 123904
    buffer_store_dwordx4 v[212:215], v10, s[8:11], s45 offen sc1
    v_cvt_pk_bf16_f32 v216, v24, v25
    v_cvt_pk_bf16_f32 v217, v26, v27
    v_cvt_pk_bf16_f32 v218, v56, v57
    v_cvt_pk_bf16_f32 v219, v58, v59
    s_add_u32 s45, s52, 124928
    buffer_store_dwordx4 v[216:219], v10, s[8:11], s45 offen sc1
    v_cvt_pk_bf16_f32 v220, v28, v29
    v_cvt_pk_bf16_f32 v221, v30, v31
    v_cvt_pk_bf16_f32 v222, v60, v61
    v_cvt_pk_bf16_f32 v223, v62, v63
    s_add_u32 s45, s52, 125952
    buffer_store_dwordx4 v[220:223], v10, s[8:11], s45 offen sc1
    v_cvt_pk_bf16_f32 v224, v32, v33
    v_cvt_pk_bf16_f32 v225, v34, v35
    v_cvt_pk_bf16_f32 v226, v64, v65
    v_cvt_pk_bf16_f32 v227, v66, v67
    s_add_u32 s45, s52, 126976
    buffer_store_dwordx4 v[224:227], v10, s[8:11], s45 offen sc1
    v_cvt_pk_bf16_f32 v228, v36, v37
    v_cvt_pk_bf16_f32 v229, v38, v39
    v_cvt_pk_bf16_f32 v230, v68, v69
    v_cvt_pk_bf16_f32 v231, v70, v71
    s_add_u32 s45, s52, 128000
    buffer_store_dwordx4 v[228:231], v10, s[8:11], s45 offen sc1
    v_cvt_pk_bf16_f32 v232, v40, v41
    v_cvt_pk_bf16_f32 v233, v42, v43
    v_cvt_pk_bf16_f32 v234, v72, v73
    v_cvt_pk_bf16_f32 v235, v74, v75
    s_add_u32 s45, s52, 129024
    buffer_store_dwordx4 v[232:235], v10, s[8:11], s45 offen sc1
    v_cvt_pk_bf16_f32 v236, v44, v45
    v_cvt_pk_bf16_f32 v237, v46, v47
    v_cvt_pk_bf16_f32 v238, v76, v77
    v_cvt_pk_bf16_f32 v239, v78, v79
    s_add_u32 s45, s52, 130048
    buffer_store_dwordx4 v[236:239], v10, s[8:11], s45 offen sc1
    s_waitcnt vmcnt(8)
    v_mfma_f32_16x16x32_bf16 v[16:19], v[112:115], a[0:3], 0
    v_mfma_f32_16x16x32_bf16 v[20:23], v[112:115], a[24:27], 0
    v_mfma_f32_16x16x32_bf16 v[24:27], v[112:115], a[48:51], 0
    v_mfma_f32_16x16x32_bf16 v[28:31], v[112:115], a[72:75], 0
    v_mfma_f32_16x16x32_bf16 v[32:35], v[112:115], a[96:99], 0
    v_mfma_f32_16x16x32_bf16 v[36:39], v[112:115], a[120:123], 0
    v_mfma_f32_16x16x32_bf16 v[40:43], v[112:115], a[144:147], 0
    v_mfma_f32_16x16x32_bf16 v[44:47], v[112:115], a[168:171], 0
    v_mfma_f32_16x16x32_bf16 v[48:51], v[136:139], a[0:3], 0
    v_mfma_f32_16x16x32_bf16 v[52:55], v[136:139], a[24:27], 0
    v_mfma_f32_16x16x32_bf16 v[56:59], v[136:139], a[48:51], 0
    v_mfma_f32_16x16x32_bf16 v[60:63], v[136:139], a[72:75], 0
    v_mfma_f32_16x16x32_bf16 v[64:67], v[136:139], a[96:99], 0
    v_mfma_f32_16x16x32_bf16 v[68:71], v[136:139], a[120:123], 0
    v_mfma_f32_16x16x32_bf16 v[72:75], v[136:139], a[144:147], 0
    v_mfma_f32_16x16x32_bf16 v[76:79], v[136:139], a[168:171], 0
    v_mfma_f32_16x16x32_bf16 v[16:19], v[116:119], a[4:7], v[16:19]
    v_mfma_f32_16x16x32_bf16 v[20:23], v[116:119], a[28:31], v[20:23]
    v_mfma_f32_16x16x32_bf16 v[24:27], v[116:119], a[52:55], v[24:27]
    v_mfma_f32_16x16x32_bf16 v[28:31], v[116:119], a[76:79], v[28:31]
    v_mfma_f32_16x16x32_bf16 v[32:35], v[116:119], a[100:103], v[32:35]
    v_mfma_f32_16x16x32_bf16 v[36:39], v[116:119], a[124:127], v[36:39]
    v_mfma_f32_16x16x32_bf16 v[40:43], v[116:119], a[148:151], v[40:43]
    v_mfma_f32_16x16x32_bf16 v[44:47], v[116:119], a[172:175], v[44:47]
    v_mfma_f32_16x16x32_bf16 v[48:51], v[140:143], a[4:7], v[48:51]
    v_mfma_f32_16x16x32_bf16 v[52:55], v[140:143], a[28:31], v[52:55]
    v_mfma_f32_16x16x32_bf16 v[56:59], v[140:143], a[52:55], v[56:59]
    v_mfma_f32_16x16x32_bf16 v[60:63], v[140:143], a[76:79], v[60:63]
    v_mfma_f32_16x16x32_bf16 v[64:67], v[140:143], a[100:103], v[64:67]
    v_mfma_f32_16x16x32_bf16 v[68:71], v[140:143], a[124:127], v[68:71]
    v_mfma_f32_16x16x32_bf16 v[72:75], v[140:143], a[148:151], v[72:75]
    v_mfma_f32_16x16x32_bf16 v[76:79], v[140:143], a[172:175], v[76:79]
    v_mfma_f32_16x16x32_bf16 v[16:19], v[120:123], a[8:11], v[16:19]
    v_mfma_f32_16x16x32_bf16 v[20:23], v[120:123], a[32:35], v[20:23]
    v_mfma_f32_16x16x32_bf16 v[24:27], v[120:123], a[56:59], v[24:27]
    v_mfma_f32_16x16x32_bf16 v[28:31], v[120:123], a[80:83], v[28:31]
    v_mfma_f32_16x16x32_bf16 v[32:35], v[120:123], a[104:107], v[32:35]
    v_mfma_f32_16x16x32_bf16 v[36:39], v[120:123], a[128:131], v[36:39]
    v_mfma_f32_16x16x32_bf16 v[40:43], v[120:123], a[152:155], v[40:43]
    v_mfma_f32_16x16x32_bf16 v[44:47], v[120:123], a[176:179], v[44:47]
    v_mfma_f32_16x16x32_bf16 v[48:51], v[144:147], a[8:11], v[48:51]
    v_mfma_f32_16x16x32_bf16 v[52:55], v[144:147], a[32:35], v[52:55]
    v_mfma_f32_16x16x32_bf16 v[56:59], v[144:147], a[56:59], v[56:59]
    v_mfma_f32_16x16x32_bf16 v[60:63], v[144:147], a[80:83], v[60:63]
    v_mfma_f32_16x16x32_bf16 v[64:67], v[144:147], a[104:107], v[64:67]
    v_mfma_f32_16x16x32_bf16 v[68:71], v[144:147], a[128:131], v[68:71]
    v_mfma_f32_16x16x32_bf16 v[72:75], v[144:147], a[152:155], v[72:75]
    v_mfma_f32_16x16x32_bf16 v[76:79], v[144:147], a[176:179], v[76:79]
    v_mfma_f32_16x16x32_bf16 v[16:19], v[124:127], a[12:15], v[16:19]
    v_mfma_f32_16x16x32_bf16 v[20:23], v[124:127], a[36:39], v[20:23]
    v_mfma_f32_16x16x32_bf16 v[24:27], v[124:127], a[60:63], v[24:27]
    v_mfma_f32_16x16x32_bf16 v[28:31], v[124:127], a[84:87], v[28:31]
    v_mfma_f32_16x16x32_bf16 v[32:35], v[124:127], a[108:111], v[32:35]
    v_mfma_f32_16x16x32_bf16 v[36:39], v[124:127], a[132:135], v[36:39]
    v_mfma_f32_16x16x32_bf16 v[40:43], v[124:127], a[156:159], v[40:43]
    v_mfma_f32_16x16x32_bf16 v[44:47], v[124:127], a[180:183], v[44:47]
    v_mfma_f32_16x16x32_bf16 v[48:51], v[148:151], a[12:15], v[48:51]
    v_mfma_f32_16x16x32_bf16 v[52:55], v[148:151], a[36:39], v[52:55]
    v_mfma_f32_16x16x32_bf16 v[56:59], v[148:151], a[60:63], v[56:59]
    v_mfma_f32_16x16x32_bf16 v[60:63], v[148:151], a[84:87], v[60:63]
    v_mfma_f32_16x16x32_bf16 v[64:67], v[148:151], a[108:111], v[64:67]
    v_mfma_f32_16x16x32_bf16 v[68:71], v[148:151], a[132:135], v[68:71]
    v_mfma_f32_16x16x32_bf16 v[72:75], v[148:151], a[156:159], v[72:75]
    v_mfma_f32_16x16x32_bf16 v[76:79], v[148:151], a[180:183], v[76:79]
    v_mfma_f32_16x16x32_bf16 v[16:19], v[128:131], a[16:19], v[16:19]
    v_mfma_f32_16x16x32_bf16 v[20:23], v[128:131], a[40:43], v[20:23]
    v_mfma_f32_16x16x32_bf16 v[24:27], v[128:131], a[64:67], v[24:27]
    v_mfma_f32_16x16x32_bf16 v[28:31], v[128:131], a[88:91], v[28:31]
    v_mfma_f32_16x16x32_bf16 v[32:35], v[128:131], a[112:115], v[32:35]
    v_mfma_f32_16x16x32_bf16 v[36:39], v[128:131], a[136:139], v[36:39]
    v_mfma_f32_16x16x32_bf16 v[40:43], v[128:131], a[160:163], v[40:43]
    v_mfma_f32_16x16x32_bf16 v[44:47], v[128:131], a[184:187], v[44:47]
    v_mfma_f32_16x16x32_bf16 v[48:51], v[152:155], a[16:19], v[48:51]
    v_mfma_f32_16x16x32_bf16 v[52:55], v[152:155], a[40:43], v[52:55]
    v_mfma_f32_16x16x32_bf16 v[56:59], v[152:155], a[64:67], v[56:59]
    v_mfma_f32_16x16x32_bf16 v[60:63], v[152:155], a[88:91], v[60:63]
    v_mfma_f32_16x16x32_bf16 v[64:67], v[152:155], a[112:115], v[64:67]
    v_mfma_f32_16x16x32_bf16 v[68:71], v[152:155], a[136:139], v[68:71]
    v_mfma_f32_16x16x32_bf16 v[72:75], v[152:155], a[160:163], v[72:75]
    v_mfma_f32_16x16x32_bf16 v[76:79], v[152:155], a[184:187], v[76:79]
    v_mfma_f32_16x16x32_bf16 v[16:19], v[132:135], a[20:23], v[16:19]
    v_mfma_f32_16x16x32_bf16 v[20:23], v[132:135], a[44:47], v[20:23]
    v_mfma_f32_16x16x32_bf16 v[24:27], v[132:135], a[68:71], v[24:27]
    v_mfma_f32_16x16x32_bf16 v[28:31], v[132:135], a[92:95], v[28:31]
    v_mfma_f32_16x16x32_bf16 v[32:35], v[132:135], a[116:119], v[32:35]
    v_mfma_f32_16x16x32_bf16 v[36:39], v[132:135], a[140:143], v[36:39]
    v_mfma_f32_16x16x32_bf16 v[40:43], v[132:135], a[164:167], v[40:43]
    v_mfma_f32_16x16x32_bf16 v[44:47], v[132:135], a[188:191], v[44:47]
    v_mfma_f32_16x16x32_bf16 v[48:51], v[156:159], a[20:23], v[48:51]
    v_mfma_f32_16x16x32_bf16 v[52:55], v[156:159], a[44:47], v[52:55]
    v_mfma_f32_16x16x32_bf16 v[56:59], v[156:159], a[68:71], v[56:59]
    v_mfma_f32_16x16x32_bf16 v[60:63], v[156:159], a[92:95], v[60:63]
    v_mfma_f32_16x16x32_bf16 v[64:67], v[156:159], a[116:119], v[64:67]
    v_mfma_f32_16x16x32_bf16 v[68:71], v[156:159], a[140:143], v[68:71]
    v_mfma_f32_16x16x32_bf16 v[72:75], v[156:159], a[164:167], v[72:75]
    v_mfma_f32_16x16x32_bf16 v[76:79], v[156:159], a[188:191], v[76:79]
    v_cvt_pk_bf16_f32 v208, v16, v17
    v_cvt_pk_bf16_f32 v209, v18, v19
    v_cvt_pk_bf16_f32 v210, v48, v49
    v_cvt_pk_bf16_f32 v211, v50, v51
    s_add_u32 s45, s52, 163840
    buffer_store_dwordx4 v[208:211], v10, s[8:11], s45 offen sc1
    v_cvt_pk_bf16_f32 v212, v20, v21
    v_cvt_pk_bf16_f32 v213, v22, v23
    v_cvt_pk_bf16_f32 v214, v52, v53
    v_cvt_pk_bf16_f32 v215, v54, v55
    s_add_u32 s45, s52, 164864
    buffer_store_dwordx4 v[212:215], v10, s[8:11], s45 offen sc1
    v_cvt_pk_bf16_f32 v216, v24, v25
    v_cvt_pk_bf16_f32 v217, v26, v27
    v_cvt_pk_bf16_f32 v218, v56, v57
    v_cvt_pk_bf16_f32 v219, v58, v59
    s_add_u32 s45, s52, 165888
    buffer_store_dwordx4 v[216:219], v10, s[8:11], s45 offen sc1
    v_cvt_pk_bf16_f32 v220, v28, v29
    v_cvt_pk_bf16_f32 v221, v30, v31
    v_cvt_pk_bf16_f32 v222, v60, v61
    v_cvt_pk_bf16_f32 v223, v62, v63
    s_add_u32 s45, s52, 166912
    buffer_store_dwordx4 v[220:223], v10, s[8:11], s45 offen sc1
    v_cvt_pk_bf16_f32 v224, v32, v33
    v_cvt_pk_bf16_f32 v225, v34, v35
    v_cvt_pk_bf16_f32 v226, v64, v65
    v_cvt_pk_bf16_f32 v227, v66, v67
    s_add_u32 s45, s52, 167936
    buffer_store_dwordx4 v[224:227], v10, s[8:11], s45 offen sc1
    v_cvt_pk_bf16_f32 v228, v36, v37
    v_cvt_pk_bf16_f32 v229, v38, v39
    v_cvt_pk_bf16_f32 v230, v68, v69
    v_cvt_pk_bf16_f32 v231, v70, v71
    s_add_u32 s45, s52, 168960
    buffer_store_dwordx4 v[228:231], v10, s[8:11], s45 offen sc1
    v_cvt_pk_bf16_f32 v232, v40, v41
    v_cvt_pk_bf16_f32 v233, v42, v43
    v_cvt_pk_bf16_f32 v234, v72, v73
    v_cvt_pk_bf16_f32 v235, v74, v75
    s_add_u32 s45, s52, 169984
    buffer_store_dwordx4 v[232:235], v10, s[8:11], s45 offen sc1
    v_cvt_pk_bf16_f32 v236, v44, v45
    v_cvt_pk_bf16_f32 v237, v46, v47
    v_cvt_pk_bf16_f32 v238, v76, v77
    v_cvt_pk_bf16_f32 v239, v78, v79
    s_add_u32 s45, s52, 171008
    buffer_store_dwordx4 v[236:239], v10, s[8:11], s45 offen sc1
    s_waitcnt vmcnt(0)
    s_barrier
    s_cmp_lg_u32 s33, 0
    s_cbranch_scc1 FF_56
    s_lshl_b32 s45, s49, 7
    s_lshl_b32 s46, s48, 2
    s_add_u32 s45, s45, s46
    s_add_u32 s45, s45, 0
    v_mov_b32 v1, 1
    v_mov_b32 v2, s45
    s_mov_b64 exec, 1
    buffer_store_dword v1, v2, s[8:11], 0 offen sc1
    s_mov_b64 exec, -1
FF_56:
    s_lshr_b32 s50, s66, 3
    s_cmp_lg_u32 s33, 0
    s_cbranch_scc1 FW_57
    v_mov_b32 v2, 4
    s_movk_i32 s45, 254
PL_58:
    buffer_load_dword v1, v2, s[28:31], 0 offen sc1
    s_waitcnt vmcnt(0)
    v_cmp_gt_u32 vcc, s45, v1
    s_cbranch_vccz PD_59
    s_sub_u32 s35, s35, 1
    s_cbranch_scc1 TO_60
    s_branch PL_58
PD_59:
    v_and_b32 v2, 31, v0
    v_lshlrev_b32 v2, 2, v2
    s_lshl_b32 s45, s50, 7
    s_add_u32 s45, s45, 0
    s_mov_b32 s46, 1
PL_61:
    buffer_load_dword v1, v2, s[8:11], s45 offen sc1
    s_waitcnt vmcnt(0)
    v_cmp_gt_u32 vcc, s46, v1
    s_cbranch_vccz PD_62
    s_sub_u32 s35, s35, 1
    s_cbranch_scc1 TO_63
    s_branch PL_61
PD_62:
FW_57:
    s_barrier
    v_and_b32 v16, 15, v0
    v_lshlrev_b32 v16, 6, v16
    v_lshrrev_b32 v17, 4, v0
    v_lshl_add_u32 v16, v17, 4, v16
    s_lshl_b32 s48, s65, 4
    s_lshl_b32 s45, s33, 2
    s_add_u32 s48, s48, s45
    s_mul_i32 s50, s48, 819200
    s_lshl_b32 s45, s66, 10
    s_add_u32 s50, s50, s45
    s_add_u32 s50, s50, 24117248
    v_lshrrev_b32 v1, 4, v0
    v_and_b32 v2, 15, v0
    v_mul_u32_u24 v2, 1280, v2
    v_lshl_add_u32 v4, v1, 4, v2
    s_mul_i32 s45, s33, 320
    v_add_u32 v4, s45, v4
    v_lshlrev_b32 v5, 4, v0
    s_mul_i32 s52, s33, 10240
    s_mul_i32 s45, s34, 40960
    s_and_b32 s46, s34, 1
    s_mul_i32 s46, s46, 40960
    s_add_u32 s46, s46, s52
    s_add_u32 m0, s46, 0
    s_add_u32 s47, s45, 0
    buffer_load_dwordx4 v4, s[12:15], s47 offen lds
    s_add_u32 m0, s46, 1024
    s_add_u32 s47, s45, 20480
    buffer_load_dwordx4 v4, s[12:15], s47 offen lds
    s_add_u32 m0, s46, 2048
    s_add_u32 s47, s45, 64
    buffer_load_dwordx4 v4, s[12:15], s47 offen lds
    s_add_u32 m0, s46, 3072
    s_add_u32 s47, s45, 20544
    buffer_load_dwordx4 v4, s[12:15], s47 offen lds
    s_add_u32 m0, s46, 4096
    s_add_u32 s47, s45, 128
    buffer_load_dwordx4 v4, s[12:15], s47 offen lds
    s_add_u32 m0, s46, 5120
    s_add_u32 s47, s45, 20608
    buffer_load_dwordx4 v4, s[12:15], s47 offen lds
    s_add_u32 m0, s46, 6144
    s_add_u32 s47, s45, 192
    buffer_load_dwordx4 v4, s[12:15], s47 offen lds
    s_add_u32 m0, s46, 7168
    s_add_u32 s47, s45, 20672
    buffer_load_dwordx4 v4, s[12:15], s47 offen lds
    s_add_u32 m0, s46, 8192
    s_add_u32 s47, s45, 256
    buffer_load_dwordx4 v4, s[12:15], s47 offen lds
    s_add_u32 m0, s46, 9216
    s_add_u32 s47, s45, 20736
    buffer_load_dwordx4 v4, s[12:15], s47 offen lds
    s_add_u32 s45, s50, 0
    buffer_load_dwordx4 a[0:3], v16, s[8:11], s45 offen sc1
    s_add_u32 s45, s50, 819200
    buffer_load_dwordx4 a[80:83], v16, s[8:11], s45 offen sc1
    s_add_u32 s45, s50, 1638400
    buffer_load_dwordx4 a[160:163], v16, s[8:11], s45 offen sc1
    s_add_u32 s45, s50, 2457600
    buffer_load_dwordx4 a[240:243], v16, s[8:11], s45 offen sc1
    s_add_u32 s45, s50, 40960
    buffer_load_dwordx4 a[4:7], v16, s[8:11], s45 offen sc1
    s_add_u32 s45, s50, 860160
    buffer_load_dwordx4 a[84:87], v16, s[8:11], s45 offen sc1
    s_add_u32 s45, s50, 1679360
    buffer_load_dwordx4 a[164:167], v16, s[8:11], s45 offen sc1
    s_add_u32 s45, s50, 2498560
    buffer_load_dwordx4 a[244:247], v16, s[8:11], s45 offen sc1
    s_add_u32 s45, s50, 81920
    buffer_load_dwordx4 a[8:11], v16, s[8:11], s45 offen sc1
    s_add_u32 s45, s50, 901120
    buffer_load_dwordx4 a[88:91], v16, s[8:11], s45 offen sc1
    s_add_u32 s45, s50, 1720320
    buffer_load_dwordx4 a[168:171], v16, s[8:11], s45 offen sc1
    s_add_u32 s45, s50, 2539520
    buffer_load_dwordx4 a[248:251], v16, s[8:11], s45 offen sc1
    s_add_u32 s45, s50, 122880
    buffer_load_dwordx4 a[12:15], v16, s[8:11], s45 offen sc1
    s_add_u32 s45, s50, 942080
    buffer_load_dwordx4 a[92:95], v16, s[8:11], s45 offen sc1
    s_add_u32 s45, s50, 1761280
    buffer_load_dwordx4 a[172:175], v16, s[8:11], s45 offen sc1
    s_add_u32 s45, s50, 2580480
    buffer_load_dwordx4 a[252:255], v16, s[8:11], s45 offen sc1
    s_add_u32 s45, s50, 163840
    buffer_load_dwordx4 a[16:19], v16, s[8:11], s45 offen sc1
    s_add_u32 s45, s50, 983040
    buffer_load_dwordx4 a[96:99], v16, s[8:11], s45 offen sc1
    s_add_u32 s45, s50, 1802240
    buffer_load_dwordx4 a[176:179], v16, s[8:11], s45 offen sc1
    s_add_u32 s45, s50, 2621440
    buffer_load_dwordx4 v[192:195], v16, s[8:11], s45 offen sc1
    s_add_u32 s45, s50, 204800
    buffer_load_dwordx4 a[20:23], v16, s[8:11], s45 offen sc1
    s_add_u32 s45, s50, 1024000
    buffer_load_dwordx4 a[100:103], v16, s[8:11], s45 offen sc1
    s_add_u32 s45, s50, 1843200
    buffer_load_dwordx4 a[180:183], v16, s[8:11], s45 offen sc1
    s_add_u32 s45, s50, 2662400
    buffer_load_dwordx4 v[196:199], v16, s[8:11], s45 offen sc1
    s_add_u32 s45, s50, 245760
    buffer_load_dwordx4 a[24:27], v16, s[8:11], s45 offen sc1
    s_add_u32 s45, s50, 1064960
    buffer_load_dwordx4 a[104:107], v16, s[8:11], s45 offen sc1
    s_add_u32 s45, s50, 1884160
    buffer_load_dwordx4 a[184:187], v16, s[8:11], s45 offen sc1
    s_add_u32 s45, s50, 2703360
    buffer_load_dwordx4 v[200:203], v16, s[8:11], s45 offen sc1
    s_add_u32 s45, s50, 286720
    buffer_load_dwordx4 a[28:31], v16, s[8:11], s45 offen sc1
    s_add_u32 s45, s50, 1105920
    buffer_load_dwordx4 a[108:111], v16, s[8:11], s45 offen sc1
    s_add_u32 s45, s50, 1925120
    buffer_load_dwordx4 a[188:191], v16, s[8:11], s45 offen sc1
    s_add_u32 s45, s50, 2744320
    buffer_load_dwordx4 v[204:207], v16, s[8:11], s45 offen sc1
    s_add_u32 s45, s50, 327680
    buffer_load_dwordx4 a[32:35], v16, s[8:11], s45 offen sc1
    s_add_u32 s45, s50, 1146880
    buffer_load_dwordx4 a[112:115], v16, s[8:11], s45 offen sc1
    s_add_u32 s45, s50, 1966080
    buffer_load_dwordx4 a[192:195], v16, s[8:11], s45 offen sc1
    s_add_u32 s45, s50, 2785280
    buffer_load_dwordx4 v[208:211], v16, s[8:11], s45 offen sc1
    s_add_u32 s45, s50, 368640
    buffer_load_dwordx4 a[36:39], v16, s[8:11], s45 offen sc1
    s_add_u32 s45, s50, 1187840
    buffer_load_dwordx4 a[116:119], v16, s[8:11], s45 offen sc1
    s_add_u32 s45, s50, 2007040
    buffer_load_dwordx4 a[196:199], v16, s[8:11], s45 offen sc1
    s_add_u32 s45, s50, 2826240
    buffer_load_dwordx4 v[212:215], v16, s[8:11], s45 offen sc1
    s_add_u32 s45, s50, 409600
    buffer_load_dwordx4 a[40:43], v16, s[8:11], s45 offen sc1
    s_add_u32 s45, s50, 1228800
    buffer_load_dwordx4 a[120:123], v16, s[8:11], s45 offen sc1
    s_add_u32 s45, s50, 2048000
    buffer_load_dwordx4 a[200:203], v16, s[8:11], s45 offen sc1
    s_add_u32 s45, s50, 2867200
    buffer_load_dwordx4 v[216:219], v16, s[8:11], s45 offen sc1
    s_add_u32 s45, s50, 450560
    buffer_load_dwordx4 a[44:47], v16, s[8:11], s45 offen sc1
    s_add_u32 s45, s50, 1269760
    buffer_load_dwordx4 a[124:127], v16, s[8:11], s45 offen sc1
    s_add_u32 s45, s50, 2088960
    buffer_load_dwordx4 a[204:207], v16, s[8:11], s45 offen sc1
    s_add_u32 s45, s50, 2908160
    buffer_load_dwordx4 v[220:223], v16, s[8:11], s45 offen sc1
    s_add_u32 s45, s50, 491520
    buffer_load_dwordx4 a[48:51], v16, s[8:11], s45 offen sc1
    s_add_u32 s45, s50, 1310720
    buffer_load_dwordx4 a[128:131], v16, s[8:11], s45 offen sc1
    s_add_u32 s45, s50, 2129920
    buffer_load_dwordx4 a[208:211], v16, s[8:11], s45 offen sc1
    s_add_u32 s45, s50, 2949120
    buffer_load_dwordx4 v[224:227], v16, s[8:11], s45 offen sc1
    s_add_u32 s45, s50, 532480
    buffer_load_dwordx4 a[52:55], v16, s[8:11], s45 offen sc1
    s_add_u32 s45, s50, 1351680
    buffer_load_dwordx4 a[132:135], v16, s[8:11], s45 offen sc1
    s_add_u32 s45, s50, 2170880
    buffer_load_dwordx4 a[212:215], v16, s[8:11], s45 offen sc1
    s_add_u32 s45, s50, 2990080
    buffer_load_dwordx4 v[228:231], v16, s[8:11], s45 offen sc1
    s_add_u32 s45, s50, 573440
    buffer_load_dwordx4 a[56:59], v16, s[8:11], s45 offen sc1
    s_add_u32 s45, s50, 1392640
    buffer_load_dwordx4 a[136:139], v16, s[8:11], s45 offen sc1
    s_add_u32 s45, s50, 2211840
    buffer_load_dwordx4 a[216:219], v16, s[8:11], s45 offen sc1
    s_add_u32 s45, s50, 3031040
    buffer_load_dwordx4 v[232:235], v16, s[8:11], s45 offen sc1
    s_add_u32 s45, s50, 614400
    buffer_load_dwordx4 a[60:63], v16, s[8:11], s45 offen sc1
    s_add_u32 s45, s50, 1433600
    buffer_load_dwordx4 a[140:143], v16, s[8:11], s45 offen sc1
    s_add_u32 s45, s50, 2252800
    buffer_load_dwordx4 a[220:223], v16, s[8:11], s45 offen sc1
    s_add_u32 s45, s50, 3072000
    buffer_load_dwordx4 v[236:239], v16, s[8:11], s45 offen sc1
    s_add_u32 s45, s50, 655360
    buffer_load_dwordx4 a[64:67], v16, s[8:11], s45 offen sc1
    s_add_u32 s45, s50, 1474560
    buffer_load_dwordx4 a[144:147], v16, s[8:11], s45 offen sc1
    s_add_u32 s45, s50, 2293760
    buffer_load_dwordx4 a[224:227], v16, s[8:11], s45 offen sc1
    s_add_u32 s45, s50, 3112960
    buffer_load_dwordx4 v[240:243], v16, s[8:11], s45 offen sc1
    s_add_u32 s45, s50, 696320
    buffer_load_dwordx4 a[68:71], v16, s[8:11], s45 offen sc1
    s_add_u32 s45, s50, 1515520
    buffer_load_dwordx4 a[148:151], v16, s[8:11], s45 offen sc1
    s_add_u32 s45, s50, 2334720
    buffer_load_dwordx4 a[228:231], v16, s[8:11], s45 offen sc1
    s_add_u32 s45, s50, 3153920
    buffer_load_dwordx4 v[244:247], v16, s[8:11], s45 offen sc1
    s_add_u32 s45, s50, 737280
    buffer_load_dwordx4 a[72:75], v16, s[8:11], s45 offen sc1
    s_add_u32 s45, s50, 1556480
    buffer_load_dwordx4 a[152:155], v16, s[8:11], s45 offen sc1
    s_add_u32 s45, s50, 2375680
    buffer_load_dwordx4 a[232:235], v16, s[8:11], s45 offen sc1
    s_add_u32 s45, s50, 3194880
    buffer_load_dwordx4 v[248:251], v16, s[8:11], s45 offen sc1
    s_add_u32 s45, s50, 778240
    buffer_load_dwordx4 a[76:79], v16, s[8:11], s45 offen sc1
    s_add_u32 s45, s50, 1597440
    buffer_load_dwordx4 a[156:159], v16, s[8:11], s45 offen sc1
    s_add_u32 s45, s50, 2416640
    buffer_load_dwordx4 a[236:239], v16, s[8:11], s45 offen sc1
    s_add_u32 s45, s50, 3235840
    buffer_load_dwordx4 v[252:255], v16, s[8:11], s45 offen sc1
    s_lshl_b32 s53, s33, 10
    s_cmp_lt_u32 s33, 2
    s_cselect_b32 s54, 2, 1
    s_lshl_b32 s54, s54, 12
    v_lshlrev_b32 v7, 4, v0
    v_add_u32 v13, 81920, v7
    v_add_u32 v11, s53, v13
    v_add_u32 v12, s54, v11
    s_add_u32 s53, s53, 131072
    v_and_b32 v1, 8, v0
    v_cmp_eq_u32 vcc, 0, v1
    v_mov_b32 v10, 0xeeee
    v_mov_b32 v1, 0x4444
    v_cndmask_b32 v10, v10, v1, vcc
    s_lshl_b32 s45, s33, 11
    s_add_u32 s45, s45, 92160
    v_add_u32 v8, s45, v7
    v_and_b32 v1, 3, v0
    v_add_u32 v1, s48, v1
    v_lshlrev_b32 v1, 2, v1
    v_add_u32 v9, 8192, v1
    s_lshl_b32 s68, s48, 11
    s_add_u32 s68, s68, 2097152
    s_lshl_b32 s69, s48, 9
    s_add_u32 s69, s69, 2162688
    s_mul_i32 s70, s65, 81920
    s_lshl_b32 s45, s66, 11
    s_add_u32 s70, s70, s45
    s_lshl_b32 s45, s33, 10
    s_add_u32 s70, s70, s45
    s_add_u32 s70, s70, 13631488
    s_waitcnt vmcnt(0)
    s_barrier
R3L_64:
    s_add_u32 s55, s34, 1
    s_mul_i32 s56, s34, 10240
    s_add_u32 s56, s56, s53
    s_add_u32 s57, s56, 4096
    s_add_u32 s58, s56, s54
    s_mul_i32 s71, s34, 81920
    s_add_u32 s72, s71, s69
    s_add_u32 s71, s71, s68
    s_add_u32 s45, s34, 1
    s_and_b32 s64, s45, 1
    s_mul_i32 s64, s64, 40960
    s_add_u32 s64, s64, s52
    s_min_u32 s45, s45, 63
    s_mul_i32 s63, s45, 40960
    s_and_b32 s45, s34, 1
    s_mul_i32 s45, s45, 40960
    v_add_u32 v6, s45, v5
    ds_read_b128 v[48:51], v6 offset:0
    ds_read_b128 v[52:55], v6 offset:1024
    ds_read_b128 v[56:59], v6 offset:2048
    ds_read_b128 v[60:63], v6 offset:3072
    s_waitcnt lgkmcnt(2)
    v_mfma_f32_16x16x32_bf16 v[16:19], v[48:51], a[0:3], 0
    ds_read_b128 v[64:67], v6 offset:4096
    v_mfma_f32_16x16x32_bf16 v[32:35], v[52:55], a[0:3], 0
    ds_read_b128 v[68:71], v6 offset:5120
    v_mfma_f32_16x16x32_bf16 v[20:23], v[48:51], a[80:83], 0
    v_mfma_f32_16x16x32_bf16 v[36:39], v[52:55], a[80:83], 0
    s_add_u32 m0, s64, 0
    s_add_u32 s47, s63, 0
    buffer_load_dwordx4 v4, s[12:15], s47 offen lds
    v_mfma_f32_16x16x32_bf16 v[24:27], v[48:51], a[160:163], 0
    v_mfma_f32_16x16x32_bf16 v[40:43], v[52:55], a[160:163], 0
    v_mfma_f32_16x16x32_bf16 v[28:31], v[48:51], a[240:243], 0
    v_mfma_f32_16x16x32_bf16 v[44:47], v[52:55], a[240:243], 0
    s_waitcnt lgkmcnt(2)
    v_mfma_f32_16x16x32_bf16 v[16:19], v[56:59], a[4:7], v[16:19]
    v_mov_b32 v92, 0
    ds_read_b128 v[48:51], v6 offset:6144
    v_mfma_f32_16x16x32_bf16 v[32:35], v[60:63], a[4:7], v[32:35]
    v_mov_b32 v93, 0
    ds_read_b128 v[52:55], v6 offset:7168
    v_mfma_f32_16x16x32_bf16 v[20:23], v[56:59], a[84:87], v[20:23]
    v_mov_b32 v94, 0
    v_mfma_f32_16x16x32_bf16 v[36:39], v[60:63], a[84:87], v[36:39]
    v_mov_b32 v95, 0
    s_add_u32 m0, s64, 1024
    s_add_u32 s47, s63, 20480
    buffer_load_dwordx4 v4, s[12:15], s47 offen lds
    v_mfma_f32_16x16x32_bf16 v[24:27], v[56:59], a[164:167], v[24:27]
    v_mov_b32 v96, 0
    v_mfma_f32_16x16x32_bf16 v[40:43], v[60:63], a[164:167], v[40:43]
    v_mov_b32 v97, 0
    v_mfma_f32_16x16x32_bf16 v[28:31], v[56:59], a[244:247], v[28:31]
    v_mov_b32 v98, 0
    v_mfma_f32_16x16x32_bf16 v[44:47], v[60:63], a[244:247], v[44:47]
    v_mov_b32 v99, 0
    s_waitcnt lgkmcnt(2)
    v_mfma_f32_16x16x32_bf16 v[16:19], v[64:67], a[8:11], v[16:19]
    v_mov_b32 v100, 0
    ds_read_b128 v[56:59], v6 offset:8192
    v_mfma_f32_16x16x32_bf16 v[32:35], v[68:71], a[8:11], v[32:35]
    v_mov_b32 v101, 0
    ds_read_b128 v[60:63], v6 offset:9216
    v_mfma_f32_16x16x32_bf16 v[20:23], v[64:67], a[88:91], v[20:23]
    v_mov_b32 v102, 0
    v_mfma_f32_16x16x32_bf16 v[36:39], v[68:71], a[88:91], v[36:39]
    v_mov_b32 v103, 0
    v_mfma_f32_16x16x32_bf16 v[24:27], v[64:67], a[168:171], v[24:27]
    v_mov_b32 v104, 0
    v_mfma_f32_16x16x32_bf16 v[40:43], v[68:71], a[168:171], v[40:43]
    v_mov_b32 v105, 0
    v_mfma_f32_16x16x32_bf16 v[28:31], v[64:67], a[248:251], v[28:31]
    v_mov_b32 v106, 0
    v_mfma_f32_16x16x32_bf16 v[44:47], v[68:71], a[248:251], v[44:47]
    v_mov_b32 v107, 0
    s_waitcnt lgkmcnt(2)
    v_mfma_f32_16x16x32_bf16 v[16:19], v[48:51], a[12:15], v[16:19]
    ds_read_b128 v[64:67], v6 offset:10240
    v_mfma_f32_16x16x32_bf16 v[32:35], v[52:55], a[12:15], v[32:35]
    ds_read_b128 v[68:71], v6 offset:11264
    v_mfma_f32_16x16x32_bf16 v[20:23], v[48:51], a[92:95], v[20:23]
    v_mfma_f32_16x16x32_bf16 v[36:39], v[52:55], a[92:95], v[36:39]
    s_add_u32 m0, s64, 2048
    s_add_u32 s47, s63, 64
    buffer_load_dwordx4 v4, s[12:15], s47 offen lds
    v_mfma_f32_16x16x32_bf16 v[24:27], v[48:51], a[172:175], v[24:27]
    v_mfma_f32_16x16x32_bf16 v[40:43], v[52:55], a[172:175], v[40:43]
    v_mfma_f32_16x16x32_bf16 v[28:31], v[48:51], a[252:255], v[28:31]
    v_mfma_f32_16x16x32_bf16 v[44:47], v[52:55], a[252:255], v[44:47]
    s_waitcnt lgkmcnt(2)
    v_mfma_f32_16x16x32_bf16 v[16:19], v[56:59], a[16:19], v[16:19]
    ds_read_b128 v[48:51], v6 offset:12288
    v_mfma_f32_16x16x32_bf16 v[32:35], v[60:63], a[16:19], v[32:35]
    ds_read_b128 v[52:55], v6 offset:13312
    v_mfma_f32_16x16x32_bf16 v[20:23], v[56:59], a[96:99], v[20:23]
    v_mfma_f32_16x16x32_bf16 v[36:39], v[60:63], a[96:99], v[36:39]
    s_add_u32 m0, s64, 3072
    s_add_u32 s47, s63, 20544
    buffer_load_dwordx4 v4, s[12:15], s47 offen lds
    v_mfma_f32_16x16x32_bf16 v[24:27], v[56:59], a[176:179], v[24:27]
    v_mfma_f32_16x16x32_bf16 v[40:43], v[60:63], a[176:179], v[40:43]
    buffer_load_dwordx4 v[80:83], v7, s[8:11], s56 offen sc1
    v_mfma_f32_16x16x32_bf16 v[28:31], v[56:59], v[192:195], v[28:31]
    v_mfma_f32_16x16x32_bf16 v[44:47], v[60:63], v[192:195], v[44:47]
    s_waitcnt lgkmcnt(2)
    v_mfma_f32_16x16x32_bf16 v[16:19], v[64:67], a[20:23], v[16:19]
    ds_read_b128 v[56:59], v6 offset:14336
    v_mfma_f32_16x16x32_bf16 v[32:35], v[68:71], a[20:23], v[32:35]
    ds_read_b128 v[60:63], v6 offset:15360
    v_mfma_f32_16x16x32_bf16 v[20:23], v[64:67], a[100:103], v[20:23]
    v_mfma_f32_16x16x32_bf16 v[36:39], v[68:71], a[100:103], v[36:39]
    v_mfma_f32_16x16x32_bf16 v[24:27], v[64:67], a[180:183], v[24:27]
    v_mfma_f32_16x16x32_bf16 v[40:43], v[68:71], a[180:183], v[40:43]
    buffer_load_dwordx4 v[84:87], v7, s[8:11], s57 offen sc1
    v_mfma_f32_16x16x32_bf16 v[28:31], v[64:67], v[196:199], v[28:31]
    v_mfma_f32_16x16x32_bf16 v[44:47], v[68:71], v[196:199], v[44:47]
    s_waitcnt lgkmcnt(2)
    v_mfma_f32_16x16x32_bf16 v[16:19], v[48:51], a[24:27], v[16:19]
    ds_read_b128 v[64:67], v6 offset:16384
    v_mfma_f32_16x16x32_bf16 v[32:35], v[52:55], a[24:27], v[32:35]
    ds_read_b128 v[68:71], v6 offset:17408
    v_mfma_f32_16x16x32_bf16 v[20:23], v[48:51], a[104:107], v[20:23]
    v_mfma_f32_16x16x32_bf16 v[36:39], v[52:55], a[104:107], v[36:39]
    s_add_u32 m0, s64, 4096
    s_add_u32 s47, s63, 128
    buffer_load_dwordx4 v4, s[12:15], s47 offen lds
    v_mfma_f32_16x16x32_bf16 v[24:27], v[48:51], a[184:187], v[24:27]
    v_mfma_f32_16x16x32_bf16 v[40:43], v[52:55], a[184:187], v[40:43]
    buffer_load_dwordx4 v[88:91], v7, s[8:11], s58 offen sc1
    v_mfma_f32_16x16x32_bf16 v[28:31], v[48:51], v[200:203], v[28:31]
    v_mfma_f32_16x16x32_bf16 v[44:47], v[52:55], v[200:203], v[44:47]
    s_waitcnt lgkmcnt(2)
    v_mfma_f32_16x16x32_bf16 v[16:19], v[56:59], a[28:31], v[16:19]
    ds_read_b128 v[48:51], v6 offset:18432
    v_mfma_f32_16x16x32_bf16 v[32:35], v[60:63], a[28:31], v[32:35]
    ds_read_b128 v[52:55], v6 offset:19456
    v_mfma_f32_16x16x32_bf16 v[20:23], v[56:59], a[108:111], v[20:23]
    v_mfma_f32_16x16x32_bf16 v[36:39], v[60:63], a[108:111], v[36:39]
    s_add_u32 m0, s64, 5120
    s_add_u32 s47, s63, 20608
    buffer_load_dwordx4 v4, s[12:15], s47 offen lds
    v_mfma_f32_16x16x32_bf16 v[24:27], v[56:59], a[188:191], v[24:27]
    v_mfma_f32_16x16x32_bf16 v[40:43], v[60:63], a[188:191], v[40:43]
    v_mfma_f32_16x16x32_bf16 v[28:31], v[56:59], v[204:207], v[28:31]
    v_mfma_f32_16x16x32_bf16 v[44:47], v[60:63], v[204:207], v[44:47]
    s_waitcnt lgkmcnt(2)
    v_mfma_f32_16x16x32_bf16 v[16:19], v[64:67], a[32:35], v[16:19]
    ds_read_b128 v[56:59], v6 offset:20480
    v_mfma_f32_16x16x32_bf16 v[32:35], v[68:71], a[32:35], v[32:35]
    ds_read_b128 v[60:63], v6 offset:21504
    v_mfma_f32_16x16x32_bf16 v[20:23], v[64:67], a[112:115], v[20:23]
    v_mfma_f32_16x16x32_bf16 v[36:39], v[68:71], a[112:115], v[36:39]
    v_mfma_f32_16x16x32_bf16 v[24:27], v[64:67], a[192:195], v[24:27]
    v_mfma_f32_16x16x32_bf16 v[40:43], v[68:71], a[192:195], v[40:43]
    v_mfma_f32_16x16x32_bf16 v[28:31], v[64:67], v[208:211], v[28:31]
    v_mfma_f32_16x16x32_bf16 v[44:47], v[68:71], v[208:211], v[44:47]
    s_waitcnt lgkmcnt(2)
    v_mfma_f32_16x16x32_bf16 v[16:19], v[48:51], a[36:39], v[16:19]
    ds_read_b128 v[64:67], v6 offset:22528
    v_mfma_f32_16x16x32_bf16 v[32:35], v[52:55], a[36:39], v[32:35]
    ds_read_b128 v[68:71], v6 offset:23552
    v_mfma_f32_16x16x32_bf16 v[20:23], v[48:51], a[116:119], v[20:23]
    v_mfma_f32_16x16x32_bf16 v[36:39], v[52:55], a[116:119], v[36:39]
    s_add_u32 m0, s64, 6144
    s_add_u32 s47, s63, 192
    buffer_load_dwordx4 v4, s[12:15], s47 offen lds
    v_mfma_f32_16x16x32_bf16 v[24:27], v[48:51], a[196:199], v[24:27]
    v_mfma_f32_16x16x32_bf16 v[40:43], v[52:55], a[196:199], v[40:43]
    v_mfma_f32_16x16x32_bf16 v[28:31], v[48:51], v[212:215], v[28:31]
    v_mfma_f32_16x16x32_bf16 v[44:47], v[52:55], v[212:215], v[44:47]
    s_waitcnt lgkmcnt(2)
    v_mfma_f32_16x16x32_bf16 v[16:19], v[56:59], a[40:43], v[16:19]
    ds_read_b128 v[48:51], v6 offset:24576
    v_mfma_f32_16x16x32_bf16 v[32:35], v[60:63], a[40:43], v[32:35]
    ds_read_b128 v[52:55], v6 offset:25600
    v_mfma_f32_16x16x32_bf16 v[20:23], v[56:59], a[120:123], v[20:23]
    v_mfma_f32_16x16x32_bf16 v[36:39], v[60:63], a[120:123], v[36:39]
    s_add_u32 m0, s64, 7168
    s_add_u32 s47, s63, 20672
    buffer_load_dwordx4 v4, s[12:15], s47 offen lds
    v_mfma_f32_16x16x32_bf16 v[24:27], v[56:59], a[200:203], v[24:27]
    v_mfma_f32_16x16x32_bf16 v[40:43], v[60:63], a[200:203], v[40:43]
    v_mfma_f32_16x16x32_bf16 v[28:31], v[56:59], v[216:219], v[28:31]
    v_mfma_f32_16x16x32_bf16 v[44:47], v[60:63], v[216:219], v[44:47]
    s_waitcnt lgkmcnt(2)
    v_mfma_f32_16x16x32_bf16 v[16:19], v[64:67], a[44:47], v[16:19]
    ds_read_b128 v[56:59], v6 offset:26624
    v_mfma_f32_16x16x32_bf16 v[32:35], v[68:71], a[44:47], v[32:35]
    ds_read_b128 v[60:63], v6 offset:27648
    v_mfma_f32_16x16x32_bf16 v[20:23], v[64:67], a[124:127], v[20:23]
    v_mfma_f32_16x16x32_bf16 v[36:39], v[68:71], a[124:127], v[36:39]
    v_mfma_f32_16x16x32_bf16 v[24:27], v[64:67], a[204:207], v[24:27]
    v_mfma_f32_16x16x32_bf16 v[40:43], v[68:71], a[204:207], v[40:43]
    v_mfma_f32_16x16x32_bf16 v[28:31], v[64:67], v[220:223], v[28:31]
    v_mfma_f32_16x16x32_bf16 v[44:47], v[68:71], v[220:223], v[44:47]
    s_cmp_ge_u32 s33, 2
    s_cbranch_scc1 R3P_65
    s_waitcnt vmcnt(11)
    v_mov_b32 v1, s34
    v_mov_b32 v2, s67
    s_mov_b64 exec, 1
    buffer_store_dword v1, v2, s[8:11], 0 offen sc1
    s_mov_b64 exec, -1
R3P_65:
    buffer_load_dword v3, v9, s[8:11], 0 offen sc1
    s_waitcnt lgkmcnt(2)
    v_mfma_f32_16x16x32_bf16 v[16:19], v[48:51], a[48:51], v[16:19]
    ds_read_b128 v[64:67], v6 offset:28672
    v_mfma_f32_16x16x32_bf16 v[32:35], v[52:55], a[48:51], v[32:35]
    ds_read_b128 v[68:71], v6 offset:29696
    v_mfma_f32_16x16x32_bf16 v[20:23], v[48:51], a[128:131], v[20:23]
    v_mfma_f32_16x16x32_bf16 v[36:39], v[52:55], a[128:131], v[36:39]
    s_add_u32 m0, s64, 8192
    s_add_u32 s47, s63, 256
    buffer_load_dwordx4 v4, s[12:15], s47 offen lds
    v_mfma_f32_16x16x32_bf16 v[24:27], v[48:51], a[208:211], v[24:27]
    v_mfma_f32_16x16x32_bf16 v[40:43], v[52:55], a[208:211], v[40:43]
    v_mfma_f32_16x16x32_bf16 v[28:31], v[48:51], v[224:227], v[28:31]
    v_mfma_f32_16x16x32_bf16 v[44:47], v[52:55], v[224:227], v[44:47]
    s_waitcnt lgkmcnt(2)
    v_mfma_f32_16x16x32_bf16 v[16:19], v[56:59], a[52:55], v[16:19]
    ds_read_b128 v[48:51], v6 offset:30720
    v_mfma_f32_16x16x32_bf16 v[32:35], v[60:63], a[52:55], v[32:35]
    ds_read_b128 v[52:55], v6 offset:31744
    v_mfma_f32_16x16x32_bf16 v[20:23], v[56:59], a[132:135], v[20:23]
    v_mfma_f32_16x16x32_bf16 v[36:39], v[60:63], a[132:135], v[36:39]
    s_add_u32 m0, s64, 9216
    s_add_u32 s47, s63, 20736
    buffer_load_dwordx4 v4, s[12:15], s47 offen lds
    v_mfma_f32_16x16x32_bf16 v[24:27], v[56:59], a[212:215], v[24:27]
    v_mfma_f32_16x16x32_bf16 v[40:43], v[60:63], a[212:215], v[40:43]
    v_mfma_f32_16x16x32_bf16 v[28:31], v[56:59], v[228:231], v[28:31]
    v_mfma_f32_16x16x32_bf16 v[44:47], v[60:63], v[228:231], v[44:47]
    s_waitcnt lgkmcnt(2)
    v_mfma_f32_16x16x32_bf16 v[16:19], v[64:67], a[56:59], v[16:19]
    ds_read_b128 v[56:59], v6 offset:32768
    v_mfma_f32_16x16x32_bf16 v[32:35], v[68:71], a[56:59], v[32:35]
    ds_read_b128 v[60:63], v6 offset:33792
    v_mfma_f32_16x16x32_bf16 v[20:23], v[64:67], a[136:139], v[20:23]
    v_mfma_f32_16x16x32_bf16 v[36:39], v[68:71], a[136:139], v[36:39]
    v_mfma_f32_16x16x32_bf16 v[24:27], v[64:67], a[216:219], v[24:27]
    v_mfma_f32_16x16x32_bf16 v[40:43], v[68:71], a[216:219], v[40:43]
    v_mfma_f32_16x16x32_bf16 v[28:31], v[64:67], v[232:235], v[28:31]
    v_mfma_f32_16x16x32_bf16 v[44:47], v[68:71], v[232:235], v[44:47]
    s_waitcnt lgkmcnt(2)
    v_mfma_f32_16x16x32_bf16 v[16:19], v[48:51], a[60:63], v[16:19]
    ds_read_b128 v[64:67], v6 offset:34816
    v_mfma_f32_16x16x32_bf16 v[32:35], v[52:55], a[60:63], v[32:35]
    ds_read_b128 v[68:71], v6 offset:35840
    v_mfma_f32_16x16x32_bf16 v[20:23], v[48:51], a[140:143], v[20:23]
    v_mfma_f32_16x16x32_bf16 v[36:39], v[52:55], a[140:143], v[36:39]
    v_mfma_f32_16x16x32_bf16 v[24:27], v[48:51], a[220:223], v[24:27]
    v_mfma_f32_16x16x32_bf16 v[40:43], v[52:55], a[220:223], v[40:43]
    v_mfma_f32_16x16x32_bf16 v[28:31], v[48:51], v[236:239], v[28:31]
    v_mfma_f32_16x16x32_bf16 v[44:47], v[52:55], v[236:239], v[44:47]
    s_waitcnt lgkmcnt(2)
    v_mfma_f32_16x16x32_bf16 v[16:19], v[56:59], a[64:67], v[16:19]
    ds_read_b128 v[48:51], v6 offset:36864
    v_mfma_f32_16x16x32_bf16 v[32:35], v[60:63], a[64:67], v[32:35]
    ds_read_b128 v[52:55], v6 offset:37888
    v_mfma_f32_16x16x32_bf16 v[20:23], v[56:59], a[144:147], v[20:23]
    v_mfma_f32_16x16x32_bf16 v[36:39], v[60:63], a[144:147], v[36:39]
    v_mfma_f32_16x16x32_bf16 v[24:27], v[56:59], a[224:227], v[24:27]
    v_mfma_f32_16x16x32_bf16 v[40:43], v[60:63], a[224:227], v[40:43]
    v_mfma_f32_16x16x32_bf16 v[28:31], v[56:59], v[240:243], v[28:31]
    v_mfma_f32_16x16x32_bf16 v[44:47], v[60:63], v[240:243], v[44:47]
    s_waitcnt lgkmcnt(2)
    s_waitcnt vmcnt(6)
    v_mfma_f32_16x16x32_bf16 v[16:19], v[64:67], a[68:71], v[16:19]
    v_max3_u32 v1, v80, v81, v82
    ds_read_b128 v[56:59], v6 offset:38912
    v_mfma_f32_16x16x32_bf16 v[32:35], v[68:71], a[68:71], v[32:35]
    v_max3_u32 v2, v86, v87, v88
    ds_read_b128 v[60:63], v6 offset:39936
    v_mfma_f32_16x16x32_bf16 v[20:23], v[64:67], a[148:151], v[20:23]
    v_max3_u32 v1, v1, v83, v84
    v_mfma_f32_16x16x32_bf16 v[36:39], v[68:71], a[148:151], v[36:39]
    v_max3_u32 v2, v2, v89, v90
    v_mfma_f32_16x16x32_bf16 v[24:27], v[64:67], a[228:231], v[24:27]
    v_max_u32 v1, v1, v85
    v_mfma_f32_16x16x32_bf16 v[40:43], v[68:71], a[228:231], v[40:43]
    v_max_u32 v2, v2, v91
    v_mfma_f32_16x16x32_bf16 v[28:31], v[64:67], v[244:247], v[28:31]
    v_max_u32 v1, v1, v2
    v_mfma_f32_16x16x32_bf16 v[44:47], v[68:71], v[244:247], v[44:47]
    v_cmp_eq_u32 vcc, -1, v1
    s_cbranch_vccz MO_67
MS_66:
    s_sub_u32 s35, s35, 1
    s_cbranch_scc1 TO_68
    buffer_load_dwordx4 v[80:83], v7, s[8:11], s56 offen sc1
    buffer_load_dwordx4 v[84:87], v7, s[8:11], s57 offen sc1
    buffer_load_dwordx4 v[88:91], v7, s[8:11], s58 offen sc1
    s_waitcnt vmcnt(0)
    v_max3_u32 v1, v80, v81, v82
    v_max3_u32 v2, v86, v87, v88
    v_max3_u32 v1, v1, v83, v84
    v_max3_u32 v2, v2, v89, v90
    v_max_u32 v1, v1, v85
    v_max_u32 v2, v2, v91
    v_max_u32 v1, v1, v2
    v_cmp_eq_u32 vcc, -1, v1
    s_cbranch_vccnz MS_66
MO_67:
    ds_write_b128 v11, v[80:83]
    ds_write_b128 v11, v[84:87] offset:4096
    ds_write_b128 v12, v[88:91]
    s_waitcnt lgkmcnt(5)
    v_mfma_f32_16x16x32_bf16 v[16:19], v[48:51], a[72:75], v[16:19]
    v_mfma_f32_16x16x32_bf16 v[32:35], v[52:55], a[72:75], v[32:35]
    v_mfma_f32_16x16x32_bf16 v[20:23], v[48:51], a[152:155], v[20:23]
    v_mfma_f32_16x16x32_bf16 v[36:39], v[52:55], a[152:155], v[36:39]
    v_mfma_f32_16x16x32_bf16 v[24:27], v[48:51], a[232:235], v[24:27]
    v_mfma_f32_16x16x32_bf16 v[40:43], v[52:55], a[232:235], v[40:43]
    v_mfma_f32_16x16x32_bf16 v[28:31], v[48:51], v[248:251], v[28:31]
    v_mfma_f32_16x16x32_bf16 v[44:47], v[52:55], v[248:251], v[44:47]
    s_waitcnt vmcnt(2)
    v_cmp_gt_u32 vcc, s55, v3
    s_mov_b32 s74, 0
    s_cbranch_vccnz R3S_69
    s_mov_b32 s74, 1
    s_add_u32 s73, s71, 4096
    buffer_load_dwordx4 v[124:127], v7, s[8:11], s71 offen offset:0 sc1
    buffer_load_dwordx4 v[128:131], v7, s[8:11], s71 offen offset:1024 sc1
    buffer_load_dwordx4 v[132:135], v7, s[8:11], s71 offen offset:2048 sc1
    buffer_load_dwordx4 v[136:139], v7, s[8:11], s71 offen offset:3072 sc1
    buffer_load_dwordx4 v[140:143], v7, s[8:11], s73 offen offset:0 sc1
    buffer_load_dwordx4 v[144:147], v7, s[8:11], s73 offen offset:1024 sc1
    buffer_load_dwordx4 v[148:151], v7, s[8:11], s73 offen offset:2048 sc1
    buffer_load_dwordx4 v[152:155], v7, s[8:11], s73 offen offset:3072 sc1
    buffer_load_dwordx4 v[156:159], v7, s[8:11], s72 offen offset:0 sc1
    buffer_load_dwordx4 v[160:163], v7, s[8:11], s72 offen offset:1024 sc1
R3S_69:
    s_waitcnt lgkmcnt(3)
    s_waitcnt lgkmcnt(0)
    s_barrier
    ds_read_b128 v[108:111], v13 offset:0
    ds_read_b128 v[112:115], v13 offset:1024
    v_mfma_f32_16x16x32_bf16 v[16:19], v[56:59], a[76:79], v[16:19]
    v_mfma_f32_16x16x32_bf16 v[32:35], v[60:63], a[76:79], v[32:35]
    v_mfma_f32_16x16x32_bf16 v[20:23], v[56:59], a[156:159], v[20:23]
    v_mfma_f32_16x16x32_bf16 v[36:39], v[60:63], a[156:159], v[36:39]
    v_mfma_f32_16x16x32_bf16 v[24:27], v[56:59], a[236:239], v[24:27]
    v_mfma_f32_16x16x32_bf16 v[40:43], v[60:63], a[236:239], v[40:43]
    v_mfma_f32_16x16x32_bf16 v[28:31], v[56:59], v[252:255], v[28:31]
    v_mfma_f32_16x16x32_bf16 v[44:47], v[60:63], v[252:255], v[44:47]
    ds_read_b128 v[116:119], v13 offset:2048
    s_waitcnt lgkmcnt(2)
    v_smfmac_f32_16x16x64_bf16 v[92:95], v[108:111], a[0:7], v10
    v_smfmac_f32_16x16x64_bf16 v[96:99], v[108:111], a[80:87], v10
    v_smfmac_f32_16x16x64_bf16 v[100:103], v[108:111], a[160:167], v10
    v_smfmac_f32_16x16x64_bf16 v[104:107], v[108:111], a[240:247], v10
    ds_read_b128 v[108:111], v13 offset:3072
    s_waitcnt lgkmcnt(2)
    v_smfmac_f32_16x16x64_bf16 v[92:95], v[112:115], a[8:15], v10
    v_cvt_pk_bf16_f32 v64, v16, v17
    v_smfmac_f32_16x16x64_bf16 v[96:99], v[112:115], a[88:95], v10
    v_cvt_pk_bf16_f32 v65, v18, v19
    v_smfmac_f32_16x16x64_bf16 v[100:103], v[112:115], a[168:175], v10
    v_cvt_pk_bf16_f32 v66, v32, v33
    v_smfmac_f32_16x16x64_bf16 v[104:107], v[112:115], a[248:255], v10
    v_cvt_pk_bf16_f32 v67, v34, v35
    ds_read_b128 v[112:115], v13 offset:4096
    s_waitcnt lgkmcnt(2)
    v_smfmac_f32_16x16x64_bf16 v[92:95], v[116:119], a[16:23], v10
    v_cvt_pk_bf16_f32 v68, v20, v21
    v_smfmac_f32_16x16x64_bf16 v[96:99], v[116:119], a[96:103], v10
    v_cvt_pk_bf16_f32 v69, v22, v23
    v_smfmac_f32_16x16x64_bf16 v[100:103], v[116:119], a[176:183], v10
    v_cvt_pk_bf16_f32 v70, v36, v37
    v_smfmac_f32_16x16x64_bf16 v[104:107], v[116:119], v[192:199], v10
    v_cvt_pk_bf16_f32 v71, v38, v39
    ds_read_b128 v[116:119], v13 offset:5120
    s_waitcnt lgkmcnt(2)
    v_smfmac_f32_16x16x64_bf16 v[92:95], v[108:111], a[24:31], v10
    v_cvt_pk_bf16_f32 v72, v24, v25
    v_smfmac_f32_16x16x64_bf16 v[96:99], v[108:111], a[104:111], v10
    v_cvt_pk_bf16_f32 v73, v26, v27
    v_smfmac_f32_16x16x64_bf16 v[100:103], v[108:111], a[184:191], v10
    v_cvt_pk_bf16_f32 v74, v40, v41
    v_smfmac_f32_16x16x64_bf16 v[104:107], v[108:111], v[200:207], v10
    v_cvt_pk_bf16_f32 v75, v42, v43
    ds_read_b128 v[108:111], v13 offset:6144
    s_waitcnt lgkmcnt(2)
    v_smfmac_f32_16x16x64_bf16 v[92:95], v[112:115], a[32:39], v10
    v_cvt_pk_bf16_f32 v76, v28, v29
    v_smfmac_f32_16x16x64_bf16 v[96:99], v[112:115], a[112:119], v10
    v_cvt_pk_bf16_f32 v77, v30, v31
    v_smfmac_f32_16x16x64_bf16 v[100:103], v[112:115], a[192:199], v10
    v_cvt_pk_bf16_f32 v78, v44, v45
    v_smfmac_f32_16x16x64_bf16 v[104:107], v[112:115], v[208:215], v10
    v_cvt_pk_bf16_f32 v79, v46, v47
    ds_read_b128 v[112:115], v13 offset:7168
    s_waitcnt lgkmcnt(2)
    v_smfmac_f32_16x16x64_bf16 v[92:95], v[116:119], a[40:47], v10
    v_smfmac_f32_16x16x64_bf16 v[96:99], v[116:119], a[120:127], v10
    v_smfmac_f32_16x16x64_bf16 v[100:103], v[116:119], a[200:207], v10
    v_smfmac_f32_16x16x64_bf16 v[104:107], v[116:119], v[216:223], v10
    ds_read_b128 v[116:119], v13 offset:8192
    s_waitcnt lgkmcnt(2)
    v_smfmac_f32_16x16x64_bf16 v[92:95], v[108:111], a[48:55], v10
    v_smfmac_f32_16x16x64_bf16 v[96:99], v[108:111], a[128:135], v10
    v_smfmac_f32_16x16x64_bf16 v[100:103], v[108:111], a[208:215], v10
    v_smfmac_f32_16x16x64_bf16 v[104:107], v[108:111], v[224:231], v10
    ds_read_b128 v[108:111], v13 offset:9216
    s_waitcnt lgkmcnt(2)
    v_smfmac_f32_16x16x64_bf16 v[92:95], v[112:115], a[56:63], v10
    v_smfmac_f32_16x16x64_bf16 v[96:99], v[112:115], a[136:143], v10
    v_smfmac_f32_16x16x64_bf16 v[100:103], v[112:115], a[216:223], v10
    v_smfmac_f32_16x16x64_bf16 v[104:107], v[112:115], v[232:239], v10
    s_waitcnt lgkmcnt(1)
    v_smfmac_f32_16x16x64_bf16 v[92:95], v[116:119], a[64:71], v10
    v_smfmac_f32_16x16x64_bf16 v[96:99], v[116:119], a[144:151], v10
    v_smfmac_f32_16x16x64_bf16 v[100:103], v[116:119], a[224:231], v10
    v_smfmac_f32_16x16x64_bf16 v[104:107], v[116:119], v[240:247], v10
    s_waitcnt lgkmcnt(0)
    v_smfmac_f32_16x16x64_bf16 v[92:95], v[108:111], a[72:79], v10
    v_smfmac_f32_16x16x64_bf16 v[96:99], v[108:111], a[152:159], v10
    v_smfmac_f32_16x16x64_bf16 v[100:103], v[108:111], a[232:239], v10
    v_smfmac_f32_16x16x64_bf16 v[104:107], v[108:111], v[248:255], v10
    s_nop 5
    v_permlane32_swap_b32 v92, v96
    s_nop 0
    v_permlane32_swap_b32 v100, v104
    v_permlane32_swap_b32 v93, v97
    v_permlane32_swap_b32 v101, v105
    v_permlane32_swap_b32 v94, v98
    v_permlane32_swap_b32 v102, v106
    v_permlane32_swap_b32 v95, v99
    v_permlane32_swap_b32 v103, v107
    v_add_f32 v92, v92, v96
    v_add_f32 v100, v100, v104
    v_add_f32 v93, v93, v97
    v_add_f32 v101, v101, v105
    v_add_f32 v94, v94, v98
    v_add_f32 v102, v102, v106
    v_add_f32 v95, v95, v99
    v_add_f32 v103, v103, v107
    v_cvt_pk_bf16_f32 v120, v92, v93
    v_cvt_pk_bf16_f32 v122, v100, v101
    v_cvt_pk_bf16_f32 v121, v94, v95
    v_cvt_pk_bf16_f32 v123, v102, v103
    v_permlane16_swap_b32 v120, v122
    s_nop 0
    v_permlane16_swap_b32 v121, v123
    s_cmp_eq_u32 s74, 1
    s_cbranch_scc1 R3G_70
PL_71:
    buffer_load_dword v1, v9, s[8:11], 0 offen sc1
    s_waitcnt vmcnt(0)
    v_cmp_gt_u32 vcc, s55, v1
    s_cbranch_vccz PD_72
    s_sub_u32 s35, s35, 1
    s_cbranch_scc1 TO_73
    s_branch PL_71
PD_72:
    s_add_u32 s73, s71, 4096
    buffer_load_dwordx4 v[124:127], v7, s[8:11], s71 offen offset:0 sc1
    buffer_load_dwordx4 v[128:131], v7, s[8:11], s71 offen offset:1024 sc1
    buffer_load_dwordx4 v[132:135], v7, s[8:11], s71 offen offset:2048 sc1
    buffer_load_dwordx4 v[136:139], v7, s[8:11], s71 offen offset:3072 sc1
    buffer_load_dwordx4 v[140:143], v7, s[8:11], s73 offen offset:0 sc1
    buffer_load_dwordx4 v[144:147], v7, s[8:11], s73 offen offset:1024 sc1
    buffer_load_dwordx4 v[148:151], v7, s[8:11], s73 offen offset:2048 sc1
    buffer_load_dwordx4 v[152:155], v7, s[8:11], s73 offen offset:3072 sc1
    buffer_load_dwordx4 v[156:159], v7, s[8:11], s72 offen offset:0 sc1
    buffer_load_dwordx4 v[160:163], v7, s[8:11], s72 offen offset:1024 sc1
R3G_70:
    s_waitcnt vmcnt(0)
    v_mfma_f32_16x16x32_bf16 v[164:167], v[64:67], v[124:127], 0
    v_mfma_f32_16x16x32_bf16 v[168:171], v[64:67], v[128:131], 0
    v_mfma_f32_16x16x32_bf16 v[164:167], v[68:71], v[132:135], v[164:167]
    v_mfma_f32_16x16x32_bf16 v[168:171], v[68:71], v[136:139], v[168:171]
    v_mfma_f32_16x16x32_bf16 v[164:167], v[72:75], v[140:143], v[164:167]
    v_mfma_f32_16x16x32_bf16 v[168:171], v[72:75], v[144:147], v[168:171]
    v_mfma_f32_16x16x32_bf16 v[164:167], v[76:79], v[148:151], v[164:167]
    v_mfma_f32_16x16x32_bf16 v[168:171], v[76:79], v[152:155], v[168:171]
    v_mfma_f32_16x16x32_bf16 v[164:167], v[120:123], v[156:159], v[164:167]
    v_mfma_f32_16x16x32_bf16 v[168:171], v[120:123], v[160:163], v[168:171]
    s_nop 6
    ds_write_b128 v8, v[164:167] offset:0
    ds_write_b128 v8, v[168:171] offset:1024
    s_waitcnt lgkmcnt(0)
    s_barrier
    s_cmp_ge_u32 s33, 2
    s_cbranch_scc1 R3N_74
    s_lshl_b32 s45, s33, 10
    s_add_u32 s45, s45, 92160
    v_add_u32 v1, s45, v7
    ds_read_b128 v[172:175], v1 offset:0
    ds_read_b128 v[176:179], v1 offset:2048
    ds_read_b128 v[180:183], v1 offset:4096
    ds_read_b128 v[184:187], v1 offset:6144
    s_mul_i32 s45, s34, 163840
    s_add_u32 s45, s45, s70
    s_waitcnt lgkmcnt(0)
    v_pk_add_f32 v[172:173], v[172:173], v[176:177]
    v_pk_add_f32 v[180:181], v[180:181], v[184:185]
    v_pk_add_f32 v[174:175], v[174:175], v[178:179]
    v_pk_add_f32 v[182:183], v[182:183], v[186:187]
    v_pk_add_f32 v[172:173], v[172:173], v[180:181]
    v_pk_add_f32 v[174:175], v[174:175], v[182:183]
    buffer_store_dwordx4 v[172:175], v7, s[8:11], s45 offen sc1
R3N_74:
    s_add_u32 s34, s34, 1
    s_cmp_lt_u32 s34, 64
    s_cbranch_scc1 R3L_64
    s_cmp_ge_u32 s33, 2
    s_cbranch_scc1 R3E_75
    s_waitcnt vmcnt(0)
    v_mov_b32 v1, 64
    v_mov_b32 v2, s67
    s_mov_b64 exec, 1
    buffer_store_dword v1, v2, s[8:11], 0 offen sc1
    s_mov_b64 exec, -1
R3E_75:
    s_waitcnt vmcnt(0)
    s_endpgm
L_R4:
    s_lshl_b32 s54, s32, 7
    s_add_u32 s54, s54, 1024
    s_cmp_lg_u32 s33, 0
    s_cbranch_scc1 R4R_76
    v_mov_b32 v1, 0
    v_mov_b32 v2, s54
    s_mov_b64 exec, 1
    buffer_store_dword v1, v2, s[8:11], 0 offen sc1
    s_mov_b64 exec, -1
R4R_76:
    s_waitcnt vmcnt(0) lgkmcnt(0)
    s_barrier
    s_cmp_lg_u32 s33, 0
    s_cbranch_scc1 SI_77
    v_mov_b32 v1, 1
    v_mov_b32 v2, 4
    s_mov_b64 exec, 1
    buffer_atomic_add v1, v2, s[28:31], 0 offen sc1
    s_mov_b64 exec, -1
SI_77:
    s_cmp_lt_u32 s33, 2
    s_cbranch_scc0 QK_78
    s_load_dwordx2 s[4:5], s[0:1], 16
    s_branch QK_79
QK_78:
    s_load_dwordx2 s[4:5], s[0:1], 24
QK_79:
    s_waitcnt lgkmcnt(0)
    s_mov_b32 s16, s4
    s_mov_b32 s17, s5
    s_mov_b32 s18, 7864320
    s_mov_b32 s19, 0x20000
    v_add_u32 v22, 0, v0
    v_mul_u32_u24 v23, 43691, v22
    v_lshrrev_b32 v23, 19, v23
    v_mul_u32_u24 v24, 12, v23
    v_sub_u32 v24, v22, v24
    v_mul_u32_u24 v23, 12288, v23
    v_lshl_add_u32 v16, v24, 4, v23
    v_add_u32 v22, 64, v0
    v_mul_u32_u24 v23, 43691, v22
    v_lshrrev_b32 v23, 19, v23
    v_mul_u32_u24 v24, 12, v23
    v_sub_u32 v24, v22, v24
    v_mul_u32_u24 v23, 12288, v23
    v_lshl_add_u32 v17, v24, 4, v23
    v_add_u32 v22, 128, v0
    v_mul_u32_u24 v23, 43691, v22
    v_lshrrev_b32 v23, 19, v23
    v_mul_u32_u24 v24, 12, v23
    v_sub_u32 v24, v22, v24
    v_mul_u32_u24 v23, 12288, v23
    v_lshl_add_u32 v18, v24, 4, v23
    v_add_u32 v22, 192, v0
    v_mul_u32_u24 v23, 43691, v22
    v_lshrrev_b32 v23, 19, v23
    v_mul_u32_u24 v24, 12, v23
    v_sub_u32 v24, v22, v24
    v_mul_u32_u24 v23, 12288, v23
    v_lshl_add_u32 v19, v24, 4, v23
    v_add_u32 v22, 256, v0
    v_mul_u32_u24 v23, 43691, v22
    v_lshrrev_b32 v23, 19, v23
    v_mul_u32_u24 v24, 12, v23
    v_sub_u32 v24, v22, v24
    v_mul_u32_u24 v23, 12288, v23
    v_lshl_add_u32 v20, v24, 4, v23
    v_add_u32 v22, 320, v0
    v_mul_u32_u24 v23, 43691, v22
    v_lshrrev_b32 v23, 19, v23
    v_mul_u32_u24 v24, 12, v23
    v_sub_u32 v24, v22, v24
    v_mul_u32_u24 v23, 12288, v23
    v_lshl_add_u32 v21, v24, 4, v23
    v_lshrrev_b32 v22, 4, v0
    v_bfe_u32 v23, v0, 2, 2
    v_lshl_add_u32 v22, v22, 3, v23
    v_mul_u32_u24 v22, 192, v22
    v_and_b32 v23, 3, v0
    v_lshl_add_u32 v25, v23, 4, v22
    s_mul_i32 s50, s33, 24576
    s_add_u32 s50, s50, 32768
    v_add_u32 v25, s50, v25
    s_mul_i32 s51, s32, 384
    s_and_b32 s45, s33, 1
    s_mul_i32 s45, s45, 192
    s_add_u32 s51, s51, s45
    v_lshlrev_b32 v7, 4, v0
    s_lshl_b32 s45, s33, 13
    v_add_u32 v7, s45, v7
    s_add_u32 s46, s51, 0
    s_add_u32 m0, s50, 0
    s_nop 0
    buffer_load_dwordx4 v16, s[16:19], s46 offen lds
    s_add_u32 m0, s50, 1024
    s_nop 0
    buffer_load_dwordx4 v17, s[16:19], s46 offen lds
    s_add_u32 m0, s50, 2048
    s_nop 0
    buffer_load_dwordx4 v18, s[16:19], s46 offen lds
    s_add_u32 m0, s50, 3072
    s_nop 0
    buffer_load_dwordx4 v19, s[16:19], s46 offen lds
    s_add_u32 m0, s50, 4096
    s_nop 0
    buffer_load_dwordx4 v20, s[16:19], s46 offen lds
    s_add_u32 m0, s50, 5120
    s_nop 0
    buffer_load_dwordx4 v21, s[16:19], s46 offen lds
    s_add_u32 s46, s51, 393216
    s_add_u32 m0, s50, 6144
    s_nop 0
    buffer_load_dwordx4 v16, s[16:19], s46 offen lds
    s_add_u32 m0, s50, 7168
    s_nop 0
    buffer_load_dwordx4 v17, s[16:19], s46 offen lds
    s_add_u32 m0, s50, 8192
    s_nop 0
    buffer_load_dwordx4 v18, s[16:19], s46 offen lds
    s_add_u32 m0, s50, 9216
    s_nop 0
    buffer_load_dwordx4 v19, s[16:19], s46 offen lds
    s_add_u32 m0, s50, 10240
    s_nop 0
    buffer_load_dwordx4 v20, s[16:19], s46 offen lds
    s_add_u32 m0, s50, 11264
    s_nop 0
    buffer_load_dwordx4 v21, s[16:19], s46 offen lds
    s_add_u32 s46, s51, 786432
    s_add_u32 m0, s50, 12288
    s_nop 0
    buffer_load_dwordx4 v16, s[16:19], s46 offen lds
    s_add_u32 m0, s50, 13312
    s_nop 0
    buffer_load_dwordx4 v17, s[16:19], s46 offen lds
    s_add_u32 m0, s50, 14336
    s_nop 0
    buffer_load_dwordx4 v18, s[16:19], s46 offen lds
    s_add_u32 m0, s50, 15360
    s_nop 0
    buffer_load_dwordx4 v19, s[16:19], s46 offen lds
    s_add_u32 m0, s50, 16384
    s_nop 0
    buffer_load_dwordx4 v20, s[16:19], s46 offen lds
    s_add_u32 m0, s50, 17408
    s_nop 0
    buffer_load_dwordx4 v21, s[16:19], s46 offen lds
    s_add_u32 s46, s51, 1179648
    s_add_u32 m0, s50, 18432
    s_nop 0
    buffer_load_dwordx4 v16, s[16:19], s46 offen lds
    s_add_u32 m0, s50, 19456
    s_nop 0
    buffer_load_dwordx4 v17, s[16:19], s46 offen lds
    s_add_u32 m0, s50, 20480
    s_nop 0
    buffer_load_dwordx4 v18, s[16:19], s46 offen lds
    s_add_u32 m0, s50, 21504
    s_nop 0
    buffer_load_dwordx4 v19, s[16:19], s46 offen lds
    s_add_u32 m0, s50, 22528
    s_nop 0
    buffer_load_dwordx4 v20, s[16:19], s46 offen lds
    s_add_u32 m0, s50, 23552
    s_nop 0
    buffer_load_dwordx4 v21, s[16:19], s46 offen lds
    s_waitcnt vmcnt(18)
    ds_read_b64_tr_b16 a[0:1], v25 offset:0
    ds_read_b64_tr_b16 a[2:3], v25 offset:768
    ds_read_b64_tr_b16 a[8:9], v25 offset:8
    ds_read_b64_tr_b16 a[10:11], v25 offset:776
    ds_read_b64_tr_b16 a[16:17], v25 offset:64
    ds_read_b64_tr_b16 a[18:19], v25 offset:832
    ds_read_b64_tr_b16 a[24:25], v25 offset:72
    ds_read_b64_tr_b16 a[26:27], v25 offset:840
    ds_read_b64_tr_b16 a[32:33], v25 offset:128
    ds_read_b64_tr_b16 a[34:35], v25 offset:896
    ds_read_b64_tr_b16 a[40:41], v25 offset:136
    ds_read_b64_tr_b16 a[42:43], v25 offset:904
    s_waitcnt lgkmcnt(0)
    s_add_u32 s46, s51, 1572864
    s_add_u32 m0, s50, 0
    s_nop 0
    buffer_load_dwordx4 v16, s[16:19], s46 offen lds
    s_add_u32 m0, s50, 1024
    s_nop 0
    buffer_load_dwordx4 v17, s[16:19], s46 offen lds
    s_add_u32 m0, s50, 2048
    s_nop 0
    buffer_load_dwordx4 v18, s[16:19], s46 offen lds
    s_add_u32 m0, s50, 3072
    s_nop 0
    buffer_load_dwordx4 v19, s[16:19], s46 offen lds
    s_add_u32 m0, s50, 4096
    s_nop 0
    buffer_load_dwordx4 v20, s[16:19], s46 offen lds
    s_add_u32 m0, s50, 5120
    s_nop 0
    buffer_load_dwordx4 v21, s[16:19], s46 offen lds
    s_waitcnt vmcnt(18)
    ds_read_b64_tr_b16 a[4:5], v25 offset:6144
    ds_read_b64_tr_b16 a[6:7], v25 offset:6912
    ds_read_b64_tr_b16 a[12:13], v25 offset:6152
    ds_read_b64_tr_b16 a[14:15], v25 offset:6920
    ds_read_b64_tr_b16 a[20:21], v25 offset:6208
    ds_read_b64_tr_b16 a[22:23], v25 offset:6976
    ds_read_b64_tr_b16 a[28:29], v25 offset:6216
    ds_read_b64_tr_b16 a[30:31], v25 offset:6984
    ds_read_b64_tr_b16 a[36:37], v25 offset:6272
    ds_read_b64_tr_b16 a[38:39], v25 offset:7040
    ds_read_b64_tr_b16 a[44:45], v25 offset:6280
    ds_read_b64_tr_b16 a[46:47], v25 offset:7048
    s_waitcnt lgkmcnt(0)
    s_add_u32 s46, s51, 1966080
    s_add_u32 m0, s50, 6144
    s_nop 0
    buffer_load_dwordx4 v16, s[16:19], s46 offen lds
    s_add_u32 m0, s50, 7168
    s_nop 0
    buffer_load_dwordx4 v17, s[16:19], s46 offen lds
    s_add_u32 m0, s50, 8192
    s_nop 0
    buffer_load_dwordx4 v18, s[16:19], s46 offen lds
    s_add_u32 m0, s50, 9216
    s_nop 0
    buffer_load_dwordx4 v19, s[16:19], s46 offen lds
    s_add_u32 m0, s50, 10240
    s_nop 0
    buffer_load_dwordx4 v20, s[16:19], s46 offen lds
    s_add_u32 m0, s50, 11264
    s_nop 0
    buffer_load_dwordx4 v21, s[16:19], s46 offen lds
    s_waitcnt vmcnt(18)
    ds_read_b64_tr_b16 v[52:53], v25 offset:12288
    ds_read_b64_tr_b16 v[54:55], v25 offset:13056
    ds_read_b64_tr_b16 a[48:49], v25 offset:12296
    ds_read_b64_tr_b16 a[50:51], v25 offset:13064
    ds_read_b64_tr_b16 a[56:57], v25 offset:12352
    ds_read_b64_tr_b16 a[58:59], v25 offset:13120
    ds_read_b64_tr_b16 a[64:65], v25 offset:12360
    ds_read_b64_tr_b16 a[66:67], v25 offset:13128
    ds_read_b64_tr_b16 a[72:73], v25 offset:12416
    ds_read_b64_tr_b16 a[74:75], v25 offset:13184
    ds_read_b64_tr_b16 a[80:81], v25 offset:12424
    ds_read_b64_tr_b16 a[82:83], v25 offset:13192
    s_waitcnt lgkmcnt(0)
    ds_write_b128 v7, v[52:55] offset:0
    s_add_u32 s46, s51, 2359296
    s_add_u32 m0, s50, 12288
    s_nop 0
    buffer_load_dwordx4 v16, s[16:19], s46 offen lds
    s_add_u32 m0, s50, 13312
    s_nop 0
    buffer_load_dwordx4 v17, s[16:19], s46 offen lds
    s_add_u32 m0, s50, 14336
    s_nop 0
    buffer_load_dwordx4 v18, s[16:19], s46 offen lds
    s_add_u32 m0, s50, 15360
    s_nop 0
    buffer_load_dwordx4 v19, s[16:19], s46 offen lds
    s_add_u32 m0, s50, 16384
    s_nop 0
    buffer_load_dwordx4 v20, s[16:19], s46 offen lds
    s_add_u32 m0, s50, 17408
    s_nop 0
    buffer_load_dwordx4 v21, s[16:19], s46 offen lds
    s_waitcnt vmcnt(18)
    ds_read_b64_tr_b16 v[52:53], v25 offset:18432
    ds_read_b64_tr_b16 v[54:55], v25 offset:19200
    ds_read_b64_tr_b16 a[52:53], v25 offset:18440
    ds_read_b64_tr_b16 a[54:55], v25 offset:19208
    ds_read_b64_tr_b16 a[60:61], v25 offset:18496
    ds_read_b64_tr_b16 a[62:63], v25 offset:19264
    ds_read_b64_tr_b16 a[68:69], v25 offset:18504
    ds_read_b64_tr_b16 a[70:71], v25 offset:19272
    ds_read_b64_tr_b16 a[76:77], v25 offset:18560
    ds_read_b64_tr_b16 a[78:79], v25 offset:19328
    ds_read_b64_tr_b16 a[84:85], v25 offset:18568
    ds_read_b64_tr_b16 a[86:87], v25 offset:19336
    s_waitcnt lgkmcnt(0)
    ds_write_b128 v7, v[52:55] offset:1024
    s_add_u32 s46, s51, 2752512
    s_add_u32 m0, s50, 18432
    s_nop 0
    buffer_load_dwordx4 v16, s[16:19], s46 offen lds
    s_add_u32 m0, s50, 19456
    s_nop 0
    buffer_load_dwordx4 v17, s[16:19], s46 offen lds
    s_add_u32 m0, s50, 20480
    s_nop 0
    buffer_load_dwordx4 v18, s[16:19], s46 offen lds
    s_add_u32 m0, s50, 21504
    s_nop 0
    buffer_load_dwordx4 v19, s[16:19], s46 offen lds
    s_add_u32 m0, s50, 22528
    s_nop 0
    buffer_load_dwordx4 v20, s[16:19], s46 offen lds
    s_add_u32 m0, s50, 23552
    s_nop 0
    buffer_load_dwordx4 v21, s[16:19], s46 offen lds
    s_waitcnt vmcnt(18)
    ds_read_b64_tr_b16 a[88:89], v25 offset:0
    ds_read_b64_tr_b16 a[90:91], v25 offset:768
    ds_read_b64_tr_b16 a[96:97], v25 offset:8
    ds_read_b64_tr_b16 a[98:99], v25 offset:776
    ds_read_b64_tr_b16 a[104:105], v25 offset:64
    ds_read_b64_tr_b16 a[106:107], v25 offset:832
    ds_read_b64_tr_b16 a[112:113], v25 offset:72
    ds_read_b64_tr_b16 a[114:115], v25 offset:840
    ds_read_b64_tr_b16 a[120:121], v25 offset:128
    ds_read_b64_tr_b16 a[122:123], v25 offset:896
    ds_read_b64_tr_b16 a[128:129], v25 offset:136
    ds_read_b64_tr_b16 a[130:131], v25 offset:904
    s_waitcnt lgkmcnt(0)
    s_add_u32 s46, s51, 3145728
    s_add_u32 m0, s50, 0
    s_nop 0
    buffer_load_dwordx4 v16, s[16:19], s46 offen lds
    s_add_u32 m0, s50, 1024
    s_nop 0
    buffer_load_dwordx4 v17, s[16:19], s46 offen lds
    s_add_u32 m0, s50, 2048
    s_nop 0
    buffer_load_dwordx4 v18, s[16:19], s46 offen lds
    s_add_u32 m0, s50, 3072
    s_nop 0
    buffer_load_dwordx4 v19, s[16:19], s46 offen lds
    s_add_u32 m0, s50, 4096
    s_nop 0
    buffer_load_dwordx4 v20, s[16:19], s46 offen lds
    s_add_u32 m0, s50, 5120
    s_nop 0
    buffer_load_dwordx4 v21, s[16:19], s46 offen lds
    s_waitcnt vmcnt(18)
    ds_read_b64_tr_b16 a[92:93], v25 offset:6144
    ds_read_b64_tr_b16 a[94:95], v25 offset:6912
    ds_read_b64_tr_b16 a[100:101], v25 offset:6152
    ds_read_b64_tr_b16 a[102:103], v25 offset:6920
    ds_read_b64_tr_b16 a[108:109], v25 offset:6208
    ds_read_b64_tr_b16 a[110:111], v25 offset:6976
    ds_read_b64_tr_b16 a[116:117], v25 offset:6216
    ds_read_b64_tr_b16 a[118:119], v25 offset:6984
    ds_read_b64_tr_b16 a[124:125], v25 offset:6272
    ds_read_b64_tr_b16 a[126:127], v25 offset:7040
    ds_read_b64_tr_b16 a[132:133], v25 offset:6280
    ds_read_b64_tr_b16 a[134:135], v25 offset:7048
    s_waitcnt lgkmcnt(0)
    s_add_u32 s46, s51, 3538944
    s_add_u32 m0, s50, 6144
    s_nop 0
    buffer_load_dwordx4 v16, s[16:19], s46 offen lds
    s_add_u32 m0, s50, 7168
    s_nop 0
    buffer_load_dwordx4 v17, s[16:19], s46 offen lds
    s_add_u32 m0, s50, 8192
    s_nop 0
    buffer_load_dwordx4 v18, s[16:19], s46 offen lds
    s_add_u32 m0, s50, 9216
    s_nop 0
    buffer_load_dwordx4 v19, s[16:19], s46 offen lds
    s_add_u32 m0, s50, 10240
    s_nop 0
    buffer_load_dwordx4 v20, s[16:19], s46 offen lds
    s_add_u32 m0, s50, 11264
    s_nop 0
    buffer_load_dwordx4 v21, s[16:19], s46 offen lds
    s_waitcnt vmcnt(18)
    ds_read_b64_tr_b16 v[52:53], v25 offset:12288
    ds_read_b64_tr_b16 v[54:55], v25 offset:13056
    ds_read_b64_tr_b16 a[136:137], v25 offset:12296
    ds_read_b64_tr_b16 a[138:139], v25 offset:13064
    ds_read_b64_tr_b16 a[144:145], v25 offset:12352
    ds_read_b64_tr_b16 a[146:147], v25 offset:13120
    ds_read_b64_tr_b16 a[152:153], v25 offset:12360
    ds_read_b64_tr_b16 a[154:155], v25 offset:13128
    ds_read_b64_tr_b16 a[160:161], v25 offset:12416
    ds_read_b64_tr_b16 a[162:163], v25 offset:13184
    ds_read_b64_tr_b16 a[168:169], v25 offset:12424
    ds_read_b64_tr_b16 a[170:171], v25 offset:13192
    s_waitcnt lgkmcnt(0)
    ds_write_b128 v7, v[52:55] offset:2048
    s_add_u32 s46, s51, 3932160
    s_add_u32 m0, s50, 12288
    s_nop 0
    buffer_load_dwordx4 v16, s[16:19], s46 offen lds
    s_add_u32 m0, s50, 13312
    s_nop 0
    buffer_load_dwordx4 v17, s[16:19], s46 offen lds
    s_add_u32 m0, s50, 14336
    s_nop 0
    buffer_load_dwordx4 v18, s[16:19], s46 offen lds
    s_add_u32 m0, s50, 15360
    s_nop 0
    buffer_load_dwordx4 v19, s[16:19], s46 offen lds
    s_add_u32 m0, s50, 16384
    s_nop 0
    buffer_load_dwordx4 v20, s[16:19], s46 offen lds
    s_add_u32 m0, s50, 17408
    s_nop 0
    buffer_load_dwordx4 v21, s[16:19], s46 offen lds
    s_waitcnt vmcnt(18)
    ds_read_b64_tr_b16 v[52:53], v25 offset:18432
    ds_read_b64_tr_b16 v[54:55], v25 offset:19200
    ds_read_b64_tr_b16 a[140:141], v25 offset:18440
    ds_read_b64_tr_b16 a[142:143], v25 offset:19208
    ds_read_b64_tr_b16 a[148:149], v25 offset:18496
    ds_read_b64_tr_b16 a[150:151], v25 offset:19264
    ds_read_b64_tr_b16 a[156:157], v25 offset:18504
    ds_read_b64_tr_b16 a[158:159], v25 offset:19272
    ds_read_b64_tr_b16 a[164:165], v25 offset:18560
    ds_read_b64_tr_b16 a[166:167], v25 offset:19328
    ds_read_b64_tr_b16 a[172:173], v25 offset:18568
    ds_read_b64_tr_b16 a[174:175], v25 offset:19336
    s_waitcnt lgkmcnt(0)
    ds_write_b128 v7, v[52:55] offset:3072
    s_add_u32 s46, s51, 4325376
    s_add_u32 m0, s50, 18432
    s_nop 0
    buffer_load_dwordx4 v16, s[16:19], s46 offen lds
    s_add_u32 m0, s50, 19456
    s_nop 0
    buffer_load_dwordx4 v17, s[16:19], s46 offen lds
    s_add_u32 m0, s50, 20480
    s_nop 0
    buffer_load_dwordx4 v18, s[16:19], s46 offen lds
    s_add_u32 m0, s50, 21504
    s_nop 0
    buffer_load_dwordx4 v19, s[16:19], s46 offen lds
    s_add_u32 m0, s50, 22528
    s_nop 0
    buffer_load_dwordx4 v20, s[16:19], s46 offen lds
    s_add_u32 m0, s50, 23552
    s_nop 0
    buffer_load_dwordx4 v21, s[16:19], s46 offen lds
    s_waitcnt vmcnt(18)
    ds_read_b64_tr_b16 a[176:177], v25 offset:0
    ds_read_b64_tr_b16 a[178:179], v25 offset:768
    ds_read_b64_tr_b16 a[184:185], v25 offset:8
    ds_read_b64_tr_b16 a[186:187], v25 offset:776
    ds_read_b64_tr_b16 a[192:193], v25 offset:64
    ds_read_b64_tr_b16 a[194:195], v25 offset:832
    ds_read_b64_tr_b16 a[200:201], v25 offset:72
    ds_read_b64_tr_b16 a[202:203], v25 offset:840
    ds_read_b64_tr_b16 a[208:209], v25 offset:128
    ds_read_b64_tr_b16 a[210:211], v25 offset:896
    ds_read_b64_tr_b16 a[216:217], v25 offset:136
    ds_read_b64_tr_b16 a[218:219], v25 offset:904
    s_waitcnt lgkmcnt(0)
    s_add_u32 s46, s51, 4718592
    s_add_u32 m0, s50, 0
    s_nop 0
    buffer_load_dwordx4 v16, s[16:19], s46 offen lds
    s_add_u32 m0, s50, 1024
    s_nop 0
    buffer_load_dwordx4 v17, s[16:19], s46 offen lds
    s_add_u32 m0, s50, 2048
    s_nop 0
    buffer_load_dwordx4 v18, s[16:19], s46 offen lds
    s_add_u32 m0, s50, 3072
    s_nop 0
    buffer_load_dwordx4 v19, s[16:19], s46 offen lds
    s_add_u32 m0, s50, 4096
    s_nop 0
    buffer_load_dwordx4 v20, s[16:19], s46 offen lds
    s_add_u32 m0, s50, 5120
    s_nop 0
    buffer_load_dwordx4 v21, s[16:19], s46 offen lds
    s_waitcnt vmcnt(18)
    ds_read_b64_tr_b16 a[180:181], v25 offset:6144
    ds_read_b64_tr_b16 a[182:183], v25 offset:6912
    ds_read_b64_tr_b16 a[188:189], v25 offset:6152
    ds_read_b64_tr_b16 a[190:191], v25 offset:6920
    ds_read_b64_tr_b16 a[196:197], v25 offset:6208
    ds_read_b64_tr_b16 a[198:199], v25 offset:6976
    ds_read_b64_tr_b16 a[204:205], v25 offset:6216
    ds_read_b64_tr_b16 a[206:207], v25 offset:6984
    ds_read_b64_tr_b16 a[212:213], v25 offset:6272
    ds_read_b64_tr_b16 a[214:215], v25 offset:7040
    ds_read_b64_tr_b16 a[220:221], v25 offset:6280
    ds_read_b64_tr_b16 a[222:223], v25 offset:7048
    s_waitcnt lgkmcnt(0)
    s_add_u32 s46, s51, 5111808
    s_add_u32 m0, s50, 6144
    s_nop 0
    buffer_load_dwordx4 v16, s[16:19], s46 offen lds
    s_add_u32 m0, s50, 7168
    s_nop 0
    buffer_load_dwordx4 v17, s[16:19], s46 offen lds
    s_add_u32 m0, s50, 8192
    s_nop 0
    buffer_load_dwordx4 v18, s[16:19], s46 offen lds
    s_add_u32 m0, s50, 9216
    s_nop 0
    buffer_load_dwordx4 v19, s[16:19], s46 offen lds
    s_add_u32 m0, s50, 10240
    s_nop 0
    buffer_load_dwordx4 v20, s[16:19], s46 offen lds
    s_add_u32 m0, s50, 11264
    s_nop 0
    buffer_load_dwordx4 v21, s[16:19], s46 offen lds
    s_waitcnt vmcnt(18)
    ds_read_b64_tr_b16 a[224:225], v25 offset:12288
    ds_read_b64_tr_b16 a[226:227], v25 offset:13056
    ds_read_b64_tr_b16 a[232:233], v25 offset:12296
    ds_read_b64_tr_b16 a[234:235], v25 offset:13064
    ds_read_b64_tr_b16 a[240:241], v25 offset:12352
    ds_read_b64_tr_b16 a[242:243], v25 offset:13120
    ds_read_b64_tr_b16 a[248:249], v25 offset:12360
    ds_read_b64_tr_b16 a[250:251], v25 offset:13128
    ds_read_b64_tr_b16 v[60:61], v25 offset:12416
    ds_read_b64_tr_b16 v[62:63], v25 offset:13184
    ds_read_b64_tr_b16 v[68:69], v25 offset:12424
    ds_read_b64_tr_b16 v[70:71], v25 offset:13192
    s_waitcnt lgkmcnt(0)
    s_add_u32 s46, s51, 5505024
    s_add_u32 m0, s50, 12288
    s_nop 0
    buffer_load_dwordx4 v16, s[16:19], s46 offen lds
    s_add_u32 m0, s50, 13312
    s_nop 0
    buffer_load_dwordx4 v17, s[16:19], s46 offen lds
    s_add_u32 m0, s50, 14336
    s_nop 0
    buffer_load_dwordx4 v18, s[16:19], s46 offen lds
    s_add_u32 m0, s50, 15360
    s_nop 0
    buffer_load_dwordx4 v19, s[16:19], s46 offen lds
    s_add_u32 m0, s50, 16384
    s_nop 0
    buffer_load_dwordx4 v20, s[16:19], s46 offen lds
    s_add_u32 m0, s50, 17408
    s_nop 0
    buffer_load_dwordx4 v21, s[16:19], s46 offen lds
    s_waitcnt vmcnt(18)
    ds_read_b64_tr_b16 a[228:229], v25 offset:18432
    ds_read_b64_tr_b16 a[230:231], v25 offset:19200
    ds_read_b64_tr_b16 a[236:237], v25 offset:18440
    ds_read_b64_tr_b16 a[238:239], v25 offset:19208
    ds_read_b64_tr_b16 a[244:245], v25 offset:18496
    ds_read_b64_tr_b16 a[246:247], v25 offset:19264
    ds_read_b64_tr_b16 a[252:253], v25 offset:18504
    ds_read_b64_tr_b16 a[254:255], v25 offset:19272
    ds_read_b64_tr_b16 v[64:65], v25 offset:18560
    ds_read_b64_tr_b16 v[66:67], v25 offset:19328
    ds_read_b64_tr_b16 v[72:73], v25 offset:18568
    ds_read_b64_tr_b16 v[74:75], v25 offset:19336
    s_waitcnt lgkmcnt(0)
    s_add_u32 s46, s51, 5898240
    s_add_u32 m0, s50, 18432
    s_nop 0
    buffer_load_dwordx4 v16, s[16:19], s46 offen lds
    s_add_u32 m0, s50, 19456
    s_nop 0
    buffer_load_dwordx4 v17, s[16:19], s46 offen lds
    s_add_u32 m0, s50, 20480
    s_nop 0
    buffer_load_dwordx4 v18, s[16:19], s46 offen lds
    s_add_u32 m0, s50, 21504
    s_nop 0
    buffer_load_dwordx4 v19, s[16:19], s46 offen lds
    s_add_u32 m0, s50, 22528
    s_nop 0
    buffer_load_dwordx4 v20, s[16:19], s46 offen lds
    s_add_u32 m0, s50, 23552
    s_nop 0
    buffer_load_dwordx4 v21, s[16:19], s46 offen lds
    s_waitcnt vmcnt(18)
    ds_read_b64_tr_b16 v[52:53], v25 offset:0
    ds_read_b64_tr_b16 v[54:55], v25 offset:768
    ds_read_b64_tr_b16 v[76:77], v25 offset:8
    ds_read_b64_tr_b16 v[78:79], v25 offset:776
    ds_read_b64_tr_b16 v[84:85], v25 offset:64
    ds_read_b64_tr_b16 v[86:87], v25 offset:832
    ds_read_b64_tr_b16 v[92:93], v25 offset:72
    ds_read_b64_tr_b16 v[94:95], v25 offset:840
    ds_read_b64_tr_b16 v[100:101], v25 offset:128
    ds_read_b64_tr_b16 v[102:103], v25 offset:896
    ds_read_b64_tr_b16 v[108:109], v25 offset:136
    ds_read_b64_tr_b16 v[110:111], v25 offset:904
    s_waitcnt lgkmcnt(0)
    ds_write_b128 v7, v[52:55] offset:4096
    s_add_u32 s46, s51, 6291456
    s_add_u32 m0, s50, 0
    s_nop 0
    buffer_load_dwordx4 v16, s[16:19], s46 offen lds
    s_add_u32 m0, s50, 1024
    s_nop 0
    buffer_load_dwordx4 v17, s[16:19], s46 offen lds
    s_add_u32 m0, s50, 2048
    s_nop 0
    buffer_load_dwordx4 v18, s[16:19], s46 offen lds
    s_add_u32 m0, s50, 3072
    s_nop 0
    buffer_load_dwordx4 v19, s[16:19], s46 offen lds
    s_add_u32 m0, s50, 4096
    s_nop 0
    buffer_load_dwordx4 v20, s[16:19], s46 offen lds
    s_add_u32 m0, s50, 5120
    s_nop 0
    buffer_load_dwordx4 v21, s[16:19], s46 offen lds
    s_waitcnt vmcnt(18)
    ds_read_b64_tr_b16 v[52:53], v25 offset:6144
    ds_read_b64_tr_b16 v[54:55], v25 offset:6912
    ds_read_b64_tr_b16 v[80:81], v25 offset:6152
    ds_read_b64_tr_b16 v[82:83], v25 offset:6920
    ds_read_b64_tr_b16 v[88:89], v25 offset:6208
    ds_read_b64_tr_b16 v[90:91], v25 offset:6976
    ds_read_b64_tr_b16 v[96:97], v25 offset:6216
    ds_read_b64_tr_b16 v[98:99], v25 offset:6984
    ds_read_b64_tr_b16 v[104:105], v25 offset:6272
    ds_read_b64_tr_b16 v[106:107], v25 offset:7040
    ds_read_b64_tr_b16 v[112:113], v25 offset:6280
    ds_read_b64_tr_b16 v[114:115], v25 offset:7048
    s_waitcnt lgkmcnt(0)
    ds_write_b128 v7, v[52:55] offset:5120
    s_add_u32 s46, s51, 6684672
    s_add_u32 m0, s50, 6144
    s_nop 0
    buffer_load_dwordx4 v16, s[16:19], s46 offen lds
    s_add_u32 m0, s50, 7168
    s_nop 0
    buffer_load_dwordx4 v17, s[16:19], s46 offen lds
    s_add_u32 m0, s50, 8192
    s_nop 0
    buffer_load_dwordx4 v18, s[16:19], s46 offen lds
    s_add_u32 m0, s50, 9216
    s_nop 0
    buffer_load_dwordx4 v19, s[16:19], s46 offen lds
    s_add_u32 m0, s50, 10240
    s_nop 0
    buffer_load_dwordx4 v20, s[16:19], s46 offen lds
    s_add_u32 m0, s50, 11264
    s_nop 0
    buffer_load_dwordx4 v21, s[16:19], s46 offen lds
    s_waitcnt vmcnt(18)
    ds_read_b64_tr_b16 v[116:117], v25 offset:12288
    ds_read_b64_tr_b16 v[118:119], v25 offset:13056
    ds_read_b64_tr_b16 v[124:125], v25 offset:12296
    ds_read_b64_tr_b16 v[126:127], v25 offset:13064
    ds_read_b64_tr_b16 v[132:133], v25 offset:12352
    ds_read_b64_tr_b16 v[134:135], v25 offset:13120
    ds_read_b64_tr_b16 v[140:141], v25 offset:12360
    ds_read_b64_tr_b16 v[142:143], v25 offset:13128
    ds_read_b64_tr_b16 v[148:149], v25 offset:12416
    ds_read_b64_tr_b16 v[150:151], v25 offset:13184
    ds_read_b64_tr_b16 v[156:157], v25 offset:12424
    ds_read_b64_tr_b16 v[158:159], v25 offset:13192
    s_waitcnt lgkmcnt(0)
    s_add_u32 s46, s51, 7077888
    s_add_u32 m0, s50, 12288
    s_nop 0
    buffer_load_dwordx4 v16, s[16:19], s46 offen lds
    s_add_u32 m0, s50, 13312
    s_nop 0
    buffer_load_dwordx4 v17, s[16:19], s46 offen lds
    s_add_u32 m0, s50, 14336
    s_nop 0
    buffer_load_dwordx4 v18, s[16:19], s46 offen lds
    s_add_u32 m0, s50, 15360
    s_nop 0
    buffer_load_dwordx4 v19, s[16:19], s46 offen lds
    s_add_u32 m0, s50, 16384
    s_nop 0
    buffer_load_dwordx4 v20, s[16:19], s46 offen lds
    s_add_u32 m0, s50, 17408
    s_nop 0
    buffer_load_dwordx4 v21, s[16:19], s46 offen lds
    s_waitcnt vmcnt(18)
    ds_read_b64_tr_b16 v[120:121], v25 offset:18432
    ds_read_b64_tr_b16 v[122:123], v25 offset:19200
    ds_read_b64_tr_b16 v[128:129], v25 offset:18440
    ds_read_b64_tr_b16 v[130:131], v25 offset:19208
    ds_read_b64_tr_b16 v[136:137], v25 offset:18496
    ds_read_b64_tr_b16 v[138:139], v25 offset:19264
    ds_read_b64_tr_b16 v[144:145], v25 offset:18504
    ds_read_b64_tr_b16 v[146:147], v25 offset:19272
    ds_read_b64_tr_b16 v[152:153], v25 offset:18560
    ds_read_b64_tr_b16 v[154:155], v25 offset:19328
    ds_read_b64_tr_b16 v[160:161], v25 offset:18568
    ds_read_b64_tr_b16 v[162:163], v25 offset:19336
    s_waitcnt lgkmcnt(0)
    s_add_u32 s46, s51, 7471104
    s_add_u32 m0, s50, 18432
    s_nop 0
    buffer_load_dwordx4 v16, s[16:19], s46 offen lds
    s_add_u32 m0, s50, 19456
    s_nop 0
    buffer_load_dwordx4 v17, s[16:19], s46 offen lds
    s_add_u32 m0, s50, 20480
    s_nop 0
    buffer_load_dwordx4 v18, s[16:19], s46 offen lds
    s_add_u32 m0, s50, 21504
    s_nop 0
    buffer_load_dwordx4 v19, s[16:19], s46 offen lds
    s_add_u32 m0, s50, 22528
    s_nop 0
    buffer_load_dwordx4 v20, s[16:19], s46 offen lds
    s_add_u32 m0, s50, 23552
    s_nop 0
    buffer_load_dwordx4 v21, s[16:19], s46 offen lds
    s_waitcnt vmcnt(18)
    ds_read_b64_tr_b16 v[52:53], v25 offset:0
    ds_read_b64_tr_b16 v[54:55], v25 offset:768
    ds_read_b64_tr_b16 v[164:165], v25 offset:8
    ds_read_b64_tr_b16 v[166:167], v25 offset:776
    ds_read_b64_tr_b16 v[172:173], v25 offset:64
    ds_read_b64_tr_b16 v[174:175], v25 offset:832
    ds_read_b64_tr_b16 v[180:181], v25 offset:72
    ds_read_b64_tr_b16 v[182:183], v25 offset:840
    ds_read_b64_tr_b16 v[188:189], v25 offset:128
    ds_read_b64_tr_b16 v[190:191], v25 offset:896
    ds_read_b64_tr_b16 v[196:197], v25 offset:136
    ds_read_b64_tr_b16 v[198:199], v25 offset:904
    s_waitcnt lgkmcnt(0)
    ds_write_b128 v7, v[52:55] offset:6144
    s_waitcnt vmcnt(12)
    ds_read_b64_tr_b16 v[52:53], v25 offset:6144
    ds_read_b64_tr_b16 v[54:55], v25 offset:6912
    ds_read_b64_tr_b16 v[168:169], v25 offset:6152
    ds_read_b64_tr_b16 v[170:171], v25 offset:6920
    ds_read_b64_tr_b16 v[176:177], v25 offset:6208
    ds_read_b64_tr_b16 v[178:179], v25 offset:6976
    ds_read_b64_tr_b16 v[184:185], v25 offset:6216
    ds_read_b64_tr_b16 v[186:187], v25 offset:6984
    ds_read_b64_tr_b16 v[192:193], v25 offset:6272
    ds_read_b64_tr_b16 v[194:195], v25 offset:7040
    ds_read_b64_tr_b16 v[200:201], v25 offset:6280
    ds_read_b64_tr_b16 v[202:203], v25 offset:7048
    s_waitcnt lgkmcnt(0)
    ds_write_b128 v7, v[52:55] offset:7168
    s_waitcnt vmcnt(6)
    ds_read_b64_tr_b16 v[204:205], v25 offset:12288
    ds_read_b64_tr_b16 v[206:207], v25 offset:13056
    ds_read_b64_tr_b16 v[212:213], v25 offset:12296
    ds_read_b64_tr_b16 v[214:215], v25 offset:13064
    ds_read_b64_tr_b16 v[220:221], v25 offset:12352
    ds_read_b64_tr_b16 v[222:223], v25 offset:13120
    ds_read_b64_tr_b16 v[228:229], v25 offset:12360
    ds_read_b64_tr_b16 v[230:231], v25 offset:13128
    ds_read_b64_tr_b16 v[236:237], v25 offset:12416
    ds_read_b64_tr_b16 v[238:239], v25 offset:13184
    ds_read_b64_tr_b16 v[244:245], v25 offset:12424
    ds_read_b64_tr_b16 v[246:247], v25 offset:13192
    s_waitcnt lgkmcnt(0)
    s_waitcnt vmcnt(0)
    ds_read_b64_tr_b16 v[208:209], v25 offset:18432
    ds_read_b64_tr_b16 v[210:211], v25 offset:19200
    ds_read_b64_tr_b16 v[216:217], v25 offset:18440
    ds_read_b64_tr_b16 v[218:219], v25 offset:19208
    ds_read_b64_tr_b16 v[224:225], v25 offset:18496
    ds_read_b64_tr_b16 v[226:227], v25 offset:19264
    ds_read_b64_tr_b16 v[232:233], v25 offset:18504
    ds_read_b64_tr_b16 v[234:235], v25 offset:19272
    ds_read_b64_tr_b16 v[240:241], v25 offset:18560
    ds_read_b64_tr_b16 v[242:243], v25 offset:19328
    ds_read_b64_tr_b16 v[248:249], v25 offset:18568
    ds_read_b64_tr_b16 v[250:251], v25 offset:19336
    s_waitcnt lgkmcnt(0)
    s_waitcnt lgkmcnt(0)
    v_lshrrev_b32 v1, 4, v0
    v_and_b32 v2, 15, v0
    v_mul_u32_u24 v2, 1280, v2
    v_lshl_add_u32 v4, v1, 4, v2
    s_mul_i32 s45, s33, 320
    v_add_u32 v4, s45, v4
    v_lshlrev_b32 v5, 4, v0
    v_add_u32 v5, 32768, v5
    s_mul_i32 s52, s33, 10240
    s_add_u32 s52, s52, 32768
    v_lshlrev_b32 v8, 4, v0
    s_mul_i32 s53, s32, 24576
    s_cmp_lt_u32 s33, 2
    s_cselect_b32 s45, 12288, 0
    s_add_u32 s53, s53, s45
    s_and_b32 s45, s33, 1
    s_mul_i32 s45, s45, 3072
    s_add_u32 s53, s53, s45
    s_add_u32 s53, s53, 50331648
    s_barrier
    s_mul_i32 s45, s34, 40960
    s_and_b32 s46, s34, 1
    s_mul_i32 s46, s46, 40960
    s_add_u32 s46, s46, s52
    s_add_u32 m0, s46, 0
    s_add_u32 s47, s45, 0
    buffer_load_dwordx4 v4, s[12:15], s47 offen lds
    s_add_u32 m0, s46, 1024
    s_add_u32 s47, s45, 20480
    buffer_load_dwordx4 v4, s[12:15], s47 offen lds
    s_add_u32 m0, s46, 2048
    s_add_u32 s47, s45, 64
    buffer_load_dwordx4 v4, s[12:15], s47 offen lds
    s_add_u32 m0, s46, 3072
    s_add_u32 s47, s45, 20544
    buffer_load_dwordx4 v4, s[12:15], s47 offen lds
    s_add_u32 m0, s46, 4096
    s_add_u32 s47, s45, 128
    buffer_load_dwordx4 v4, s[12:15], s47 offen lds
    s_add_u32 m0, s46, 5120
    s_add_u32 s47, s45, 20608
    buffer_load_dwordx4 v4, s[12:15], s47 offen lds
    s_add_u32 m0, s46, 6144
    s_add_u32 s47, s45, 192
    buffer_load_dwordx4 v4, s[12:15], s47 offen lds
    s_add_u32 m0, s46, 7168
    s_add_u32 s47, s45, 20672
    buffer_load_dwordx4 v4, s[12:15], s47 offen lds
    s_add_u32 m0, s46, 8192
    s_add_u32 s47, s45, 256
    buffer_load_dwordx4 v4, s[12:15], s47 offen lds
    s_add_u32 m0, s46, 9216
    s_add_u32 s47, s45, 20736
    buffer_load_dwordx4 v4, s[12:15], s47 offen lds
R4L_80:
    s_cmp_le_u32 s34, 1
    s_cbranch_scc1 R4W_81
    s_waitcnt vmcnt(6)
    s_sub_u32 s55, s34, 1
    s_branch R4W_82
R4W_81:
    s_waitcnt vmcnt(0)
    s_mov_b32 s55, s34
R4W_82:
    s_barrier
    s_cmp_lg_u32 s33, 0
    s_cbranch_scc1 R4F_83
    v_mov_b32 v1, s55
    v_mov_b32 v2, s54
    s_mov_b64 exec, 1
    buffer_store_dword v1, v2, s[8:11], 0 offen sc1
    s_mov_b64 exec, -1
R4F_83:
    s_add_u32 s45, s34, 1
    s_and_b32 s64, s45, 1
    s_mul_i32 s64, s64, 40960
    s_add_u32 s64, s64, s52
    s_min_u32 s45, s45, 63
    s_mul_i32 s63, s45, 40960
    s_and_b32 s45, s34, 1
    s_mul_i32 s45, s45, 40960
    v_add_u32 v6, s45, v5
    s_mul_i32 s57, s34, 786432
    s_add_u32 s57, s57, s53
    ds_read_b128 v[40:43], v6 offset:0
    ds_read_b128 v[44:47], v6 offset:2048
    ds_read_b128 v[52:55], v7 offset:0
    ds_read_b128 v[56:59], v7 offset:1024
    ds_read_b128 v[48:51], v6 offset:4096
    s_waitcnt lgkmcnt(4)
    v_mfma_f32_16x16x32_bf16 v[36:39], a[40:43], v[40:43], 0
    v_mfma_f32_16x16x32_bf16 v[32:35], a[32:35], v[40:43], 0
    v_mfma_f32_16x16x32_bf16 v[28:31], a[24:27], v[40:43], 0
    v_mfma_f32_16x16x32_bf16 v[24:27], a[16:19], v[40:43], 0
    v_mfma_f32_16x16x32_bf16 v[20:23], a[8:11], v[40:43], 0
    v_mfma_f32_16x16x32_bf16 v[16:19], a[0:3], v[40:43], 0
    s_add_u32 m0, s64, 0
    s_add_u32 s47, s63, 0
    buffer_load_dwordx4 v4, s[12:15], s47 offen lds
    ds_read_b128 v[40:43], v6 offset:6144
    s_waitcnt lgkmcnt(4)
    v_mfma_f32_16x16x32_bf16 v[36:39], a[44:47], v[44:47], v[36:39]
    v_mfma_f32_16x16x32_bf16 v[32:35], a[36:39], v[44:47], v[32:35]
    v_mfma_f32_16x16x32_bf16 v[28:31], a[28:31], v[44:47], v[28:31]
    v_mfma_f32_16x16x32_bf16 v[24:27], a[20:23], v[44:47], v[24:27]
    v_mfma_f32_16x16x32_bf16 v[20:23], a[12:15], v[44:47], v[20:23]
    v_mfma_f32_16x16x32_bf16 v[16:19], a[4:7], v[44:47], v[16:19]
    ds_read_b128 v[44:47], v6 offset:8192
    s_waitcnt lgkmcnt(2)
    v_mfma_f32_16x16x32_bf16 v[36:39], a[80:83], v[48:51], v[36:39]
    v_mfma_f32_16x16x32_bf16 v[32:35], a[72:75], v[48:51], v[32:35]
    v_mfma_f32_16x16x32_bf16 v[28:31], a[64:67], v[48:51], v[28:31]
    v_mfma_f32_16x16x32_bf16 v[24:27], a[56:59], v[48:51], v[24:27]
    v_mfma_f32_16x16x32_bf16 v[20:23], a[48:51], v[48:51], v[20:23]
    v_mfma_f32_16x16x32_bf16 v[16:19], v[52:55], v[48:51], v[16:19]
    s_add_u32 m0, s64, 1024
    s_add_u32 s47, s63, 20480
    buffer_load_dwordx4 v4, s[12:15], s47 offen lds
    ds_read_b128 v[48:51], v6 offset:10240
    s_waitcnt lgkmcnt(2)
    v_mfma_f32_16x16x32_bf16 v[36:39], a[84:87], v[40:43], v[36:39]
    v_mfma_f32_16x16x32_bf16 v[32:35], a[76:79], v[40:43], v[32:35]
    v_mfma_f32_16x16x32_bf16 v[28:31], a[68:71], v[40:43], v[28:31]
    v_mfma_f32_16x16x32_bf16 v[24:27], a[60:63], v[40:43], v[24:27]
    v_mfma_f32_16x16x32_bf16 v[20:23], a[52:55], v[40:43], v[20:23]
    v_mfma_f32_16x16x32_bf16 v[16:19], v[56:59], v[40:43], v[16:19]
    ds_read_b128 v[52:55], v7 offset:2048
    ds_read_b128 v[56:59], v7 offset:3072
    ds_read_b128 v[40:43], v6 offset:12288
    s_waitcnt lgkmcnt(4)
    v_mfma_f32_16x16x32_bf16 v[36:39], a[128:131], v[44:47], v[36:39]
    v_mfma_f32_16x16x32_bf16 v[32:35], a[120:123], v[44:47], v[32:35]
    v_mfma_f32_16x16x32_bf16 v[28:31], a[112:115], v[44:47], v[28:31]
    v_mfma_f32_16x16x32_bf16 v[24:27], a[104:107], v[44:47], v[24:27]
    v_mfma_f32_16x16x32_bf16 v[20:23], a[96:99], v[44:47], v[20:23]
    v_mfma_f32_16x16x32_bf16 v[16:19], a[88:91], v[44:47], v[16:19]
    s_add_u32 m0, s64, 2048
    s_add_u32 s47, s63, 64
    buffer_load_dwordx4 v4, s[12:15], s47 offen lds
    ds_read_b128 v[44:47], v6 offset:14336
    s_waitcnt lgkmcnt(4)
    v_mfma_f32_16x16x32_bf16 v[36:39], a[132:135], v[48:51], v[36:39]
    v_mfma_f32_16x16x32_bf16 v[32:35], a[124:127], v[48:51], v[32:35]
    v_mfma_f32_16x16x32_bf16 v[28:31], a[116:119], v[48:51], v[28:31]
    v_mfma_f32_16x16x32_bf16 v[24:27], a[108:111], v[48:51], v[24:27]
    v_mfma_f32_16x16x32_bf16 v[20:23], a[100:103], v[48:51], v[20:23]
    v_mfma_f32_16x16x32_bf16 v[16:19], a[92:95], v[48:51], v[16:19]
    ds_read_b128 v[48:51], v6 offset:16384
    s_waitcnt lgkmcnt(2)
    v_mfma_f32_16x16x32_bf16 v[36:39], a[168:171], v[40:43], v[36:39]
    v_mfma_f32_16x16x32_bf16 v[32:35], a[160:163], v[40:43], v[32:35]
    v_mfma_f32_16x16x32_bf16 v[28:31], a[152:155], v[40:43], v[28:31]
    v_mfma_f32_16x16x32_bf16 v[24:27], a[144:147], v[40:43], v[24:27]
    v_mfma_f32_16x16x32_bf16 v[20:23], a[136:139], v[40:43], v[20:23]
    v_mfma_f32_16x16x32_bf16 v[16:19], v[52:55], v[40:43], v[16:19]
    s_add_u32 m0, s64, 3072
    s_add_u32 s47, s63, 20544
    buffer_load_dwordx4 v4, s[12:15], s47 offen lds
    ds_read_b128 v[40:43], v6 offset:18432
    s_waitcnt lgkmcnt(2)
    v_mfma_f32_16x16x32_bf16 v[36:39], a[172:175], v[44:47], v[36:39]
    v_mfma_f32_16x16x32_bf16 v[32:35], a[164:167], v[44:47], v[32:35]
    v_mfma_f32_16x16x32_bf16 v[28:31], a[156:159], v[44:47], v[28:31]
    v_mfma_f32_16x16x32_bf16 v[24:27], a[148:151], v[44:47], v[24:27]
    v_mfma_f32_16x16x32_bf16 v[20:23], a[140:143], v[44:47], v[20:23]
    v_mfma_f32_16x16x32_bf16 v[16:19], v[56:59], v[44:47], v[16:19]
    ds_read_b128 v[52:55], v7 offset:4096
    ds_read_b128 v[56:59], v7 offset:5120
    ds_read_b128 v[44:47], v6 offset:20480
    s_waitcnt lgkmcnt(4)
    v_mfma_f32_16x16x32_bf16 v[36:39], a[216:219], v[48:51], v[36:39]
    v_mfma_f32_16x16x32_bf16 v[32:35], a[208:211], v[48:51], v[32:35]
    v_mfma_f32_16x16x32_bf16 v[28:31], a[200:203], v[48:51], v[28:31]
    v_mfma_f32_16x16x32_bf16 v[24:27], a[192:195], v[48:51], v[24:27]
    v_mfma_f32_16x16x32_bf16 v[20:23], a[184:187], v[48:51], v[20:23]
    v_mfma_f32_16x16x32_bf16 v[16:19], a[176:179], v[48:51], v[16:19]
    s_add_u32 m0, s64, 4096
    s_add_u32 s47, s63, 128
    buffer_load_dwordx4 v4, s[12:15], s47 offen lds
    ds_read_b128 v[48:51], v6 offset:22528
    s_waitcnt lgkmcnt(4)
    v_mfma_f32_16x16x32_bf16 v[36:39], a[220:223], v[40:43], v[36:39]
    v_mfma_f32_16x16x32_bf16 v[32:35], a[212:215], v[40:43], v[32:35]
    v_mfma_f32_16x16x32_bf16 v[28:31], a[204:207], v[40:43], v[28:31]
    v_mfma_f32_16x16x32_bf16 v[24:27], a[196:199], v[40:43], v[24:27]
    v_mfma_f32_16x16x32_bf16 v[20:23], a[188:191], v[40:43], v[20:23]
    v_mfma_f32_16x16x32_bf16 v[16:19], a[180:183], v[40:43], v[16:19]
    ds_read_b128 v[40:43], v6 offset:24576
    s_waitcnt lgkmcnt(2)
    v_mfma_f32_16x16x32_bf16 v[36:39], v[68:71], v[44:47], v[36:39]
    v_mfma_f32_16x16x32_bf16 v[32:35], v[60:63], v[44:47], v[32:35]
    v_mfma_f32_16x16x32_bf16 v[28:31], a[248:251], v[44:47], v[28:31]
    v_mfma_f32_16x16x32_bf16 v[24:27], a[240:243], v[44:47], v[24:27]
    v_mfma_f32_16x16x32_bf16 v[20:23], a[232:235], v[44:47], v[20:23]
    v_mfma_f32_16x16x32_bf16 v[16:19], a[224:227], v[44:47], v[16:19]
    s_add_u32 m0, s64, 5120
    s_add_u32 s47, s63, 20608
    buffer_load_dwordx4 v4, s[12:15], s47 offen lds
    ds_read_b128 v[44:47], v6 offset:26624
    s_waitcnt lgkmcnt(2)
    v_mfma_f32_16x16x32_bf16 v[36:39], v[72:75], v[48:51], v[36:39]
    v_mfma_f32_16x16x32_bf16 v[32:35], v[64:67], v[48:51], v[32:35]
    v_mfma_f32_16x16x32_bf16 v[28:31], a[252:255], v[48:51], v[28:31]
    v_mfma_f32_16x16x32_bf16 v[24:27], a[244:247], v[48:51], v[24:27]
    v_mfma_f32_16x16x32_bf16 v[20:23], a[236:239], v[48:51], v[20:23]
    v_mfma_f32_16x16x32_bf16 v[16:19], a[228:231], v[48:51], v[16:19]
    ds_read_b128 v[48:51], v6 offset:28672
    s_waitcnt lgkmcnt(2)
    v_mfma_f32_16x16x32_bf16 v[36:39], v[108:111], v[40:43], v[36:39]
    v_mfma_f32_16x16x32_bf16 v[32:35], v[100:103], v[40:43], v[32:35]
    v_mfma_f32_16x16x32_bf16 v[28:31], v[92:95], v[40:43], v[28:31]
    v_mfma_f32_16x16x32_bf16 v[24:27], v[84:87], v[40:43], v[24:27]
    v_mfma_f32_16x16x32_bf16 v[20:23], v[76:79], v[40:43], v[20:23]
    v_mfma_f32_16x16x32_bf16 v[16:19], v[52:55], v[40:43], v[16:19]
    s_add_u32 m0, s64, 6144
    s_add_u32 s47, s63, 192
    buffer_load_dwordx4 v4, s[12:15], s47 offen lds
    ds_read_b128 v[40:43], v6 offset:30720
    s_waitcnt lgkmcnt(2)
    v_mfma_f32_16x16x32_bf16 v[36:39], v[112:115], v[44:47], v[36:39]
    v_mfma_f32_16x16x32_bf16 v[32:35], v[104:107], v[44:47], v[32:35]
    v_mfma_f32_16x16x32_bf16 v[28:31], v[96:99], v[44:47], v[28:31]
    v_mfma_f32_16x16x32_bf16 v[24:27], v[88:91], v[44:47], v[24:27]
    v_mfma_f32_16x16x32_bf16 v[20:23], v[80:83], v[44:47], v[20:23]
    v_mfma_f32_16x16x32_bf16 v[16:19], v[56:59], v[44:47], v[16:19]
    ds_read_b128 v[52:55], v7 offset:6144
    ds_read_b128 v[56:59], v7 offset:7168
    ds_read_b128 v[44:47], v6 offset:32768
    s_waitcnt lgkmcnt(4)
    v_mfma_f32_16x16x32_bf16 v[36:39], v[156:159], v[48:51], v[36:39]
    v_mfma_f32_16x16x32_bf16 v[32:35], v[148:151], v[48:51], v[32:35]
    v_mfma_f32_16x16x32_bf16 v[28:31], v[140:143], v[48:51], v[28:31]
    v_mfma_f32_16x16x32_bf16 v[24:27], v[132:135], v[48:51], v[24:27]
    v_mfma_f32_16x16x32_bf16 v[20:23], v[124:127], v[48:51], v[20:23]
    v_mfma_f32_16x16x32_bf16 v[16:19], v[116:119], v[48:51], v[16:19]
    s_add_u32 m0, s64, 7168
    s_add_u32 s47, s63, 20672
    buffer_load_dwordx4 v4, s[12:15], s47 offen lds
    ds_read_b128 v[48:51], v6 offset:34816
    s_waitcnt lgkmcnt(4)
    v_mfma_f32_16x16x32_bf16 v[36:39], v[160:163], v[40:43], v[36:39]
    v_mfma_f32_16x16x32_bf16 v[32:35], v[152:155], v[40:43], v[32:35]
    v_mfma_f32_16x16x32_bf16 v[28:31], v[144:147], v[40:43], v[28:31]
    v_mfma_f32_16x16x32_bf16 v[24:27], v[136:139], v[40:43], v[24:27]
    v_mfma_f32_16x16x32_bf16 v[20:23], v[128:131], v[40:43], v[20:23]
    v_mfma_f32_16x16x32_bf16 v[16:19], v[120:123], v[40:43], v[16:19]
    ds_read_b128 v[40:43], v6 offset:36864
    s_waitcnt lgkmcnt(2)
    v_mfma_f32_16x16x32_bf16 v[36:39], v[196:199], v[44:47], v[36:39]
    v_mfma_f32_16x16x32_bf16 v[32:35], v[188:191], v[44:47], v[32:35]
    v_mfma_f32_16x16x32_bf16 v[28:31], v[180:183], v[44:47], v[28:31]
    v_mfma_f32_16x16x32_bf16 v[24:27], v[172:175], v[44:47], v[24:27]
    v_mfma_f32_16x16x32_bf16 v[20:23], v[164:167], v[44:47], v[20:23]
    v_mfma_f32_16x16x32_bf16 v[16:19], v[52:55], v[44:47], v[16:19]
    s_add_u32 m0, s64, 8192
    s_add_u32 s47, s63, 256
    buffer_load_dwordx4 v4, s[12:15], s47 offen lds
    ds_read_b128 v[44:47], v6 offset:38912
    s_waitcnt lgkmcnt(2)
    v_mfma_f32_16x16x32_bf16 v[36:39], v[200:203], v[48:51], v[36:39]
    v_mfma_f32_16x16x32_bf16 v[32:35], v[192:195], v[48:51], v[32:35]
    v_mfma_f32_16x16x32_bf16 v[28:31], v[184:187], v[48:51], v[28:31]
    v_mfma_f32_16x16x32_bf16 v[24:27], v[176:179], v[48:51], v[24:27]
    v_mfma_f32_16x16x32_bf16 v[20:23], v[168:171], v[48:51], v[20:23]
    v_mfma_f32_16x16x32_bf16 v[16:19], v[56:59], v[48:51], v[16:19]
    s_waitcnt lgkmcnt(1)
    v_mfma_f32_16x16x32_bf16 v[36:39], v[244:247], v[40:43], v[36:39]
    v_mfma_f32_16x16x32_bf16 v[32:35], v[236:239], v[40:43], v[32:35]
    v_mfma_f32_16x16x32_bf16 v[28:31], v[228:231], v[40:43], v[28:31]
    v_mfma_f32_16x16x32_bf16 v[24:27], v[220:223], v[40:43], v[24:27]
    v_mfma_f32_16x16x32_bf16 v[20:23], v[212:215], v[40:43], v[20:23]
    v_mfma_f32_16x16x32_bf16 v[16:19], v[204:207], v[40:43], v[16:19]
    s_add_u32 m0, s64, 9216
    s_add_u32 s47, s63, 20736
    buffer_load_dwordx4 v4, s[12:15], s47 offen lds
    s_waitcnt lgkmcnt(0)
    v_mfma_f32_16x16x32_bf16 v[36:39], v[248:251], v[44:47], v[36:39]
    v_mfma_f32_16x16x32_bf16 v[32:35], v[240:243], v[44:47], v[32:35]
    v_mfma_f32_16x16x32_bf16 v[28:31], v[232:235], v[44:47], v[28:31]
    v_mfma_f32_16x16x32_bf16 v[24:27], v[224:227], v[44:47], v[24:27]
    v_mfma_f32_16x16x32_bf16 v[20:23], v[216:219], v[44:47], v[20:23]
    v_mfma_f32_16x16x32_bf16 v[16:19], v[208:211], v[44:47], v[16:19]
    s_add_u32 s45, s57, 0
    s_nop 6
    v_cvt_pk_bf16_f32 v40, v16, v17
    v_cvt_pk_bf16_f32 v41, v18, v19
    v_cvt_pk_bf16_f32 v42, v20, v21
    v_cvt_pk_bf16_f32 v43, v22, v23
    buffer_store_dwordx4 v[40:43], v8, s[8:11], s45 offen offset:0 sc1
    v_cvt_pk_bf16_f32 v44, v24, v25
    v_cvt_pk_bf16_f32 v45, v26, v27
    v_cvt_pk_bf16_f32 v46, v28, v29
    v_cvt_pk_bf16_f32 v47, v30, v31
    buffer_store_dwordx4 v[44:47], v8, s[8:11], s45 offen offset:1024 sc1
    v_cvt_pk_bf16_f32 v48, v32, v33
    v_cvt_pk_bf16_f32 v49, v34, v35
    v_cvt_pk_bf16_f32 v50, v36, v37
    v_cvt_pk_bf16_f32 v51, v38, v39
    buffer_store_dwordx4 v[48:51], v8, s[8:11], s45 offen offset:2048 sc1
    ds_read_b128 v[40:43], v6 offset:1024
    ds_read_b128 v[44:47], v6 offset:3072
    ds_read_b128 v[52:55], v7 offset:0
    ds_read_b128 v[56:59], v7 offset:1024
    ds_read_b128 v[48:51], v6 offset:5120
    s_waitcnt lgkmcnt(4)
    v_mfma_f32_16x16x32_bf16 v[36:39], a[40:43], v[40:43], 0
    v_mfma_f32_16x16x32_bf16 v[32:35], a[32:35], v[40:43], 0
    v_mfma_f32_16x16x32_bf16 v[28:31], a[24:27], v[40:43], 0
    v_mfma_f32_16x16x32_bf16 v[24:27], a[16:19], v[40:43], 0
    v_mfma_f32_16x16x32_bf16 v[20:23], a[8:11], v[40:43], 0
    v_mfma_f32_16x16x32_bf16 v[16:19], a[0:3], v[40:43], 0
    ds_read_b128 v[40:43], v6 offset:7168
    s_waitcnt lgkmcnt(4)
    v_mfma_f32_16x16x32_bf16 v[36:39], a[44:47], v[44:47], v[36:39]
    v_mfma_f32_16x16x32_bf16 v[32:35], a[36:39], v[44:47], v[32:35]
    v_mfma_f32_16x16x32_bf16 v[28:31], a[28:31], v[44:47], v[28:31]
    v_mfma_f32_16x16x32_bf16 v[24:27], a[20:23], v[44:47], v[24:27]
    v_mfma_f32_16x16x32_bf16 v[20:23], a[12:15], v[44:47], v[20:23]
    v_mfma_f32_16x16x32_bf16 v[16:19], a[4:7], v[44:47], v[16:19]
    ds_read_b128 v[44:47], v6 offset:9216
    s_waitcnt lgkmcnt(2)
    v_mfma_f32_16x16x32_bf16 v[36:39], a[80:83], v[48:51], v[36:39]
    v_mfma_f32_16x16x32_bf16 v[32:35], a[72:75], v[48:51], v[32:35]
    v_mfma_f32_16x16x32_bf16 v[28:31], a[64:67], v[48:51], v[28:31]
    v_mfma_f32_16x16x32_bf16 v[24:27], a[56:59], v[48:51], v[24:27]
    v_mfma_f32_16x16x32_bf16 v[20:23], a[48:51], v[48:51], v[20:23]
    v_mfma_f32_16x16x32_bf16 v[16:19], v[52:55], v[48:51], v[16:19]
    ds_read_b128 v[48:51], v6 offset:11264
    s_waitcnt lgkmcnt(2)
    v_mfma_f32_16x16x32_bf16 v[36:39], a[84:87], v[40:43], v[36:39]
    v_mfma_f32_16x16x32_bf16 v[32:35], a[76:79], v[40:43], v[32:35]
    v_mfma_f32_16x16x32_bf16 v[28:31], a[68:71], v[40:43], v[28:31]
    v_mfma_f32_16x16x32_bf16 v[24:27], a[60:63], v[40:43], v[24:27]
    v_mfma_f32_16x16x32_bf16 v[20:23], a[52:55], v[40:43], v[20:23]
    v_mfma_f32_16x16x32_bf16 v[16:19], v[56:59], v[40:43], v[16:19]
    ds_read_b128 v[52:55], v7 offset:2048
    ds_read_b128 v[56:59], v7 offset:3072
    ds_read_b128 v[40:43], v6 offset:13312
    s_waitcnt lgkmcnt(4)
    v_mfma_f32_16x16x32_bf16 v[36:39], a[128:131], v[44:47], v[36:39]
    v_mfma_f32_16x16x32_bf16 v[32:35], a[120:123], v[44:47], v[32:35]
    v_mfma_f32_16x16x32_bf16 v[28:31], a[112:115], v[44:47], v[28:31]
    v_mfma_f32_16x16x32_bf16 v[24:27], a[104:107], v[44:47], v[24:27]
    v_mfma_f32_16x16x32_bf16 v[20:23], a[96:99], v[44:47], v[20:23]
    v_mfma_f32_16x16x32_bf16 v[16:19], a[88:91], v[44:47], v[16:19]
    ds_read_b128 v[44:47], v6 offset:15360
    s_waitcnt lgkmcnt(4)
    v_mfma_f32_16x16x32_bf16 v[36:39], a[132:135], v[48:51], v[36:39]
    v_mfma_f32_16x16x32_bf16 v[32:35], a[124:127], v[48:51], v[32:35]
    v_mfma_f32_16x16x32_bf16 v[28:31], a[116:119], v[48:51], v[28:31]
    v_mfma_f32_16x16x32_bf16 v[24:27], a[108:111], v[48:51], v[24:27]
    v_mfma_f32_16x16x32_bf16 v[20:23], a[100:103], v[48:51], v[20:23]
    v_mfma_f32_16x16x32_bf16 v[16:19], a[92:95], v[48:51], v[16:19]
    ds_read_b128 v[48:51], v6 offset:17408
    s_waitcnt lgkmcnt(2)
    v_mfma_f32_16x16x32_bf16 v[36:39], a[168:171], v[40:43], v[36:39]
    v_mfma_f32_16x16x32_bf16 v[32:35], a[160:163], v[40:43], v[32:35]
    v_mfma_f32_16x16x32_bf16 v[28:31], a[152:155], v[40:43], v[28:31]
    v_mfma_f32_16x16x32_bf16 v[24:27], a[144:147], v[40:43], v[24:27]
    v_mfma_f32_16x16x32_bf16 v[20:23], a[136:139], v[40:43], v[20:23]
    v_mfma_f32_16x16x32_bf16 v[16:19], v[52:55], v[40:43], v[16:19]
    ds_read_b128 v[40:43], v6 offset:19456
    s_waitcnt lgkmcnt(2)
    v_mfma_f32_16x16x32_bf16 v[36:39], a[172:175], v[44:47], v[36:39]
    v_mfma_f32_16x16x32_bf16 v[32:35], a[164:167], v[44:47], v[32:35]
    v_mfma_f32_16x16x32_bf16 v[28:31], a[156:159], v[44:47], v[28:31]
    v_mfma_f32_16x16x32_bf16 v[24:27], a[148:151], v[44:47], v[24:27]
    v_mfma_f32_16x16x32_bf16 v[20:23], a[140:143], v[44:47], v[20:23]
    v_mfma_f32_16x16x32_bf16 v[16:19], v[56:59], v[44:47], v[16:19]
    ds_read_b128 v[52:55], v7 offset:4096
    ds_read_b128 v[56:59], v7 offset:5120
    ds_read_b128 v[44:47], v6 offset:21504
    s_waitcnt lgkmcnt(4)
    v_mfma_f32_16x16x32_bf16 v[36:39], a[216:219], v[48:51], v[36:39]
    v_mfma_f32_16x16x32_bf16 v[32:35], a[208:211], v[48:51], v[32:35]
    v_mfma_f32_16x16x32_bf16 v[28:31], a[200:203], v[48:51], v[28:31]
    v_mfma_f32_16x16x32_bf16 v[24:27], a[192:195], v[48:51], v[24:27]
    v_mfma_f32_16x16x32_bf16 v[20:23], a[184:187], v[48:51], v[20:23]
    v_mfma_f32_16x16x32_bf16 v[16:19], a[176:179], v[48:51], v[16:19]
    ds_read_b128 v[48:51], v6 offset:23552
    s_waitcnt lgkmcnt(4)
    v_mfma_f32_16x16x32_bf16 v[36:39], a[220:223], v[40:43], v[36:39]
    v_mfma_f32_16x16x32_bf16 v[32:35], a[212:215], v[40:43], v[32:35]
    v_mfma_f32_16x16x32_bf16 v[28:31], a[204:207], v[40:43], v[28:31]
    v_mfma_f32_16x16x32_bf16 v[24:27], a[196:199], v[40:43], v[24:27]
    v_mfma_f32_16x16x32_bf16 v[20:23], a[188:191], v[40:43], v[20:23]
    v_mfma_f32_16x16x32_bf16 v[16:19], a[180:183], v[40:43], v[16:19]
    ds_read_b128 v[40:43], v6 offset:25600
    s_waitcnt lgkmcnt(2)
    v_mfma_f32_16x16x32_bf16 v[36:39], v[68:71], v[44:47], v[36:39]
    v_mfma_f32_16x16x32_bf16 v[32:35], v[60:63], v[44:47], v[32:35]
    v_mfma_f32_16x16x32_bf16 v[28:31], a[248:251], v[44:47], v[28:31]
    v_mfma_f32_16x16x32_bf16 v[24:27], a[240:243], v[44:47], v[24:27]
    v_mfma_f32_16x16x32_bf16 v[20:23], a[232:235], v[44:47], v[20:23]
    v_mfma_f32_16x16x32_bf16 v[16:19], a[224:227], v[44:47], v[16:19]
    ds_read_b128 v[44:47], v6 offset:27648
    s_waitcnt lgkmcnt(2)
    v_mfma_f32_16x16x32_bf16 v[36:39], v[72:75], v[48:51], v[36:39]
    v_mfma_f32_16x16x32_bf16 v[32:35], v[64:67], v[48:51], v[32:35]
    v_mfma_f32_16x16x32_bf16 v[28:31], a[252:255], v[48:51], v[28:31]
    v_mfma_f32_16x16x32_bf16 v[24:27], a[244:247], v[48:51], v[24:27]
    v_mfma_f32_16x16x32_bf16 v[20:23], a[236:239], v[48:51], v[20:23]
    v_mfma_f32_16x16x32_bf16 v[16:19], a[228:231], v[48:51], v[16:19]
    ds_read_b128 v[48:51], v6 offset:29696
    s_waitcnt lgkmcnt(2)
    v_mfma_f32_16x16x32_bf16 v[36:39], v[108:111], v[40:43], v[36:39]
    v_mfma_f32_16x16x32_bf16 v[32:35], v[100:103], v[40:43], v[32:35]
    v_mfma_f32_16x16x32_bf16 v[28:31], v[92:95], v[40:43], v[28:31]
    v_mfma_f32_16x16x32_bf16 v[24:27], v[84:87], v[40:43], v[24:27]
    v_mfma_f32_16x16x32_bf16 v[20:23], v[76:79], v[40:43], v[20:23]
    v_mfma_f32_16x16x32_bf16 v[16:19], v[52:55], v[40:43], v[16:19]
    ds_read_b128 v[40:43], v6 offset:31744
    s_waitcnt lgkmcnt(2)
    v_mfma_f32_16x16x32_bf16 v[36:39], v[112:115], v[44:47], v[36:39]
    v_mfma_f32_16x16x32_bf16 v[32:35], v[104:107], v[44:47], v[32:35]
    v_mfma_f32_16x16x32_bf16 v[28:31], v[96:99], v[44:47], v[28:31]
    v_mfma_f32_16x16x32_bf16 v[24:27], v[88:91], v[44:47], v[24:27]
    v_mfma_f32_16x16x32_bf16 v[20:23], v[80:83], v[44:47], v[20:23]
    v_mfma_f32_16x16x32_bf16 v[16:19], v[56:59], v[44:47], v[16:19]
    ds_read_b128 v[52:55], v7 offset:6144
    ds_read_b128 v[56:59], v7 offset:7168
    ds_read_b128 v[44:47], v6 offset:33792
    s_waitcnt lgkmcnt(4)
    v_mfma_f32_16x16x32_bf16 v[36:39], v[156:159], v[48:51], v[36:39]
    v_mfma_f32_16x16x32_bf16 v[32:35], v[148:151], v[48:51], v[32:35]
    v_mfma_f32_16x16x32_bf16 v[28:31], v[140:143], v[48:51], v[28:31]
    v_mfma_f32_16x16x32_bf16 v[24:27], v[132:135], v[48:51], v[24:27]
    v_mfma_f32_16x16x32_bf16 v[20:23], v[124:127], v[48:51], v[20:23]
    v_mfma_f32_16x16x32_bf16 v[16:19], v[116:119], v[48:51], v[16:19]
    ds_read_b128 v[48:51], v6 offset:35840
    s_waitcnt lgkmcnt(4)
    v_mfma_f32_16x16x32_bf16 v[36:39], v[160:163], v[40:43], v[36:39]
    v_mfma_f32_16x16x32_bf16 v[32:35], v[152:155], v[40:43], v[32:35]
    v_mfma_f32_16x16x32_bf16 v[28:31], v[144:147], v[40:43], v[28:31]
    v_mfma_f32_16x16x32_bf16 v[24:27], v[136:139], v[40:43], v[24:27]
    v_mfma_f32_16x16x32_bf16 v[20:23], v[128:131], v[40:43], v[20:23]
    v_mfma_f32_16x16x32_bf16 v[16:19], v[120:123], v[40:43], v[16:19]
    ds_read_b128 v[40:43], v6 offset:37888
    s_waitcnt lgkmcnt(2)
    v_mfma_f32_16x16x32_bf16 v[36:39], v[196:199], v[44:47], v[36:39]
    v_mfma_f32_16x16x32_bf16 v[32:35], v[188:191], v[44:47], v[32:35]
    v_mfma_f32_16x16x32_bf16 v[28:31], v[180:183], v[44:47], v[28:31]
    v_mfma_f32_16x16x32_bf16 v[24:27], v[172:175], v[44:47], v[24:27]
    v_mfma_f32_16x16x32_bf16 v[20:23], v[164:167], v[44:47], v[20:23]
    v_mfma_f32_16x16x32_bf16 v[16:19], v[52:55], v[44:47], v[16:19]
    ds_read_b128 v[44:47], v6 offset:39936
    s_waitcnt lgkmcnt(2)
    v_mfma_f32_16x16x32_bf16 v[36:39], v[200:203], v[48:51], v[36:39]
    v_mfma_f32_16x16x32_bf16 v[32:35], v[192:195], v[48:51], v[32:35]
    v_mfma_f32_16x16x32_bf16 v[28:31], v[184:187], v[48:51], v[28:31]
    v_mfma_f32_16x16x32_bf16 v[24:27], v[176:179], v[48:51], v[24:27]
    v_mfma_f32_16x16x32_bf16 v[20:23], v[168:171], v[48:51], v[20:23]
    v_mfma_f32_16x16x32_bf16 v[16:19], v[56:59], v[48:51], v[16:19]
    s_waitcnt lgkmcnt(1)
    v_mfma_f32_16x16x32_bf16 v[36:39], v[244:247], v[40:43], v[36:39]
    v_mfma_f32_16x16x32_bf16 v[32:35], v[236:239], v[40:43], v[32:35]
    v_mfma_f32_16x16x32_bf16 v[28:31], v[228:231], v[40:43], v[28:31]
    v_mfma_f32_16x16x32_bf16 v[24:27], v[220:223], v[40:43], v[24:27]
    v_mfma_f32_16x16x32_bf16 v[20:23], v[212:215], v[40:43], v[20:23]
    v_mfma_f32_16x16x32_bf16 v[16:19], v[204:207], v[40:43], v[16:19]
    s_waitcnt lgkmcnt(0)
    v_mfma_f32_16x16x32_bf16 v[36:39], v[248:251], v[44:47], v[36:39]
    v_mfma_f32_16x16x32_bf16 v[32:35], v[240:243], v[44:47], v[32:35]
    v_mfma_f32_16x16x32_bf16 v[28:31], v[232:235], v[44:47], v[28:31]
    v_mfma_f32_16x16x32_bf16 v[24:27], v[224:227], v[44:47], v[24:27]
    v_mfma_f32_16x16x32_bf16 v[20:23], v[216:219], v[44:47], v[20:23]
    v_mfma_f32_16x16x32_bf16 v[16:19], v[208:211], v[44:47], v[16:19]
    s_add_u32 s45, s57, 6144
    s_nop 6
    v_cvt_pk_bf16_f32 v40, v16, v17
    v_cvt_pk_bf16_f32 v41, v18, v19
    v_cvt_pk_bf16_f32 v42, v20, v21
    v_cvt_pk_bf16_f32 v43, v22, v23
    buffer_store_dwordx4 v[40:43], v8, s[8:11], s45 offen offset:0 sc1
    v_cvt_pk_bf16_f32 v44, v24, v25
    v_cvt_pk_bf16_f32 v45, v26, v27
    v_cvt_pk_bf16_f32 v46, v28, v29
    v_cvt_pk_bf16_f32 v47, v30, v31
    buffer_store_dwordx4 v[44:47], v8, s[8:11], s45 offen offset:1024 sc1
    v_cvt_pk_bf16_f32 v48, v32, v33
    v_cvt_pk_bf16_f32 v49, v34, v35
    v_cvt_pk_bf16_f32 v50, v36, v37
    v_cvt_pk_bf16_f32 v51, v38, v39
    buffer_store_dwordx4 v[48:51], v8, s[8:11], s45 offen offset:2048 sc1
    s_add_u32 s34, s34, 1
    s_cmp_lt_u32 s34, 64
    s_cbranch_scc1 R4L_80
    s_waitcnt vmcnt(0)
    s_barrier
    s_cmp_lg_u32 s33, 0
    s_cbranch_scc1 R4E_85
    v_mov_b32 v1, 64
    v_mov_b32 v2, s54
    s_mov_b64 exec, 1
    buffer_store_dword v1, v2, s[8:11], 0 offen sc1
    s_mov_b64 exec, -1
R4E_85:
    s_endpgm
L_R5:
    s_lshl_b32 s48, s32, 2
    s_add_u32 s48, s48, s33
    s_lshl_b32 s53, s48, 2
    s_add_u32 s53, s53, 8192
    v_mov_b32 v1, 0
    v_mov_b32 v2, s53
    s_mov_b64 exec, 1
    buffer_store_dword v1, v2, s[8:11], 0 offen sc1
    s_mov_b64 exec, -1
    s_waitcnt vmcnt(0) lgkmcnt(0)
    s_barrier
    s_cmp_lg_u32 s33, 0
    s_cbranch_scc1 SI_86
    v_mov_b32 v1, 1
    v_mov_b32 v2, 4
    s_mov_b64 exec, 1
    buffer_atomic_add v1, v2, s[28:31], 0 offen sc1
    s_mov_b64 exec, -1
SI_86:
    v_lshlrev_b32 v4, 4, v0
    v_lshrrev_b32 v1, 4, v0
    v_and_b32 v2, 7, v0
    v_lshlrev_b32 v2, 4, v2
    v_lshl_add_u32 v5, v1, 7, v2
    v_and_b32 v2, 15, v0
    v_lshlrev_b32 v2, 4, v2
    v_lshl_add_u32 v6, v1, 3, v2
    v_lshlrev_b32 v1, 2, v1
    v_and_b32 v2, 15, v0
    v_add_u32 v3, 0, v1
    v_cmp_le_u32 s[66:67], v3, v2
    v_add_u32 v3, 1, v1
    v_cmp_le_u32 s[68:69], v3, v2
    v_add_u32 v3, 2, v1
    v_cmp_le_u32 s[70:71], v3, v2
    v_add_u32 v3, 3, v1
    v_cmp_le_u32 s[72:73], v3, v2
    s_lshl_b32 s45, s48, 7
    s_add_u32 s46, s45, 10240
    s_add_u32 s45, s45, 1024
    v_and_b32 v1, 1, v0
    v_cmp_eq_u32 s[74:75], 1, v1
    v_mov_b32 v2, s46
    v_mov_b32 v3, s45
    v_cndmask_b32 v7, v2, v3, s[74:75]
    s_mul_i32 s49, s48, 24576
    s_add_u32 s49, s49, 50331648
    s_mul_i32 s50, s48, 3072
    s_add_u32 s50, s50, 101711872
    s_lshl_b32 s51, s48, 11
    s_add_u32 s51, s51, 2097152
    s_lshr_b32 s45, s48, 2
    s_lshl_b32 s45, s45, 11
    s_bfe_u32 s46, s48, 0x10001
    s_and_b32 s47, s48, 1
    s_lshl_b32 s47, s47, 1
    s_or_b32 s46, s46, s47
    s_lshl_b32 s46, s46, 8
    s_add_u32 s45, s45, s46
    s_add_u32 s52, s45, 2162688
    s_mov_b32 s54, 0x3dd53b95
    s_mov_b32 s76, 0xffffffff
    s_mov_b32 s77, 0x0
    v_mov_b32 v9, 0xff800000
    v_mov_b32 v2, 4
    s_movk_i32 s45, 254
PL_87:
    buffer_load_dword v1, v2, s[28:31], 0 offen sc1
    s_waitcnt vmcnt(0)
    v_cmp_gt_u32 vcc, s45, v1
    s_cbranch_vccz PD_88
    s_sub_u32 s35, s35, 1
    s_cbranch_scc1 TO_89
    s_branch PL_87
PD_88:
    v_mov_b32 v2, s45
    s_lshl_b32 s45, s48, 7
    s_add_u32 s45, s45, 1024
    v_mov_b32 v2, s45
    s_mov_b32 s46, 1
PL_90:
    buffer_load_dword v1, v2, s[8:11], 0 offen sc1
    s_waitcnt vmcnt(0)
    v_cmp_gt_u32 vcc, s46, v1
    s_cbranch_vccz PD_91
    s_sub_u32 s35, s35, 1
    s_cbranch_scc1 TO_92
    s_branch PL_90
PD_91:
    s_mul_i32 s45, s34, 786432
    s_add_u32 s45, s45, s49
    buffer_load_dwordx4 v[64:67], v4, s[8:11], s45 offen offset:0 sc1
    buffer_load_dwordx4 v[68:71], v4, s[8:11], s45 offen offset:1024 sc1
    buffer_load_dwordx4 v[72:75], v4, s[8:11], s45 offen offset:2048 sc1
    buffer_load_dwordx4 v[76:79], v4, s[8:11], s45 offen offset:3072 sc1
    s_add_u32 s45, s45, 4096
    buffer_load_dwordx4 v[80:83], v4, s[8:11], s45 offen offset:0 sc1
    buffer_load_dwordx4 v[84:87], v4, s[8:11], s45 offen offset:1024 sc1
    buffer_load_dwordx4 v[88:91], v4, s[8:11], s45 offen offset:2048 sc1
    buffer_load_dwordx4 v[92:95], v4, s[8:11], s45 offen offset:3072 sc1
    s_add_u32 s45, s45, 4096
    buffer_load_dwordx4 v[96:99], v4, s[8:11], s45 offen offset:0 sc1
    buffer_load_dwordx4 v[100:103], v4, s[8:11], s45 offen offset:1024 sc1
    buffer_load_dwordx4 v[104:107], v4, s[8:11], s45 offen offset:2048 sc1
    buffer_load_dwordx4 v[108:111], v4, s[8:11], s45 offen offset:3072 sc1
    s_add_u32 s45, s45, 4096
    buffer_load_dwordx4 v[16:19], v4, s[8:11], s45 offen offset:0 sc1
    buffer_load_dwordx4 v[20:23], v4, s[8:11], s45 offen offset:1024 sc1
    buffer_load_dwordx4 v[24:27], v4, s[8:11], s45 offen offset:2048 sc1
    buffer_load_dwordx4 v[28:31], v4, s[8:11], s45 offen offset:3072 sc1
    s_add_u32 s45, s45, 4096
    buffer_load_dwordx4 v[32:35], v4, s[8:11], s45 offen offset:0 sc1
    buffer_load_dwordx4 v[36:39], v4, s[8:11], s45 offen offset:1024 sc1
    buffer_load_dwordx4 v[40:43], v4, s[8:11], s45 offen offset:2048 sc1
    buffer_load_dwordx4 v[44:47], v4, s[8:11], s45 offen offset:3072 sc1
    s_add_u32 s45, s45, 4096
    buffer_load_dwordx4 v[48:51], v4, s[8:11], s45 offen offset:0 sc1
    buffer_load_dwordx4 v[52:55], v4, s[8:11], s45 offen offset:1024 sc1
    buffer_load_dwordx4 v[56:59], v4, s[8:11], s45 offen offset:2048 sc1
    buffer_load_dwordx4 v[60:63], v4, s[8:11], s45 offen offset:3072 sc1
R5L_93:
    s_add_u32 s55, s34, 1
    s_add_u32 s56, s34, 2
    s_min_u32 s56, s56, 64
    v_mov_b32 v2, s55
    v_mov_b32 v3, s56
    v_cndmask_b32 v8, v2, v3, s[74:75]
PL_94:
    buffer_load_dword v1, v7, s[8:11], 0 offen sc1
    s_waitcnt vmcnt(0)
    v_cmp_gt_u32 vcc, v8, v1
    s_cbranch_vccz PD_95
    s_sub_u32 s35, s35, 1
    s_cbranch_scc1 TO_96
    s_branch PL_94
PD_95:
    s_mul_i32 s45, s34, 98304
    s_add_u32 s45, s45, s50
    buffer_load_dwordx4 v[112:115], v5, s[8:11], s45 offen offset:0 sc1
    buffer_load_dwordx4 v[116:119], v5, s[8:11], s45 offen offset:512 sc1
    buffer_load_dwordx4 v[120:123], v5, s[8:11], s45 offen offset:1024 sc1
    buffer_load_dwordx4 v[124:127], v5, s[8:11], s45 offen offset:1536 sc1
    buffer_load_dwordx4 v[128:131], v5, s[8:11], s45 offen offset:2048 sc1
    buffer_load_dwordx4 v[132:135], v5, s[8:11], s45 offen offset:2560 sc1
    v_mfma_f32_16x16x32_bf16 v[140:143], v[64:67], v[16:19], 0
    v_mfma_f32_16x16x32_bf16 v[148:151], v[64:67], v[40:43], 0
    v_mfma_f32_16x16x32_bf16 v[152:155], v[88:91], v[40:43], 0
    v_mfma_f32_16x16x32_bf16 v[140:143], v[68:71], v[20:23], v[140:143]
    v_mfma_f32_16x16x32_bf16 v[148:151], v[68:71], v[44:47], v[148:151]
    v_mfma_f32_16x16x32_bf16 v[152:155], v[92:95], v[44:47], v[152:155]
    v_mfma_f32_16x16x32_bf16 v[140:143], v[72:75], v[24:27], v[140:143]
    v_mfma_f32_16x16x32_bf16 v[148:151], v[72:75], v[48:51], v[148:151]
    v_mfma_f32_16x16x32_bf16 v[152:155], v[96:99], v[48:51], v[152:155]
    v_mfma_f32_16x16x32_bf16 v[140:143], v[76:79], v[28:31], v[140:143]
    v_mfma_f32_16x16x32_bf16 v[148:151], v[76:79], v[52:55], v[148:151]
    v_mfma_f32_16x16x32_bf16 v[152:155], v[100:103], v[52:55], v[152:155]
    v_mfma_f32_16x16x32_bf16 v[140:143], v[80:83], v[32:35], v[140:143]
    v_mfma_f32_16x16x32_bf16 v[148:151], v[80:83], v[56:59], v[148:151]
    v_mfma_f32_16x16x32_bf16 v[152:155], v[104:107], v[56:59], v[152:155]
    v_mfma_f32_16x16x32_bf16 v[140:143], v[84:87], v[36:39], v[140:143]
    v_mfma_f32_16x16x32_bf16 v[148:151], v[84:87], v[60:63], v[148:151]
    v_mfma_f32_16x16x32_bf16 v[152:155], v[108:111], v[60:63], v[152:155]
    s_waitcnt vmcnt(0)
    v_mfma_f32_16x16x32_bf16 v[136:139], v[112:115], v[16:19], 0
    v_mfma_f32_16x16x32_bf16 v[144:147], v[112:115], v[40:43], 0
    v_mfma_f32_16x16x32_bf16 v[136:139], v[116:119], v[20:23], v[136:139]
    v_mfma_f32_16x16x32_bf16 v[144:147], v[116:119], v[44:47], v[144:147]
    v_mfma_f32_16x16x32_bf16 v[136:139], v[120:123], v[24:27], v[136:139]
    v_mfma_f32_16x16x32_bf16 v[144:147], v[120:123], v[48:51], v[144:147]
    v_mfma_f32_16x16x32_bf16 v[136:139], v[124:127], v[28:31], v[136:139]
    v_mfma_f32_16x16x32_bf16 v[144:147], v[124:127], v[52:55], v[144:147]
    v_mfma_f32_16x16x32_bf16 v[136:139], v[128:131], v[32:35], v[136:139]
    v_mfma_f32_16x16x32_bf16 v[144:147], v[128:131], v[56:59], v[144:147]
    v_mfma_f32_16x16x32_bf16 v[136:139], v[132:135], v[36:39], v[136:139]
    v_mfma_f32_16x16x32_bf16 v[144:147], v[132:135], v[60:63], v[144:147]
    v_cndmask_b32 v140, v9, v140, s[66:67]
    v_cndmask_b32 v152, v9, v152, s[66:67]
    v_cndmask_b32 v141, v9, v141, s[68:69]
    v_cndmask_b32 v153, v9, v153, s[68:69]
    v_cndmask_b32 v142, v9, v142, s[70:71]
    v_cndmask_b32 v154, v9, v154, s[70:71]
    v_cndmask_b32 v143, v9, v143, s[72:73]
    v_cndmask_b32 v155, v9, v155, s[72:73]
    v_max3_f32 v156, v136, v137, v138
    v_max3_f32 v157, v139, v140, v141
    v_max3_f32 v156, v156, v142, v143
    v_max_f32 v156, v156, v157
    v_mov_b32 v157, v156
    s_nop 1
    v_permlane32_swap_b32 v156, v157
    v_max_f32 v156, v156, v157
    v_mov_b32 v157, v156
    s_nop 1
    v_permlane16_swap_b32 v156, v157
    v_max_f32 v156, v156, v157
    v_mul_f32 v156, s54, v156
    v_fma_f32 v136, v136, s54, -v156
    v_fma_f32 v137, v137, s54, -v156
    v_fma_f32 v138, v138, s54, -v156
    v_fma_f32 v139, v139, s54, -v156
    v_fma_f32 v140, v140, s54, -v156
    v_fma_f32 v141, v141, s54, -v156
    v_fma_f32 v142, v142, s54, -v156
    v_fma_f32 v143, v143, s54, -v156
    v_exp_f32 v136, v136
    v_exp_f32 v137, v137
    v_exp_f32 v138, v138
    v_exp_f32 v139, v139
    v_exp_f32 v140, v140
    v_exp_f32 v141, v141
    v_exp_f32 v142, v142
    v_exp_f32 v143, v143
    s_nop 0
    v_pk_add_f32 v[156:157], v[140:141], v[142:143]
    v_pk_add_f32 v[158:159], v[136:137], v[138:139]
    v_add_f32 v156, v156, v157
    v_add_f32 v158, v158, v159
    v_fma_f32 v156, v158, 0.5, v156
    v_mov_b32 v157, v156
    s_nop 1
    v_permlane32_swap_b32 v156, v157
    v_add_f32 v156, v156, v157
    v_mov_b32 v157, v156
    s_nop 1
    v_permlane16_swap_b32 v156, v157
    v_add_f32 v156, v156, v157
    v_rcp_f32 v156, v156
    s_nop 0
    v_mul_f32 v136, v136, v156
    v_mul_f32 v137, v137, v156
    v_mul_f32 v138, v138, v156
    v_mul_f32 v139, v139, v156
    v_mul_f32 v140, v140, v156
    v_mul_f32 v141, v141, v156
    v_mul_f32 v142, v142, v156
    v_mul_f32 v143, v143, v156
    v_max3_f32 v156, v144, v145, v146
    v_max3_f32 v157, v147, v148, v149
    v_max3_f32 v156, v156, v150, v151
    v_max3_f32 v157, v157, v152, v153
    v_max3_f32 v156, v156, v154, v155
    v_max_f32 v156, v156, v157
    v_mov_b32 v157, v156
    s_nop 1
    v_permlane32_swap_b32 v156, v157
    v_max_f32 v156, v156, v157
    v_mov_b32 v157, v156
    s_nop 1
    v_permlane16_swap_b32 v156, v157
    v_max_f32 v156, v156, v157
    v_mul_f32 v156, s54, v156
    v_fma_f32 v144, v144, s54, -v156
    v_fma_f32 v145, v145, s54, -v156
    v_fma_f32 v146, v146, s54, -v156
    v_fma_f32 v147, v147, s54, -v156
    v_fma_f32 v148, v148, s54, -v156
    v_fma_f32 v149, v149, s54, -v156
    v_fma_f32 v150, v150, s54, -v156
    v_fma_f32 v151, v151, s54, -v156
    v_fma_f32 v152, v152, s54, -v156
    v_fma_f32 v153, v153, s54, -v156
    v_fma_f32 v154, v154, s54, -v156
    v_fma_f32 v155, v155, s54, -v156
    v_exp_f32 v144, v144
    v_exp_f32 v145, v145
    v_exp_f32 v146, v146
    v_exp_f32 v147, v147
    v_exp_f32 v148, v148
    v_exp_f32 v149, v149
    v_exp_f32 v150, v150
    v_exp_f32 v151, v151
    v_exp_f32 v152, v152
    v_exp_f32 v153, v153
    v_exp_f32 v154, v154
    v_exp_f32 v155, v155
    v_pk_add_f32 v[156:157], v[148:149], v[150:151]
    v_pk_add_f32 v[156:157], v[156:157], v[152:153]
    v_pk_add_f32 v[156:157], v[156:157], v[154:155]
    v_pk_add_f32 v[158:159], v[144:145], v[146:147]
    v_add_f32 v156, v156, v157
    v_add_f32 v158, v158, v159
    v_fma_f32 v156, v158, 0.5, v156
    v_mov_b32 v157, v156
    s_nop 1
    v_permlane32_swap_b32 v156, v157
    v_add_f32 v156, v156, v157
    v_mov_b32 v157, v156
    s_nop 1
    v_permlane16_swap_b32 v156, v157
    v_add_f32 v156, v156, v157
    v_rcp_f32 v156, v156
    s_nop 0
    v_mul_f32 v144, v144, v156
    v_mul_f32 v145, v145, v156
    v_mul_f32 v146, v146, v156
    v_mul_f32 v147, v147, v156
    v_mul_f32 v148, v148, v156
    v_mul_f32 v149, v149, v156
    v_mul_f32 v150, v150, v156
    v_mul_f32 v151, v151, v156
    v_mul_f32 v152, v152, v156
    v_mul_f32 v153, v153, v156
    v_mul_f32 v154, v154, v156
    v_mul_f32 v155, v155, v156
    v_cvt_pk_bf16_f32 v160, v140, v141
    v_cvt_pk_bf16_f32 v161, v142, v143
    v_mov_b32 v162, 0
    v_mov_b32 v163, 0
    v_cvt_pk_bf16_f32 v164, v148, v149
    v_cvt_pk_bf16_f32 v165, v150, v151
    v_cvt_pk_bf16_f32 v166, v152, v153
    v_cvt_pk_bf16_f32 v167, v154, v155
    v_cvt_pk_bf16_f32 v168, v136, v137
    v_cvt_pk_bf16_f32 v169, v138, v139
    v_cvt_pk_bf16_f32 v170, v144, v145
    v_cvt_pk_bf16_f32 v171, v146, v147
    s_mul_i32 s46, s34, 81920
    s_add_u32 s45, s46, s51
    s_add_u32 s46, s46, s52
    buffer_store_dwordx4 v[160:163], v4, s[8:11], s45 offen offset:0 sc1
    buffer_store_dwordx4 v[164:167], v4, s[8:11], s45 offen offset:1024 sc1
    s_mov_b64 exec, s[76:77]
    buffer_store_dwordx2 v[168:169], v6, s[8:11], s46 offen offset:0 sc1
    buffer_store_dwordx2 v[170:171], v6, s[8:11], s46 offen offset:1024 sc1
    s_mov_b64 exec, -1
    s_add_u32 s46, s34, 1
    s_min_u32 s46, s46, 63
    s_mul_i32 s45, s46, 786432
    s_add_u32 s45, s45, s49
    buffer_load_dwordx4 v[64:67], v4, s[8:11], s45 offen offset:0 sc1
    buffer_load_dwordx4 v[68:71], v4, s[8:11], s45 offen offset:1024 sc1
    buffer_load_dwordx4 v[72:75], v4, s[8:11], s45 offen offset:2048 sc1
    buffer_load_dwordx4 v[76:79], v4, s[8:11], s45 offen offset:3072 sc1
    s_add_u32 s45, s45, 4096
    buffer_load_dwordx4 v[80:83], v4, s[8:11], s45 offen offset:0 sc1
    buffer_load_dwordx4 v[84:87], v4, s[8:11], s45 offen offset:1024 sc1
    buffer_load_dwordx4 v[88:91], v4, s[8:11], s45 offen offset:2048 sc1
    buffer_load_dwordx4 v[92:95], v4, s[8:11], s45 offen offset:3072 sc1
    s_add_u32 s45, s45, 4096
    buffer_load_dwordx4 v[96:99], v4, s[8:11], s45 offen offset:0 sc1
    buffer_load_dwordx4 v[100:103], v4, s[8:11], s45 offen offset:1024 sc1
    buffer_load_dwordx4 v[104:107], v4, s[8:11], s45 offen offset:2048 sc1
    buffer_load_dwordx4 v[108:111], v4, s[8:11], s45 offen offset:3072 sc1
    s_add_u32 s45, s45, 4096
    buffer_load_dwordx4 v[16:19], v4, s[8:11], s45 offen offset:0 sc1
    buffer_load_dwordx4 v[20:23], v4, s[8:11], s45 offen offset:1024 sc1
    buffer_load_dwordx4 v[24:27], v4, s[8:11], s45 offen offset:2048 sc1
    buffer_load_dwordx4 v[28:31], v4, s[8:11], s45 offen offset:3072 sc1
    s_add_u32 s45, s45, 4096
    buffer_load_dwordx4 v[32:35], v4, s[8:11], s45 offen offset:0 sc1
    buffer_load_dwordx4 v[36:39], v4, s[8:11], s45 offen offset:1024 sc1
    buffer_load_dwordx4 v[40:43], v4, s[8:11], s45 offen offset:2048 sc1
    buffer_load_dwordx4 v[44:47], v4, s[8:11], s45 offen offset:3072 sc1
    s_add_u32 s45, s45, 4096
    buffer_load_dwordx4 v[48:51], v4, s[8:11], s45 offen offset:0 sc1
    buffer_load_dwordx4 v[52:55], v4, s[8:11], s45 offen offset:1024 sc1
    buffer_load_dwordx4 v[56:59], v4, s[8:11], s45 offen offset:2048 sc1
    buffer_load_dwordx4 v[60:63], v4, s[8:11], s45 offen offset:3072 sc1
    s_waitcnt vmcnt(24)
    v_mov_b32 v1, s55
    v_mov_b32 v2, s53
    s_mov_b64 exec, 1
    buffer_store_dword v1, v2, s[8:11], 0 offen sc1
    s_mov_b64 exec, -1
    s_add_u32 s34, s34, 1
    s_cmp_lt_u32 s34, 64
    s_cbranch_scc1 R5L_93
    s_waitcnt vmcnt(0)
    s_endpgm
L_F1:
    s_lshl_b32 s54, s32, 2
    s_add_u32 s54, s54, 8448
    s_cmp_lg_u32 s33, 0
    s_cbranch_scc1 F1R_97
    v_mov_b32 v1, 0
    v_mov_b32 v2, s54
    s_mov_b64 exec, 1
    buffer_store_dword v1, v2, s[8:11], 0 offen sc1
    s_mov_b64 exec, -1
F1R_97:
    s_waitcnt vmcnt(0) lgkmcnt(0)
    s_barrier
    s_cmp_lg_u32 s33, 0
    s_cbranch_scc1 SI_98
    v_mov_b32 v1, 1
    v_mov_b32 v2, 4
    s_mov_b64 exec, 1
    buffer_atomic_add v1, v2, s[28:31], 0 offen sc1
    s_mov_b64 exec, -1
SI_98:
    s_load_dwordx2 s[4:5], s[0:1], 64
    s_waitcnt lgkmcnt(0)
    s_mov_b32 s16, s4
    s_mov_b32 s17, s5
    s_mov_b32 s18, 1966080
    s_mov_b32 s19, 0x20000
    s_load_dwordx2 s[4:5], s[0:1], 72
    s_waitcnt lgkmcnt(0)
    s_mov_b32 s20, s4
    s_mov_b32 s21, s5
    s_mov_b32 s22, 1966080
    s_mov_b32 s23, 0x20000
    v_lshrrev_b32 v1, 4, v0
    v_and_b32 v2, 15, v0
    v_mul_u32_u24 v2, 1280, v2
    v_lshl_add_u32 v4, v1, 4, v2
    s_mul_i32 s45, s33, 320
    v_add_u32 v4, s45, v4
    v_lshlrev_b32 v5, 4, v0
    s_mul_i32 s52, s33, 10240
    s_mul_i32 s45, s34, 40960
    s_and_b32 s46, s34, 1
    s_mul_i32 s46, s46, 40960
    s_add_u32 s46, s46, s52
    s_add_u32 m0, s46, 0
    s_add_u32 s47, s45, 0
    buffer_load_dwordx4 v4, s[12:15], s47 offen lds
    s_add_u32 m0, s46, 1024
    s_add_u32 s47, s45, 20480
    buffer_load_dwordx4 v4, s[12:15], s47 offen lds
    s_add_u32 m0, s46, 2048
    s_add_u32 s47, s45, 64
    buffer_load_dwordx4 v4, s[12:15], s47 offen lds
    s_add_u32 m0, s46, 3072
    s_add_u32 s47, s45, 20544
    buffer_load_dwordx4 v4, s[12:15], s47 offen lds
    s_add_u32 m0, s46, 4096
    s_add_u32 s47, s45, 128
    buffer_load_dwordx4 v4, s[12:15], s47 offen lds
    s_add_u32 m0, s46, 5120
    s_add_u32 s47, s45, 20608
    buffer_load_dwordx4 v4, s[12:15], s47 offen lds
    s_add_u32 m0, s46, 6144
    s_add_u32 s47, s45, 192
    buffer_load_dwordx4 v4, s[12:15], s47 offen lds
    s_add_u32 m0, s46, 7168
    s_add_u32 s47, s45, 20672
    buffer_load_dwordx4 v4, s[12:15], s47 offen lds
    s_add_u32 m0, s46, 8192
    s_add_u32 s47, s45, 256
    buffer_load_dwordx4 v4, s[12:15], s47 offen lds
    s_add_u32 m0, s46, 9216
    s_add_u32 s47, s45, 20736
    buffer_load_dwordx4 v4, s[12:15], s47 offen lds
    v_lshlrev_b32 v8, 4, v0
    v_lshrrev_b32 v1, 2, v0
    v_mul_u32_u24 v1, 3072, v1
    v_and_b32 v2, 3, v0
    v_lshl_add_u32 v10, v2, 4, v1
    v_lshrrev_b32 v1, 4, v0
    v_bfe_u32 v3, v0, 2, 2
    v_lshl_add_u32 v1, v1, 3, v3
    v_lshlrev_b32 v1, 6, v1
    v_lshl_add_u32 v9, v2, 4, v1
    s_mul_i32 s50, s33, 16384
    s_add_u32 s50, s50, 81920
    v_add_u32 v9, s50, v9
    s_lshl_b32 s51, s32, 8
    s_lshl_b32 s45, s33, 6
    s_add_u32 s51, s51, s45
    s_add_u32 s46, s51, 0
    s_add_u32 m0, s50, 0
    s_nop 0
    buffer_load_dwordx4 v10, s[16:19], s46 offen lds
    s_add_u32 s46, s51, 49152
    s_add_u32 m0, s50, 1024
    s_nop 0
    buffer_load_dwordx4 v10, s[16:19], s46 offen lds
    s_add_u32 s46, s51, 0
    s_add_u32 m0, s50, 2048
    s_nop 0
    buffer_load_dwordx4 v10, s[20:23], s46 offen lds
    s_add_u32 s46, s51, 49152
    s_add_u32 m0, s50, 3072
    s_nop 0
    buffer_load_dwordx4 v10, s[20:23], s46 offen lds
    s_add_u32 s46, s51, 98304
    s_add_u32 m0, s50, 4096
    s_nop 0
    buffer_load_dwordx4 v10, s[16:19], s46 offen lds
    s_add_u32 s46, s51, 147456
    s_add_u32 m0, s50, 5120
    s_nop 0
    buffer_load_dwordx4 v10, s[16:19], s46 offen lds
    s_add_u32 s46, s51, 98304
    s_add_u32 m0, s50, 6144
    s_nop 0
    buffer_load_dwordx4 v10, s[20:23], s46 offen lds
    s_add_u32 s46, s51, 147456
    s_add_u32 m0, s50, 7168
    s_nop 0
    buffer_load_dwordx4 v10, s[20:23], s46 offen lds
    s_add_u32 s46, s51, 196608
    s_add_u32 m0, s50, 8192
    s_nop 0
    buffer_load_dwordx4 v10, s[16:19], s46 offen lds
    s_add_u32 s46, s51, 245760
    s_add_u32 m0, s50, 9216
    s_nop 0
    buffer_load_dwordx4 v10, s[16:19], s46 offen lds
    s_add_u32 s46, s51, 196608
    s_add_u32 m0, s50, 10240
    s_nop 0
    buffer_load_dwordx4 v10, s[20:23], s46 offen lds
    s_add_u32 s46, s51, 245760
    s_add_u32 m0, s50, 11264
    s_nop 0
    buffer_load_dwordx4 v10, s[20:23], s46 offen lds
    s_add_u32 s46, s51, 294912
    s_add_u32 m0, s50, 12288
    s_nop 0
    buffer_load_dwordx4 v10, s[16:19], s46 offen lds
    s_add_u32 s46, s51, 344064
    s_add_u32 m0, s50, 13312
    s_nop 0
    buffer_load_dwordx4 v10, s[16:19], s46 offen lds
    s_add_u32 s46, s51, 294912
    s_add_u32 m0, s50, 14336
    s_nop 0
    buffer_load_dwordx4 v10, s[20:23], s46 offen lds
    s_add_u32 s46, s51, 344064
    s_add_u32 m0, s50, 15360
    s_nop 0
    buffer_load_dwordx4 v10, s[20:23], s46 offen lds
    s_waitcnt vmcnt(12)
    ds_read_b64_tr_b16 a[0:1], v9 offset:0
    ds_read_b64_tr_b16 a[2:3], v9 offset:256
    ds_read_b64_tr_b16 a[80:81], v9 offset:8
    ds_read_b64_tr_b16 a[82:83], v9 offset:264
    ds_read_b64_tr_b16 a[160:161], v9 offset:2048
    ds_read_b64_tr_b16 a[162:163], v9 offset:2304
    ds_read_b64_tr_b16 a[240:241], v9 offset:2056
    ds_read_b64_tr_b16 a[242:243], v9 offset:2312
    s_waitcnt lgkmcnt(0)
    s_add_u32 s46, s51, 393216
    s_add_u32 m0, s50, 0
    s_nop 0
    buffer_load_dwordx4 v10, s[16:19], s46 offen lds
    s_add_u32 s46, s51, 442368
    s_add_u32 m0, s50, 1024
    s_nop 0
    buffer_load_dwordx4 v10, s[16:19], s46 offen lds
    s_add_u32 s46, s51, 393216
    s_add_u32 m0, s50, 2048
    s_nop 0
    buffer_load_dwordx4 v10, s[20:23], s46 offen lds
    s_add_u32 s46, s51, 442368
    s_add_u32 m0, s50, 3072
    s_nop 0
    buffer_load_dwordx4 v10, s[20:23], s46 offen lds
    s_waitcnt vmcnt(12)
    ds_read_b64_tr_b16 a[4:5], v9 offset:4096
    ds_read_b64_tr_b16 a[6:7], v9 offset:4352
    ds_read_b64_tr_b16 a[84:85], v9 offset:4104
    ds_read_b64_tr_b16 a[86:87], v9 offset:4360
    ds_read_b64_tr_b16 a[164:165], v9 offset:6144
    ds_read_b64_tr_b16 a[166:167], v9 offset:6400
    ds_read_b64_tr_b16 a[244:245], v9 offset:6152
    ds_read_b64_tr_b16 a[246:247], v9 offset:6408
    s_waitcnt lgkmcnt(0)
    s_add_u32 s46, s51, 491520
    s_add_u32 m0, s50, 4096
    s_nop 0
    buffer_load_dwordx4 v10, s[16:19], s46 offen lds
    s_add_u32 s46, s51, 540672
    s_add_u32 m0, s50, 5120
    s_nop 0
    buffer_load_dwordx4 v10, s[16:19], s46 offen lds
    s_add_u32 s46, s51, 491520
    s_add_u32 m0, s50, 6144
    s_nop 0
    buffer_load_dwordx4 v10, s[20:23], s46 offen lds
    s_add_u32 s46, s51, 540672
    s_add_u32 m0, s50, 7168
    s_nop 0
    buffer_load_dwordx4 v10, s[20:23], s46 offen lds
    s_waitcnt vmcnt(12)
    ds_read_b64_tr_b16 a[8:9], v9 offset:8192
    ds_read_b64_tr_b16 a[10:11], v9 offset:8448
    ds_read_b64_tr_b16 a[88:89], v9 offset:8200
    ds_read_b64_tr_b16 a[90:91], v9 offset:8456
    ds_read_b64_tr_b16 a[168:169], v9 offset:10240
    ds_read_b64_tr_b16 a[170:171], v9 offset:10496
    ds_read_b64_tr_b16 a[248:249], v9 offset:10248
    ds_read_b64_tr_b16 a[250:251], v9 offset:10504
    s_waitcnt lgkmcnt(0)
    s_add_u32 s46, s51, 589824
    s_add_u32 m0, s50, 8192
    s_nop 0
    buffer_load_dwordx4 v10, s[16:19], s46 offen lds
    s_add_u32 s46, s51, 638976
    s_add_u32 m0, s50, 9216
    s_nop 0
    buffer_load_dwordx4 v10, s[16:19], s46 offen lds
    s_add_u32 s46, s51, 589824
    s_add_u32 m0, s50, 10240
    s_nop 0
    buffer_load_dwordx4 v10, s[20:23], s46 offen lds
    s_add_u32 s46, s51, 638976
    s_add_u32 m0, s50, 11264
    s_nop 0
    buffer_load_dwordx4 v10, s[20:23], s46 offen lds
    s_waitcnt vmcnt(12)
    ds_read_b64_tr_b16 a[12:13], v9 offset:12288
    ds_read_b64_tr_b16 a[14:15], v9 offset:12544
    ds_read_b64_tr_b16 a[92:93], v9 offset:12296
    ds_read_b64_tr_b16 a[94:95], v9 offset:12552
    ds_read_b64_tr_b16 a[172:173], v9 offset:14336
    ds_read_b64_tr_b16 a[174:175], v9 offset:14592
    ds_read_b64_tr_b16 a[252:253], v9 offset:14344
    ds_read_b64_tr_b16 a[254:255], v9 offset:14600
    s_waitcnt lgkmcnt(0)
    s_add_u32 s46, s51, 688128
    s_add_u32 m0, s50, 12288
    s_nop 0
    buffer_load_dwordx4 v10, s[16:19], s46 offen lds
    s_add_u32 s46, s51, 737280
    s_add_u32 m0, s50, 13312
    s_nop 0
    buffer_load_dwordx4 v10, s[16:19], s46 offen lds
    s_add_u32 s46, s51, 688128
    s_add_u32 m0, s50, 14336
    s_nop 0
    buffer_load_dwordx4 v10, s[20:23], s46 offen lds
    s_add_u32 s46, s51, 737280
    s_add_u32 m0, s50, 15360
    s_nop 0
    buffer_load_dwordx4 v10, s[20:23], s46 offen lds
    s_waitcnt vmcnt(12)
    ds_read_b64_tr_b16 a[16:17], v9 offset:0
    ds_read_b64_tr_b16 a[18:19], v9 offset:256
    ds_read_b64_tr_b16 a[96:97], v9 offset:8
    ds_read_b64_tr_b16 a[98:99], v9 offset:264
    ds_read_b64_tr_b16 a[176:177], v9 offset:2048
    ds_read_b64_tr_b16 a[178:179], v9 offset:2304
    ds_read_b64_tr_b16 v[192:193], v9 offset:2056
    ds_read_b64_tr_b16 v[194:195], v9 offset:2312
    s_waitcnt lgkmcnt(0)
    s_add_u32 s46, s51, 786432
    s_add_u32 m0, s50, 0
    s_nop 0
    buffer_load_dwordx4 v10, s[16:19], s46 offen lds
    s_add_u32 s46, s51, 835584
    s_add_u32 m0, s50, 1024
    s_nop 0
    buffer_load_dwordx4 v10, s[16:19], s46 offen lds
    s_add_u32 s46, s51, 786432
    s_add_u32 m0, s50, 2048
    s_nop 0
    buffer_load_dwordx4 v10, s[20:23], s46 offen lds
    s_add_u32 s46, s51, 835584
    s_add_u32 m0, s50, 3072
    s_nop 0
    buffer_load_dwordx4 v10, s[20:23], s46 offen lds
    s_waitcnt vmcnt(12)
    ds_read_b64_tr_b16 a[20:21], v9 offset:4096
    ds_read_b64_tr_b16 a[22:23], v9 offset:4352
    ds_read_b64_tr_b16 a[100:101], v9 offset:4104
    ds_read_b64_tr_b16 a[102:103], v9 offset:4360
    ds_read_b64_tr_b16 a[180:181], v9 offset:6144
    ds_read_b64_tr_b16 a[182:183], v9 offset:6400
    ds_read_b64_tr_b16 v[196:197], v9 offset:6152
    ds_read_b64_tr_b16 v[198:199], v9 offset:6408
    s_waitcnt lgkmcnt(0)
    s_add_u32 s46, s51, 884736
    s_add_u32 m0, s50, 4096
    s_nop 0
    buffer_load_dwordx4 v10, s[16:19], s46 offen lds
    s_add_u32 s46, s51, 933888
    s_add_u32 m0, s50, 5120
    s_nop 0
    buffer_load_dwordx4 v10, s[16:19], s46 offen lds
    s_add_u32 s46, s51, 884736
    s_add_u32 m0, s50, 6144
    s_nop 0
    buffer_load_dwordx4 v10, s[20:23], s46 offen lds
    s_add_u32 s46, s51, 933888
    s_add_u32 m0, s50, 7168
    s_nop 0
    buffer_load_dwordx4 v10, s[20:23], s46 offen lds
    s_waitcnt vmcnt(12)
    ds_read_b64_tr_b16 a[24:25], v9 offset:8192
    ds_read_b64_tr_b16 a[26:27], v9 offset:8448
    ds_read_b64_tr_b16 a[104:105], v9 offset:8200
    ds_read_b64_tr_b16 a[106:107], v9 offset:8456
    ds_read_b64_tr_b16 a[184:185], v9 offset:10240
    ds_read_b64_tr_b16 a[186:187], v9 offset:10496
    ds_read_b64_tr_b16 v[200:201], v9 offset:10248
    ds_read_b64_tr_b16 v[202:203], v9 offset:10504
    s_waitcnt lgkmcnt(0)
    s_add_u32 s46, s51, 983040
    s_add_u32 m0, s50, 8192
    s_nop 0
    buffer_load_dwordx4 v10, s[16:19], s46 offen lds
    s_add_u32 s46, s51, 1032192
    s_add_u32 m0, s50, 9216
    s_nop 0
    buffer_load_dwordx4 v10, s[16:19], s46 offen lds
    s_add_u32 s46, s51, 983040
    s_add_u32 m0, s50, 10240
    s_nop 0
    buffer_load_dwordx4 v10, s[20:23], s46 offen lds
    s_add_u32 s46, s51, 1032192
    s_add_u32 m0, s50, 11264
    s_nop 0
    buffer_load_dwordx4 v10, s[20:23], s46 offen lds
    s_waitcnt vmcnt(12)
    ds_read_b64_tr_b16 a[28:29], v9 offset:12288
    ds_read_b64_tr_b16 a[30:31], v9 offset:12544
    ds_read_b64_tr_b16 a[108:109], v9 offset:12296
    ds_read_b64_tr_b16 a[110:111], v9 offset:12552
    ds_read_b64_tr_b16 a[188:189], v9 offset:14336
    ds_read_b64_tr_b16 a[190:191], v9 offset:14592
    ds_read_b64_tr_b16 v[204:205], v9 offset:14344
    ds_read_b64_tr_b16 v[206:207], v9 offset:14600
    s_waitcnt lgkmcnt(0)
    s_add_u32 s46, s51, 1081344
    s_add_u32 m0, s50, 12288
    s_nop 0
    buffer_load_dwordx4 v10, s[16:19], s46 offen lds
    s_add_u32 s46, s51, 1130496
    s_add_u32 m0, s50, 13312
    s_nop 0
    buffer_load_dwordx4 v10, s[16:19], s46 offen lds
    s_add_u32 s46, s51, 1081344
    s_add_u32 m0, s50, 14336
    s_nop 0
    buffer_load_dwordx4 v10, s[20:23], s46 offen lds
    s_add_u32 s46, s51, 1130496
    s_add_u32 m0, s50, 15360
    s_nop 0
    buffer_load_dwordx4 v10, s[20:23], s46 offen lds
    s_waitcnt vmcnt(12)
    ds_read_b64_tr_b16 a[32:33], v9 offset:0
    ds_read_b64_tr_b16 a[34:35], v9 offset:256
    ds_read_b64_tr_b16 a[112:113], v9 offset:8
    ds_read_b64_tr_b16 a[114:115], v9 offset:264
    ds_read_b64_tr_b16 a[192:193], v9 offset:2048
    ds_read_b64_tr_b16 a[194:195], v9 offset:2304
    ds_read_b64_tr_b16 v[208:209], v9 offset:2056
    ds_read_b64_tr_b16 v[210:211], v9 offset:2312
    s_waitcnt lgkmcnt(0)
    s_add_u32 s46, s51, 1179648
    s_add_u32 m0, s50, 0
    s_nop 0
    buffer_load_dwordx4 v10, s[16:19], s46 offen lds
    s_add_u32 s46, s51, 1228800
    s_add_u32 m0, s50, 1024
    s_nop 0
    buffer_load_dwordx4 v10, s[16:19], s46 offen lds
    s_add_u32 s46, s51, 1179648
    s_add_u32 m0, s50, 2048
    s_nop 0
    buffer_load_dwordx4 v10, s[20:23], s46 offen lds
    s_add_u32 s46, s51, 1228800
    s_add_u32 m0, s50, 3072
    s_nop 0
    buffer_load_dwordx4 v10, s[20:23], s46 offen lds
    s_waitcnt vmcnt(12)
    ds_read_b64_tr_b16 a[36:37], v9 offset:4096
    ds_read_b64_tr_b16 a[38:39], v9 offset:4352
    ds_read_b64_tr_b16 a[116:117], v9 offset:4104
    ds_read_b64_tr_b16 a[118:119], v9 offset:4360
    ds_read_b64_tr_b16 a[196:197], v9 offset:6144
    ds_read_b64_tr_b16 a[198:199], v9 offset:6400
    ds_read_b64_tr_b16 v[212:213], v9 offset:6152
    ds_read_b64_tr_b16 v[214:215], v9 offset:6408
    s_waitcnt lgkmcnt(0)
    s_add_u32 s46, s51, 1277952
    s_add_u32 m0, s50, 4096
    s_nop 0
    buffer_load_dwordx4 v10, s[16:19], s46 offen lds
    s_add_u32 s46, s51, 1327104
    s_add_u32 m0, s50, 5120
    s_nop 0
    buffer_load_dwordx4 v10, s[16:19], s46 offen lds
    s_add_u32 s46, s51, 1277952
    s_add_u32 m0, s50, 6144
    s_nop 0
    buffer_load_dwordx4 v10, s[20:23], s46 offen lds
    s_add_u32 s46, s51, 1327104
    s_add_u32 m0, s50, 7168
    s_nop 0
    buffer_load_dwordx4 v10, s[20:23], s46 offen lds
    s_waitcnt vmcnt(12)
    ds_read_b64_tr_b16 a[40:41], v9 offset:8192
    ds_read_b64_tr_b16 a[42:43], v9 offset:8448
    ds_read_b64_tr_b16 a[120:121], v9 offset:8200
    ds_read_b64_tr_b16 a[122:123], v9 offset:8456
    ds_read_b64_tr_b16 a[200:201], v9 offset:10240
    ds_read_b64_tr_b16 a[202:203], v9 offset:10496
    ds_read_b64_tr_b16 v[216:217], v9 offset:10248
    ds_read_b64_tr_b16 v[218:219], v9 offset:10504
    s_waitcnt lgkmcnt(0)
    s_add_u32 s46, s51, 1376256
    s_add_u32 m0, s50, 8192
    s_nop 0
    buffer_load_dwordx4 v10, s[16:19], s46 offen lds
    s_add_u32 s46, s51, 1425408
    s_add_u32 m0, s50, 9216
    s_nop 0
    buffer_load_dwordx4 v10, s[16:19], s46 offen lds
    s_add_u32 s46, s51, 1376256
    s_add_u32 m0, s50, 10240
    s_nop 0
    buffer_load_dwordx4 v10, s[20:23], s46 offen lds
    s_add_u32 s46, s51, 1425408
    s_add_u32 m0, s50, 11264
    s_nop 0
    buffer_load_dwordx4 v10, s[20:23], s46 offen lds
    s_waitcnt vmcnt(12)
    ds_read_b64_tr_b16 a[44:45], v9 offset:12288
    ds_read_b64_tr_b16 a[46:47], v9 offset:12544
    ds_read_b64_tr_b16 a[124:125], v9 offset:12296
    ds_read_b64_tr_b16 a[126:127], v9 offset:12552
    ds_read_b64_tr_b16 a[204:205], v9 offset:14336
    ds_read_b64_tr_b16 a[206:207], v9 offset:14592
    ds_read_b64_tr_b16 v[220:221], v9 offset:14344
    ds_read_b64_tr_b16 v[222:223], v9 offset:14600
    s_waitcnt lgkmcnt(0)
    s_add_u32 s46, s51, 1474560
    s_add_u32 m0, s50, 12288
    s_nop 0
    buffer_load_dwordx4 v10, s[16:19], s46 offen lds
    s_add_u32 s46, s51, 1523712
    s_add_u32 m0, s50, 13312
    s_nop 0
    buffer_load_dwordx4 v10, s[16:19], s46 offen lds
    s_add_u32 s46, s51, 1474560
    s_add_u32 m0, s50, 14336
    s_nop 0
    buffer_load_dwordx4 v10, s[20:23], s46 offen lds
    s_add_u32 s46, s51, 1523712
    s_add_u32 m0, s50, 15360
    s_nop 0
    buffer_load_dwordx4 v10, s[20:23], s46 offen lds
    s_waitcnt vmcnt(12)
    ds_read_b64_tr_b16 a[48:49], v9 offset:0
    ds_read_b64_tr_b16 a[50:51], v9 offset:256
    ds_read_b64_tr_b16 a[128:129], v9 offset:8
    ds_read_b64_tr_b16 a[130:131], v9 offset:264
    ds_read_b64_tr_b16 a[208:209], v9 offset:2048
    ds_read_b64_tr_b16 a[210:211], v9 offset:2304
    ds_read_b64_tr_b16 v[224:225], v9 offset:2056
    ds_read_b64_tr_b16 v[226:227], v9 offset:2312
    s_waitcnt lgkmcnt(0)
    s_add_u32 s46, s51, 1572864
    s_add_u32 m0, s50, 0
    s_nop 0
    buffer_load_dwordx4 v10, s[16:19], s46 offen lds
    s_add_u32 s46, s51, 1622016
    s_add_u32 m0, s50, 1024
    s_nop 0
    buffer_load_dwordx4 v10, s[16:19], s46 offen lds
    s_add_u32 s46, s51, 1572864
    s_add_u32 m0, s50, 2048
    s_nop 0
    buffer_load_dwordx4 v10, s[20:23], s46 offen lds
    s_add_u32 s46, s51, 1622016
    s_add_u32 m0, s50, 3072
    s_nop 0
    buffer_load_dwordx4 v10, s[20:23], s46 offen lds
    s_waitcnt vmcnt(12)
    ds_read_b64_tr_b16 a[52:53], v9 offset:4096
    ds_read_b64_tr_b16 a[54:55], v9 offset:4352
    ds_read_b64_tr_b16 a[132:133], v9 offset:4104
    ds_read_b64_tr_b16 a[134:135], v9 offset:4360
    ds_read_b64_tr_b16 a[212:213], v9 offset:6144
    ds_read_b64_tr_b16 a[214:215], v9 offset:6400
    ds_read_b64_tr_b16 v[228:229], v9 offset:6152
    ds_read_b64_tr_b16 v[230:231], v9 offset:6408
    s_waitcnt lgkmcnt(0)
    s_add_u32 s46, s51, 1671168
    s_add_u32 m0, s50, 4096
    s_nop 0
    buffer_load_dwordx4 v10, s[16:19], s46 offen lds
    s_add_u32 s46, s51, 1720320
    s_add_u32 m0, s50, 5120
    s_nop 0
    buffer_load_dwordx4 v10, s[16:19], s46 offen lds
    s_add_u32 s46, s51, 1671168
    s_add_u32 m0, s50, 6144
    s_nop 0
    buffer_load_dwordx4 v10, s[20:23], s46 offen lds
    s_add_u32 s46, s51, 1720320
    s_add_u32 m0, s50, 7168
    s_nop 0
    buffer_load_dwordx4 v10, s[20:23], s46 offen lds
    s_waitcnt vmcnt(12)
    ds_read_b64_tr_b16 a[56:57], v9 offset:8192
    ds_read_b64_tr_b16 a[58:59], v9 offset:8448
    ds_read_b64_tr_b16 a[136:137], v9 offset:8200
    ds_read_b64_tr_b16 a[138:139], v9 offset:8456
    ds_read_b64_tr_b16 a[216:217], v9 offset:10240
    ds_read_b64_tr_b16 a[218:219], v9 offset:10496
    ds_read_b64_tr_b16 v[232:233], v9 offset:10248
    ds_read_b64_tr_b16 v[234:235], v9 offset:10504
    s_waitcnt lgkmcnt(0)
    s_add_u32 s46, s51, 1769472
    s_add_u32 m0, s50, 8192
    s_nop 0
    buffer_load_dwordx4 v10, s[16:19], s46 offen lds
    s_add_u32 s46, s51, 1818624
    s_add_u32 m0, s50, 9216
    s_nop 0
    buffer_load_dwordx4 v10, s[16:19], s46 offen lds
    s_add_u32 s46, s51, 1769472
    s_add_u32 m0, s50, 10240
    s_nop 0
    buffer_load_dwordx4 v10, s[20:23], s46 offen lds
    s_add_u32 s46, s51, 1818624
    s_add_u32 m0, s50, 11264
    s_nop 0
    buffer_load_dwordx4 v10, s[20:23], s46 offen lds
    s_waitcnt vmcnt(12)
    ds_read_b64_tr_b16 a[60:61], v9 offset:12288
    ds_read_b64_tr_b16 a[62:63], v9 offset:12544
    ds_read_b64_tr_b16 a[140:141], v9 offset:12296
    ds_read_b64_tr_b16 a[142:143], v9 offset:12552
    ds_read_b64_tr_b16 a[220:221], v9 offset:14336
    ds_read_b64_tr_b16 a[222:223], v9 offset:14592
    ds_read_b64_tr_b16 v[236:237], v9 offset:14344
    ds_read_b64_tr_b16 v[238:239], v9 offset:14600
    s_waitcnt lgkmcnt(0)
    s_add_u32 s46, s51, 1867776
    s_add_u32 m0, s50, 12288
    s_nop 0
    buffer_load_dwordx4 v10, s[16:19], s46 offen lds
    s_add_u32 s46, s51, 1916928
    s_add_u32 m0, s50, 13312
    s_nop 0
    buffer_load_dwordx4 v10, s[16:19], s46 offen lds
    s_add_u32 s46, s51, 1867776
    s_add_u32 m0, s50, 14336
    s_nop 0
    buffer_load_dwordx4 v10, s[20:23], s46 offen lds
    s_add_u32 s46, s51, 1916928
    s_add_u32 m0, s50, 15360
    s_nop 0
    buffer_load_dwordx4 v10, s[20:23], s46 offen lds
    s_waitcnt vmcnt(12)
    ds_read_b64_tr_b16 a[64:65], v9 offset:0
    ds_read_b64_tr_b16 a[66:67], v9 offset:256
    ds_read_b64_tr_b16 a[144:145], v9 offset:8
    ds_read_b64_tr_b16 a[146:147], v9 offset:264
    ds_read_b64_tr_b16 a[224:225], v9 offset:2048
    ds_read_b64_tr_b16 a[226:227], v9 offset:2304
    ds_read_b64_tr_b16 v[240:241], v9 offset:2056
    ds_read_b64_tr_b16 v[242:243], v9 offset:2312
    s_waitcnt lgkmcnt(0)
    s_waitcnt vmcnt(8)
    ds_read_b64_tr_b16 a[68:69], v9 offset:4096
    ds_read_b64_tr_b16 a[70:71], v9 offset:4352
    ds_read_b64_tr_b16 a[148:149], v9 offset:4104
    ds_read_b64_tr_b16 a[150:151], v9 offset:4360
    ds_read_b64_tr_b16 a[228:229], v9 offset:6144
    ds_read_b64_tr_b16 a[230:231], v9 offset:6400
    ds_read_b64_tr_b16 v[244:245], v9 offset:6152
    ds_read_b64_tr_b16 v[246:247], v9 offset:6408
    s_waitcnt lgkmcnt(0)
    s_waitcnt vmcnt(4)
    ds_read_b64_tr_b16 a[72:73], v9 offset:8192
    ds_read_b64_tr_b16 a[74:75], v9 offset:8448
    ds_read_b64_tr_b16 a[152:153], v9 offset:8200
    ds_read_b64_tr_b16 a[154:155], v9 offset:8456
    ds_read_b64_tr_b16 a[232:233], v9 offset:10240
    ds_read_b64_tr_b16 a[234:235], v9 offset:10496
    ds_read_b64_tr_b16 v[248:249], v9 offset:10248
    ds_read_b64_tr_b16 v[250:251], v9 offset:10504
    s_waitcnt lgkmcnt(0)
    s_waitcnt vmcnt(0)
    ds_read_b64_tr_b16 a[76:77], v9 offset:12288
    ds_read_b64_tr_b16 a[78:79], v9 offset:12544
    ds_read_b64_tr_b16 a[156:157], v9 offset:12296
    ds_read_b64_tr_b16 a[158:159], v9 offset:12552
    ds_read_b64_tr_b16 a[236:237], v9 offset:14336
    ds_read_b64_tr_b16 a[238:239], v9 offset:14592
    ds_read_b64_tr_b16 v[252:253], v9 offset:14344
    ds_read_b64_tr_b16 v[254:255], v9 offset:14600
    s_waitcnt lgkmcnt(0)
    s_or_b32 s58, s32, s33
    s_load_dwordx2 s[4:5], s[0:1], 88
    s_waitcnt lgkmcnt(0)
    s_mov_b32 s16, s4
    s_mov_b32 s17, s5
    s_mov_b32 s18, 1280
    s_mov_b32 s19, 0x20000
    s_cmp_lg_u32 s58, 0
    s_cbranch_scc1 F1G_99
    v_lshrrev_b32 v1, 4, v0
    v_lshlrev_b32 v1, 4, v1
    buffer_load_dwordx4 v[100:103], v1, s[16:19], 0 offen offset:0
    buffer_load_dwordx4 v[104:107], v1, s[16:19], 0 offen offset:64
    buffer_load_dwordx4 v[108:111], v1, s[16:19], 0 offen offset:128
    buffer_load_dwordx4 v[112:115], v1, s[16:19], 0 offen offset:192
    buffer_load_dwordx4 v[116:119], v1, s[16:19], 0 offen offset:256
    buffer_load_dwordx4 v[120:123], v1, s[16:19], 0 offen offset:320
    buffer_load_dwordx4 v[124:127], v1, s[16:19], 0 offen offset:384
    buffer_load_dwordx4 v[128:131], v1, s[16:19], 0 offen offset:448
    buffer_load_dwordx4 v[132:135], v1, s[16:19], 0 offen offset:512
    buffer_load_dwordx4 v[136:139], v1, s[16:19], 0 offen offset:576
    buffer_load_dwordx4 v[140:143], v1, s[16:19], 0 offen offset:640
    buffer_load_dwordx4 v[144:147], v1, s[16:19], 0 offen offset:704
    buffer_load_dwordx4 v[148:151], v1, s[16:19], 0 offen offset:768
    buffer_load_dwordx4 v[152:155], v1, s[16:19], 0 offen offset:832
    buffer_load_dwordx4 v[156:159], v1, s[16:19], 0 offen offset:896
    buffer_load_dwordx4 v[160:163], v1, s[16:19], 0 offen offset:960
    buffer_load_dwordx4 v[164:167], v1, s[16:19], 0 offen offset:1024
    buffer_load_dwordx4 v[168:171], v1, s[16:19], 0 offen offset:1088
    buffer_load_dwordx4 v[172:175], v1, s[16:19], 0 offen offset:1152
    buffer_load_dwordx4 v[176:179], v1, s[16:19], 0 offen offset:1216
F1G_99:
    v_and_b32 v1, 15, v0
    v_lshlrev_b32 v11, 2, v1
    s_lshl_b32 s53, s32, 2
    s_add_u32 s53, s53, s33
    s_lshl_b32 s53, s53, 10
    s_add_u32 s53, s53, 7340032
    s_waitcnt vmcnt(0)
F1L_100:
    s_cmp_le_u32 s34, 1
    s_cbranch_scc1 F1W_101
    s_cmp_eq_u32 s58, 0
    s_cbranch_scc1 F1W_101
    s_waitcnt vmcnt(2)
    s_branch F1W_102
F1W_101:
    s_waitcnt vmcnt(0)
F1W_102:
    s_sub_u32 s55, s34, 1
    s_cmp_le_u32 s34, 1
    s_cselect_b32 s55, s34, s55
    s_barrier
    s_cmp_lg_u32 s33, 0
    s_cbranch_scc1 F1F_103
    v_mov_b32 v1, s55
    v_mov_b32 v2, s54
    s_mov_b64 exec, 1
    buffer_store_dword v1, v2, s[8:11], 0 offen sc1
    s_mov_b64 exec, -1
F1F_103:
    s_add_u32 s45, s34, 1
    s_and_b32 s64, s45, 1
    s_mul_i32 s64, s64, 40960
    s_add_u32 s64, s64, s52
    s_min_u32 s45, s45, 63
    s_mul_i32 s63, s45, 40960
    s_and_b32 s45, s34, 1
    s_mul_i32 s45, s45, 40960
    v_add_u32 v6, s45, v5
    ds_read_b128 v[48:51], v6 offset:0
    ds_read_b128 v[52:55], v6 offset:1024
    ds_read_b128 v[56:59], v6 offset:2048
    ds_read_b128 v[60:63], v6 offset:3072
    s_waitcnt lgkmcnt(2)
    v_mfma_f32_16x16x32_bf16 v[16:19], a[0:3], v[48:51], 0
    v_mfma_f32_16x16x32_bf16 v[32:35], a[0:3], v[52:55], 0
    v_mfma_f32_16x16x32_bf16 v[20:23], a[80:83], v[48:51], 0
    v_mfma_f32_16x16x32_bf16 v[36:39], a[80:83], v[52:55], 0
    v_mfma_f32_16x16x32_bf16 v[24:27], a[160:163], v[48:51], 0
    v_mfma_f32_16x16x32_bf16 v[40:43], a[160:163], v[52:55], 0
    v_mfma_f32_16x16x32_bf16 v[28:31], a[240:243], v[48:51], 0
    v_mfma_f32_16x16x32_bf16 v[44:47], a[240:243], v[52:55], 0
    s_add_u32 m0, s64, 0
    s_add_u32 s47, s63, 0
    buffer_load_dwordx4 v4, s[12:15], s47 offen lds
    ds_read_b128 v[48:51], v6 offset:4096
    ds_read_b128 v[52:55], v6 offset:5120
    s_waitcnt lgkmcnt(2)
    v_mfma_f32_16x16x32_bf16 v[16:19], a[4:7], v[56:59], v[16:19]
    v_mfma_f32_16x16x32_bf16 v[32:35], a[4:7], v[60:63], v[32:35]
    v_mfma_f32_16x16x32_bf16 v[20:23], a[84:87], v[56:59], v[20:23]
    v_mfma_f32_16x16x32_bf16 v[36:39], a[84:87], v[60:63], v[36:39]
    v_mfma_f32_16x16x32_bf16 v[24:27], a[164:167], v[56:59], v[24:27]
    v_mfma_f32_16x16x32_bf16 v[40:43], a[164:167], v[60:63], v[40:43]
    v_mfma_f32_16x16x32_bf16 v[28:31], a[244:247], v[56:59], v[28:31]
    v_mfma_f32_16x16x32_bf16 v[44:47], a[244:247], v[60:63], v[44:47]
    ds_read_b128 v[56:59], v6 offset:6144
    ds_read_b128 v[60:63], v6 offset:7168
    s_waitcnt lgkmcnt(2)
    v_mfma_f32_16x16x32_bf16 v[16:19], a[8:11], v[48:51], v[16:19]
    v_mfma_f32_16x16x32_bf16 v[32:35], a[8:11], v[52:55], v[32:35]
    v_mfma_f32_16x16x32_bf16 v[20:23], a[88:91], v[48:51], v[20:23]
    v_mfma_f32_16x16x32_bf16 v[36:39], a[88:91], v[52:55], v[36:39]
    v_mfma_f32_16x16x32_bf16 v[24:27], a[168:171], v[48:51], v[24:27]
    v_mfma_f32_16x16x32_bf16 v[40:43], a[168:171], v[52:55], v[40:43]
    v_mfma_f32_16x16x32_bf16 v[28:31], a[248:251], v[48:51], v[28:31]
    v_mfma_f32_16x16x32_bf16 v[44:47], a[248:251], v[52:55], v[44:47]
    s_add_u32 m0, s64, 1024
    s_add_u32 s47, s63, 20480
    buffer_load_dwordx4 v4, s[12:15], s47 offen lds
    ds_read_b128 v[48:51], v6 offset:8192
    ds_read_b128 v[52:55], v6 offset:9216
    s_waitcnt lgkmcnt(2)
    v_mfma_f32_16x16x32_bf16 v[16:19], a[12:15], v[56:59], v[16:19]
    v_mfma_f32_16x16x32_bf16 v[32:35], a[12:15], v[60:63], v[32:35]
    v_mfma_f32_16x16x32_bf16 v[20:23], a[92:95], v[56:59], v[20:23]
    v_mfma_f32_16x16x32_bf16 v[36:39], a[92:95], v[60:63], v[36:39]
    v_mfma_f32_16x16x32_bf16 v[24:27], a[172:175], v[56:59], v[24:27]
    v_mfma_f32_16x16x32_bf16 v[40:43], a[172:175], v[60:63], v[40:43]
    v_mfma_f32_16x16x32_bf16 v[28:31], a[252:255], v[56:59], v[28:31]
    v_mfma_f32_16x16x32_bf16 v[44:47], a[252:255], v[60:63], v[44:47]
    ds_read_b128 v[56:59], v6 offset:10240
    ds_read_b128 v[60:63], v6 offset:11264
    s_waitcnt lgkmcnt(2)
    v_mfma_f32_16x16x32_bf16 v[16:19], a[16:19], v[48:51], v[16:19]
    v_mfma_f32_16x16x32_bf16 v[32:35], a[16:19], v[52:55], v[32:35]
    v_mfma_f32_16x16x32_bf16 v[20:23], a[96:99], v[48:51], v[20:23]
    v_mfma_f32_16x16x32_bf16 v[36:39], a[96:99], v[52:55], v[36:39]
    v_mfma_f32_16x16x32_bf16 v[24:27], a[176:179], v[48:51], v[24:27]
    v_mfma_f32_16x16x32_bf16 v[40:43], a[176:179], v[52:55], v[40:43]
    v_mfma_f32_16x16x32_bf16 v[28:31], v[192:195], v[48:51], v[28:31]
    v_mfma_f32_16x16x32_bf16 v[44:47], v[192:195], v[52:55], v[44:47]
    s_add_u32 m0, s64, 2048
    s_add_u32 s47, s63, 64
    buffer_load_dwordx4 v4, s[12:15], s47 offen lds
    ds_read_b128 v[48:51], v6 offset:12288
    ds_read_b128 v[52:55], v6 offset:13312
    s_waitcnt lgkmcnt(2)
    v_mfma_f32_16x16x32_bf16 v[16:19], a[20:23], v[56:59], v[16:19]
    v_mfma_f32_16x16x32_bf16 v[32:35], a[20:23], v[60:63], v[32:35]
    v_mfma_f32_16x16x32_bf16 v[20:23], a[100:103], v[56:59], v[20:23]
    v_mfma_f32_16x16x32_bf16 v[36:39], a[100:103], v[60:63], v[36:39]
    v_mfma_f32_16x16x32_bf16 v[24:27], a[180:183], v[56:59], v[24:27]
    v_mfma_f32_16x16x32_bf16 v[40:43], a[180:183], v[60:63], v[40:43]
    v_mfma_f32_16x16x32_bf16 v[28:31], v[196:199], v[56:59], v[28:31]
    v_mfma_f32_16x16x32_bf16 v[44:47], v[196:199], v[60:63], v[44:47]
    ds_read_b128 v[56:59], v6 offset:14336
    ds_read_b128 v[60:63], v6 offset:15360
    s_waitcnt lgkmcnt(2)
    v_mfma_f32_16x16x32_bf16 v[16:19], a[24:27], v[48:51], v[16:19]
    v_mfma_f32_16x16x32_bf16 v[32:35], a[24:27], v[52:55], v[32:35]
    v_mfma_f32_16x16x32_bf16 v[20:23], a[104:107], v[48:51], v[20:23]
    v_mfma_f32_16x16x32_bf16 v[36:39], a[104:107], v[52:55], v[36:39]
    v_mfma_f32_16x16x32_bf16 v[24:27], a[184:187], v[48:51], v[24:27]
    v_mfma_f32_16x16x32_bf16 v[40:43], a[184:187], v[52:55], v[40:43]
    v_mfma_f32_16x16x32_bf16 v[28:31], v[200:203], v[48:51], v[28:31]
    v_mfma_f32_16x16x32_bf16 v[44:47], v[200:203], v[52:55], v[44:47]
    s_add_u32 m0, s64, 3072
    s_add_u32 s47, s63, 20544
    buffer_load_dwordx4 v4, s[12:15], s47 offen lds
    ds_read_b128 v[48:51], v6 offset:16384
    ds_read_b128 v[52:55], v6 offset:17408
    s_waitcnt lgkmcnt(2)
    v_mfma_f32_16x16x32_bf16 v[16:19], a[28:31], v[56:59], v[16:19]
    v_mfma_f32_16x16x32_bf16 v[32:35], a[28:31], v[60:63], v[32:35]
    v_mfma_f32_16x16x32_bf16 v[20:23], a[108:111], v[56:59], v[20:23]
    v_mfma_f32_16x16x32_bf16 v[36:39], a[108:111], v[60:63], v[36:39]
    v_mfma_f32_16x16x32_bf16 v[24:27], a[188:191], v[56:59], v[24:27]
    v_mfma_f32_16x16x32_bf16 v[40:43], a[188:191], v[60:63], v[40:43]
    v_mfma_f32_16x16x32_bf16 v[28:31], v[204:207], v[56:59], v[28:31]
    v_mfma_f32_16x16x32_bf16 v[44:47], v[204:207], v[60:63], v[44:47]
    ds_read_b128 v[56:59], v6 offset:18432
    ds_read_b128 v[60:63], v6 offset:19456
    s_waitcnt lgkmcnt(2)
    v_mfma_f32_16x16x32_bf16 v[16:19], a[32:35], v[48:51], v[16:19]
    v_mfma_f32_16x16x32_bf16 v[32:35], a[32:35], v[52:55], v[32:35]
    v_mfma_f32_16x16x32_bf16 v[20:23], a[112:115], v[48:51], v[20:23]
    v_mfma_f32_16x16x32_bf16 v[36:39], a[112:115], v[52:55], v[36:39]
    v_mfma_f32_16x16x32_bf16 v[24:27], a[192:195], v[48:51], v[24:27]
    v_mfma_f32_16x16x32_bf16 v[40:43], a[192:195], v[52:55], v[40:43]
    v_mfma_f32_16x16x32_bf16 v[28:31], v[208:211], v[48:51], v[28:31]
    v_mfma_f32_16x16x32_bf16 v[44:47], v[208:211], v[52:55], v[44:47]
    s_add_u32 m0, s64, 4096
    s_add_u32 s47, s63, 128
    buffer_load_dwordx4 v4, s[12:15], s47 offen lds
    ds_read_b128 v[48:51], v6 offset:20480
    ds_read_b128 v[52:55], v6 offset:21504
    s_waitcnt lgkmcnt(2)
    v_mfma_f32_16x16x32_bf16 v[16:19], a[36:39], v[56:59], v[16:19]
    v_mfma_f32_16x16x32_bf16 v[32:35], a[36:39], v[60:63], v[32:35]
    v_mfma_f32_16x16x32_bf16 v[20:23], a[116:119], v[56:59], v[20:23]
    v_mfma_f32_16x16x32_bf16 v[36:39], a[116:119], v[60:63], v[36:39]
    v_mfma_f32_16x16x32_bf16 v[24:27], a[196:199], v[56:59], v[24:27]
    v_mfma_f32_16x16x32_bf16 v[40:43], a[196:199], v[60:63], v[40:43]
    v_mfma_f32_16x16x32_bf16 v[28:31], v[212:215], v[56:59], v[28:31]
    v_mfma_f32_16x16x32_bf16 v[44:47], v[212:215], v[60:63], v[44:47]
    ds_read_b128 v[56:59], v6 offset:22528
    ds_read_b128 v[60:63], v6 offset:23552
    s_waitcnt lgkmcnt(2)
    v_mfma_f32_16x16x32_bf16 v[16:19], a[40:43], v[48:51], v[16:19]
    v_mfma_f32_16x16x32_bf16 v[32:35], a[40:43], v[52:55], v[32:35]
    v_mfma_f32_16x16x32_bf16 v[20:23], a[120:123], v[48:51], v[20:23]
    v_mfma_f32_16x16x32_bf16 v[36:39], a[120:123], v[52:55], v[36:39]
    v_mfma_f32_16x16x32_bf16 v[24:27], a[200:203], v[48:51], v[24:27]
    v_mfma_f32_16x16x32_bf16 v[40:43], a[200:203], v[52:55], v[40:43]
    v_mfma_f32_16x16x32_bf16 v[28:31], v[216:219], v[48:51], v[28:31]
    v_mfma_f32_16x16x32_bf16 v[44:47], v[216:219], v[52:55], v[44:47]
    s_add_u32 m0, s64, 5120
    s_add_u32 s47, s63, 20608
    buffer_load_dwordx4 v4, s[12:15], s47 offen lds
    ds_read_b128 v[48:51], v6 offset:24576
    ds_read_b128 v[52:55], v6 offset:25600
    s_waitcnt lgkmcnt(2)
    v_mfma_f32_16x16x32_bf16 v[16:19], a[44:47], v[56:59], v[16:19]
    v_mfma_f32_16x16x32_bf16 v[32:35], a[44:47], v[60:63], v[32:35]
    v_mfma_f32_16x16x32_bf16 v[20:23], a[124:127], v[56:59], v[20:23]
    v_mfma_f32_16x16x32_bf16 v[36:39], a[124:127], v[60:63], v[36:39]
    v_mfma_f32_16x16x32_bf16 v[24:27], a[204:207], v[56:59], v[24:27]
    v_mfma_f32_16x16x32_bf16 v[40:43], a[204:207], v[60:63], v[40:43]
    v_mfma_f32_16x16x32_bf16 v[28:31], v[220:223], v[56:59], v[28:31]
    v_mfma_f32_16x16x32_bf16 v[44:47], v[220:223], v[60:63], v[44:47]
    ds_read_b128 v[56:59], v6 offset:26624
    ds_read_b128 v[60:63], v6 offset:27648
    s_waitcnt lgkmcnt(2)
    v_mfma_f32_16x16x32_bf16 v[16:19], a[48:51], v[48:51], v[16:19]
    v_mfma_f32_16x16x32_bf16 v[32:35], a[48:51], v[52:55], v[32:35]
    v_mfma_f32_16x16x32_bf16 v[20:23], a[128:131], v[48:51], v[20:23]
    v_mfma_f32_16x16x32_bf16 v[36:39], a[128:131], v[52:55], v[36:39]
    v_mfma_f32_16x16x32_bf16 v[24:27], a[208:211], v[48:51], v[24:27]
    v_mfma_f32_16x16x32_bf16 v[40:43], a[208:211], v[52:55], v[40:43]
    v_mfma_f32_16x16x32_bf16 v[28:31], v[224:227], v[48:51], v[28:31]
    v_mfma_f32_16x16x32_bf16 v[44:47], v[224:227], v[52:55], v[44:47]
    s_add_u32 m0, s64, 6144
    s_add_u32 s47, s63, 192
    buffer_load_dwordx4 v4, s[12:15], s47 offen lds
    ds_read_b128 v[48:51], v6 offset:28672
    ds_read_b128 v[52:55], v6 offset:29696
    s_waitcnt lgkmcnt(2)
    v_mfma_f32_16x16x32_bf16 v[16:19], a[52:55], v[56:59], v[16:19]
    v_mfma_f32_16x16x32_bf16 v[32:35], a[52:55], v[60:63], v[32:35]
    v_mfma_f32_16x16x32_bf16 v[20:23], a[132:135], v[56:59], v[20:23]
    v_mfma_f32_16x16x32_bf16 v[36:39], a[132:135], v[60:63], v[36:39]
    v_mfma_f32_16x16x32_bf16 v[24:27], a[212:215], v[56:59], v[24:27]
    v_mfma_f32_16x16x32_bf16 v[40:43], a[212:215], v[60:63], v[40:43]
    v_mfma_f32_16x16x32_bf16 v[28:31], v[228:231], v[56:59], v[28:31]
    v_mfma_f32_16x16x32_bf16 v[44:47], v[228:231], v[60:63], v[44:47]
    ds_read_b128 v[56:59], v6 offset:30720
    ds_read_b128 v[60:63], v6 offset:31744
    s_waitcnt lgkmcnt(2)
    v_mfma_f32_16x16x32_bf16 v[16:19], a[56:59], v[48:51], v[16:19]
    v_mfma_f32_16x16x32_bf16 v[32:35], a[56:59], v[52:55], v[32:35]
    v_mfma_f32_16x16x32_bf16 v[20:23], a[136:139], v[48:51], v[20:23]
    v_mfma_f32_16x16x32_bf16 v[36:39], a[136:139], v[52:55], v[36:39]
    v_mfma_f32_16x16x32_bf16 v[24:27], a[216:219], v[48:51], v[24:27]
    v_mfma_f32_16x16x32_bf16 v[40:43], a[216:219], v[52:55], v[40:43]
    v_mfma_f32_16x16x32_bf16 v[28:31], v[232:235], v[48:51], v[28:31]
    v_mfma_f32_16x16x32_bf16 v[44:47], v[232:235], v[52:55], v[44:47]
    s_add_u32 m0, s64, 7168
    s_add_u32 s47, s63, 20672
    buffer_load_dwordx4 v4, s[12:15], s47 offen lds
    ds_read_b128 v[48:51], v6 offset:32768
    ds_read_b128 v[52:55], v6 offset:33792
    s_waitcnt lgkmcnt(2)
    v_mfma_f32_16x16x32_bf16 v[16:19], a[60:63], v[56:59], v[16:19]
    v_mfma_f32_16x16x32_bf16 v[32:35], a[60:63], v[60:63], v[32:35]
    v_mfma_f32_16x16x32_bf16 v[20:23], a[140:143], v[56:59], v[20:23]
    v_mfma_f32_16x16x32_bf16 v[36:39], a[140:143], v[60:63], v[36:39]
    v_mfma_f32_16x16x32_bf16 v[24:27], a[220:223], v[56:59], v[24:27]
    v_mfma_f32_16x16x32_bf16 v[40:43], a[220:223], v[60:63], v[40:43]
    v_mfma_f32_16x16x32_bf16 v[28:31], v[236:239], v[56:59], v[28:31]
    v_mfma_f32_16x16x32_bf16 v[44:47], v[236:239], v[60:63], v[44:47]
    ds_read_b128 v[56:59], v6 offset:34816
    ds_read_b128 v[60:63], v6 offset:35840
    s_waitcnt lgkmcnt(2)
    v_mfma_f32_16x16x32_bf16 v[16:19], a[64:67], v[48:51], v[16:19]
    v_mfma_f32_16x16x32_bf16 v[32:35], a[64:67], v[52:55], v[32:35]
    v_mfma_f32_16x16x32_bf16 v[20:23], a[144:147], v[48:51], v[20:23]
    v_mfma_f32_16x16x32_bf16 v[36:39], a[144:147], v[52:55], v[36:39]
    v_mfma_f32_16x16x32_bf16 v[24:27], a[224:227], v[48:51], v[24:27]
    v_mfma_f32_16x16x32_bf16 v[40:43], a[224:227], v[52:55], v[40:43]
    v_mfma_f32_16x16x32_bf16 v[28:31], v[240:243], v[48:51], v[28:31]
    v_mfma_f32_16x16x32_bf16 v[44:47], v[240:243], v[52:55], v[44:47]
    s_add_u32 m0, s64, 8192
    s_add_u32 s47, s63, 256
    buffer_load_dwordx4 v4, s[12:15], s47 offen lds
    ds_read_b128 v[48:51], v6 offset:36864
    ds_read_b128 v[52:55], v6 offset:37888
    s_waitcnt lgkmcnt(2)
    v_mfma_f32_16x16x32_bf16 v[16:19], a[68:71], v[56:59], v[16:19]
    v_mfma_f32_16x16x32_bf16 v[32:35], a[68:71], v[60:63], v[32:35]
    v_mfma_f32_16x16x32_bf16 v[20:23], a[148:151], v[56:59], v[20:23]
    v_mfma_f32_16x16x32_bf16 v[36:39], a[148:151], v[60:63], v[36:39]
    v_mfma_f32_16x16x32_bf16 v[24:27], a[228:231], v[56:59], v[24:27]
    v_mfma_f32_16x16x32_bf16 v[40:43], a[228:231], v[60:63], v[40:43]
    v_mfma_f32_16x16x32_bf16 v[28:31], v[244:247], v[56:59], v[28:31]
    v_mfma_f32_16x16x32_bf16 v[44:47], v[244:247], v[60:63], v[44:47]
    ds_read_b128 v[56:59], v6 offset:38912
    ds_read_b128 v[60:63], v6 offset:39936
    s_waitcnt lgkmcnt(2)
    v_mfma_f32_16x16x32_bf16 v[16:19], a[72:75], v[48:51], v[16:19]
    v_mfma_f32_16x16x32_bf16 v[32:35], a[72:75], v[52:55], v[32:35]
    v_mfma_f32_16x16x32_bf16 v[20:23], a[152:155], v[48:51], v[20:23]
    v_mfma_f32_16x16x32_bf16 v[36:39], a[152:155], v[52:55], v[36:39]
    v_mfma_f32_16x16x32_bf16 v[24:27], a[232:235], v[48:51], v[24:27]
    v_mfma_f32_16x16x32_bf16 v[40:43], a[232:235], v[52:55], v[40:43]
    v_mfma_f32_16x16x32_bf16 v[28:31], v[248:251], v[48:51], v[28:31]
    v_mfma_f32_16x16x32_bf16 v[44:47], v[248:251], v[52:55], v[44:47]
    s_add_u32 m0, s64, 9216
    s_add_u32 s47, s63, 20736
    buffer_load_dwordx4 v4, s[12:15], s47 offen lds
    s_waitcnt lgkmcnt(0)
    v_mfma_f32_16x16x32_bf16 v[16:19], a[76:79], v[56:59], v[16:19]
    v_mfma_f32_16x16x32_bf16 v[32:35], a[76:79], v[60:63], v[32:35]
    v_mfma_f32_16x16x32_bf16 v[20:23], a[156:159], v[56:59], v[20:23]
    v_mfma_f32_16x16x32_bf16 v[36:39], a[156:159], v[60:63], v[36:39]
    v_mfma_f32_16x16x32_bf16 v[24:27], a[236:239], v[56:59], v[24:27]
    v_mfma_f32_16x16x32_bf16 v[40:43], a[236:239], v[60:63], v[40:43]
    v_mfma_f32_16x16x32_bf16 v[28:31], v[252:255], v[56:59], v[28:31]
    v_mfma_f32_16x16x32_bf16 v[44:47], v[252:255], v[60:63], v[44:47]
    s_mul_i32 s57, s34, 98304
    s_add_u32 s57, s57, s53
    v_mul_f32 v64, 3216550459, v16
    v_exp_f32 v64, v64
    s_nop 0
    v_add_f32 v64, 1.0, v64
    v_rcp_f32 v64, v64
    v_mul_f32 v65, 3216550459, v17
    v_exp_f32 v65, v65
    s_nop 0
    v_add_f32 v65, 1.0, v65
    v_rcp_f32 v65, v65
    v_mul_f32 v66, 3216550459, v18
    v_exp_f32 v66, v66
    s_nop 0
    v_add_f32 v66, 1.0, v66
    v_rcp_f32 v66, v66
    v_mul_f32 v67, 3216550459, v19
    v_exp_f32 v67, v67
    s_nop 0
    v_add_f32 v67, 1.0, v67
    v_rcp_f32 v67, v67
    v_mul_f32 v68, 3216550459, v20
    v_exp_f32 v68, v68
    s_nop 0
    v_add_f32 v68, 1.0, v68
    v_rcp_f32 v68, v68
    v_mul_f32 v69, 3216550459, v21
    v_exp_f32 v69, v69
    s_nop 0
    v_add_f32 v69, 1.0, v69
    v_rcp_f32 v69, v69
    v_mul_f32 v70, 3216550459, v22
    v_exp_f32 v70, v70
    s_nop 0
    v_add_f32 v70, 1.0, v70
    v_rcp_f32 v70, v70
    v_mul_f32 v71, 3216550459, v23
    v_exp_f32 v71, v71
    s_nop 0
    v_add_f32 v71, 1.0, v71
    v_rcp_f32 v71, v71
    v_mul_f32 v64, v64, v24
    v_mul_f32 v65, v65, v25
    v_mul_f32 v66, v66, v26
    v_mul_f32 v67, v67, v27
    v_mul_f32 v68, v68, v28
    v_mul_f32 v69, v69, v29
    v_mul_f32 v70, v70, v30
    v_mul_f32 v71, v71, v31
    v_cvt_pk_bf16_f32 v72, v64, v65
    v_cvt_pk_bf16_f32 v73, v66, v67
    v_cvt_pk_bf16_f32 v74, v68, v69
    v_cvt_pk_bf16_f32 v75, v70, v71
    s_add_u32 s45, s57, 0
    buffer_store_dwordx4 v[72:75], v8, s[8:11], s45 offen sc1
    v_mul_f32 v64, 3216550459, v32
    v_exp_f32 v64, v64
    s_nop 0
    v_add_f32 v64, 1.0, v64
    v_rcp_f32 v64, v64
    v_mul_f32 v65, 3216550459, v33
    v_exp_f32 v65, v65
    s_nop 0
    v_add_f32 v65, 1.0, v65
    v_rcp_f32 v65, v65
    v_mul_f32 v66, 3216550459, v34
    v_exp_f32 v66, v66
    s_nop 0
    v_add_f32 v66, 1.0, v66
    v_rcp_f32 v66, v66
    v_mul_f32 v67, 3216550459, v35
    v_exp_f32 v67, v67
    s_nop 0
    v_add_f32 v67, 1.0, v67
    v_rcp_f32 v67, v67
    v_mul_f32 v68, 3216550459, v36
    v_exp_f32 v68, v68
    s_nop 0
    v_add_f32 v68, 1.0, v68
    v_rcp_f32 v68, v68
    v_mul_f32 v69, 3216550459, v37
    v_exp_f32 v69, v69
    s_nop 0
    v_add_f32 v69, 1.0, v69
    v_rcp_f32 v69, v69
    v_mul_f32 v70, 3216550459, v38
    v_exp_f32 v70, v70
    s_nop 0
    v_add_f32 v70, 1.0, v70
    v_rcp_f32 v70, v70
    v_mul_f32 v71, 3216550459, v39
    v_exp_f32 v71, v71
    s_nop 0
    v_add_f32 v71, 1.0, v71
    v_rcp_f32 v71, v71
    v_mul_f32 v64, v64, v40
    v_mul_f32 v65, v65, v41
    v_mul_f32 v66, v66, v42
    v_mul_f32 v67, v67, v43
    v_mul_f32 v68, v68, v44
    v_mul_f32 v69, v69, v45
    v_mul_f32 v70, v70, v46
    v_mul_f32 v71, v71, v47
    v_cvt_pk_bf16_f32 v76, v64, v65
    v_cvt_pk_bf16_f32 v77, v66, v67
    v_cvt_pk_bf16_f32 v78, v68, v69
    v_cvt_pk_bf16_f32 v79, v70, v71
    s_add_u32 s45, s57, 49152
    buffer_store_dwordx4 v[76:79], v8, s[8:11], s45 offen sc1
    s_cmp_lg_u32 s58, 0
    s_cbranch_scc1 F1S_105
    ds_read_b128 v[48:51], v6 offset:0
    ds_read_b128 v[52:55], v6 offset:1024
    s_waitcnt lgkmcnt(0)
    v_mfma_f32_16x16x32_bf16 v[80:83], v[100:103], v[48:51], 0
    v_mfma_f32_16x16x32_bf16 v[84:87], v[100:103], v[52:55], 0
    ds_read_b128 v[48:51], v6 offset:2048
    ds_read_b128 v[52:55], v6 offset:3072
    s_waitcnt lgkmcnt(0)
    v_mfma_f32_16x16x32_bf16 v[80:83], v[104:107], v[48:51], v[80:83]
    v_mfma_f32_16x16x32_bf16 v[84:87], v[104:107], v[52:55], v[84:87]
    ds_read_b128 v[48:51], v6 offset:4096
    ds_read_b128 v[52:55], v6 offset:5120
    s_waitcnt lgkmcnt(0)
    v_mfma_f32_16x16x32_bf16 v[80:83], v[108:111], v[48:51], v[80:83]
    v_mfma_f32_16x16x32_bf16 v[84:87], v[108:111], v[52:55], v[84:87]
    ds_read_b128 v[48:51], v6 offset:6144
    ds_read_b128 v[52:55], v6 offset:7168
    s_waitcnt lgkmcnt(0)
    v_mfma_f32_16x16x32_bf16 v[80:83], v[112:115], v[48:51], v[80:83]
    v_mfma_f32_16x16x32_bf16 v[84:87], v[112:115], v[52:55], v[84:87]
    ds_read_b128 v[48:51], v6 offset:8192
    ds_read_b128 v[52:55], v6 offset:9216
    s_waitcnt lgkmcnt(0)
    v_mfma_f32_16x16x32_bf16 v[80:83], v[116:119], v[48:51], v[80:83]
    v_mfma_f32_16x16x32_bf16 v[84:87], v[116:119], v[52:55], v[84:87]
    ds_read_b128 v[48:51], v6 offset:10240
    ds_read_b128 v[52:55], v6 offset:11264
    s_waitcnt lgkmcnt(0)
    v_mfma_f32_16x16x32_bf16 v[80:83], v[120:123], v[48:51], v[80:83]
    v_mfma_f32_16x16x32_bf16 v[84:87], v[120:123], v[52:55], v[84:87]
    ds_read_b128 v[48:51], v6 offset:12288
    ds_read_b128 v[52:55], v6 offset:13312
    s_waitcnt lgkmcnt(0)
    v_mfma_f32_16x16x32_bf16 v[80:83], v[124:127], v[48:51], v[80:83]
    v_mfma_f32_16x16x32_bf16 v[84:87], v[124:127], v[52:55], v[84:87]
    ds_read_b128 v[48:51], v6 offset:14336
    ds_read_b128 v[52:55], v6 offset:15360
    s_waitcnt lgkmcnt(0)
    v_mfma_f32_16x16x32_bf16 v[80:83], v[128:131], v[48:51], v[80:83]
    v_mfma_f32_16x16x32_bf16 v[84:87], v[128:131], v[52:55], v[84:87]
    ds_read_b128 v[48:51], v6 offset:16384
    ds_read_b128 v[52:55], v6 offset:17408
    s_waitcnt lgkmcnt(0)
    v_mfma_f32_16x16x32_bf16 v[80:83], v[132:135], v[48:51], v[80:83]
    v_mfma_f32_16x16x32_bf16 v[84:87], v[132:135], v[52:55], v[84:87]
    ds_read_b128 v[48:51], v6 offset:18432
    ds_read_b128 v[52:55], v6 offset:19456
    s_waitcnt lgkmcnt(0)
    v_mfma_f32_16x16x32_bf16 v[80:83], v[136:139], v[48:51], v[80:83]
    v_mfma_f32_16x16x32_bf16 v[84:87], v[136:139], v[52:55], v[84:87]
    ds_read_b128 v[48:51], v6 offset:20480
    ds_read_b128 v[52:55], v6 offset:21504
    s_waitcnt lgkmcnt(0)
    v_mfma_f32_16x16x32_bf16 v[80:83], v[140:143], v[48:51], v[80:83]
    v_mfma_f32_16x16x32_bf16 v[84:87], v[140:143], v[52:55], v[84:87]
    ds_read_b128 v[48:51], v6 offset:22528
    ds_read_b128 v[52:55], v6 offset:23552
    s_waitcnt lgkmcnt(0)
    v_mfma_f32_16x16x32_bf16 v[80:83], v[144:147], v[48:51], v[80:83]
    v_mfma_f32_16x16x32_bf16 v[84:87], v[144:147], v[52:55], v[84:87]
    ds_read_b128 v[48:51], v6 offset:24576
    ds_read_b128 v[52:55], v6 offset:25600
    s_waitcnt lgkmcnt(0)
    v_mfma_f32_16x16x32_bf16 v[80:83], v[148:151], v[48:51], v[80:83]
    v_mfma_f32_16x16x32_bf16 v[84:87], v[148:151], v[52:55], v[84:87]
    ds_read_b128 v[48:51], v6 offset:26624
    ds_read_b128 v[52:55], v6 offset:27648
    s_waitcnt lgkmcnt(0)
    v_mfma_f32_16x16x32_bf16 v[80:83], v[152:155], v[48:51], v[80:83]
    v_mfma_f32_16x16x32_bf16 v[84:87], v[152:155], v[52:55], v[84:87]
    ds_read_b128 v[48:51], v6 offset:28672
    ds_read_b128 v[52:55], v6 offset:29696
    s_waitcnt lgkmcnt(0)
    v_mfma_f32_16x16x32_bf16 v[80:83], v[156:159], v[48:51], v[80:83]
    v_mfma_f32_16x16x32_bf16 v[84:87], v[156:159], v[52:55], v[84:87]
    ds_read_b128 v[48:51], v6 offset:30720
    ds_read_b128 v[52:55], v6 offset:31744
    s_waitcnt lgkmcnt(0)
    v_mfma_f32_16x16x32_bf16 v[80:83], v[160:163], v[48:51], v[80:83]
    v_mfma_f32_16x16x32_bf16 v[84:87], v[160:163], v[52:55], v[84:87]
    ds_read_b128 v[48:51], v6 offset:32768
    ds_read_b128 v[52:55], v6 offset:33792
    s_waitcnt lgkmcnt(0)
    v_mfma_f32_16x16x32_bf16 v[80:83], v[164:167], v[48:51], v[80:83]
    v_mfma_f32_16x16x32_bf16 v[84:87], v[164:167], v[52:55], v[84:87]
    ds_read_b128 v[48:51], v6 offset:34816
    ds_read_b128 v[52:55], v6 offset:35840
    s_waitcnt lgkmcnt(0)
    v_mfma_f32_16x16x32_bf16 v[80:83], v[168:171], v[48:51], v[80:83]
    v_mfma_f32_16x16x32_bf16 v[84:87], v[168:171], v[52:55], v[84:87]
    ds_read_b128 v[48:51], v6 offset:36864
    ds_read_b128 v[52:55], v6 offset:37888
    s_waitcnt lgkmcnt(0)
    v_mfma_f32_16x16x32_bf16 v[80:83], v[172:175], v[48:51], v[80:83]
    v_mfma_f32_16x16x32_bf16 v[84:87], v[172:175], v[52:55], v[84:87]
    ds_read_b128 v[48:51], v6 offset:38912
    ds_read_b128 v[52:55], v6 offset:39936
    s_waitcnt lgkmcnt(0)
    v_mfma_f32_16x16x32_bf16 v[80:83], v[176:179], v[48:51], v[80:83]
    v_mfma_f32_16x16x32_bf16 v[84:87], v[176:179], v[52:55], v[84:87]
    s_lshl_b32 s45, s34, 7
    s_add_u32 s45, s45, 65536
    s_nop 4
    v_mul_f32 v64, 3216550459, v80
    v_exp_f32 v64, v64
    s_nop 0
    v_add_f32 v64, 1.0, v64
    v_rcp_f32 v64, v64
    v_mul_f32 v65, 3216550459, v84
    v_exp_f32 v65, v65
    s_nop 0
    v_add_f32 v65, 1.0, v65
    v_rcp_f32 v65, v65
    s_mov_b64 exec, 0xffff
    buffer_store_dword v64, v11, s[8:11], s45 offen offset:0 sc1
    buffer_store_dword v65, v11, s[8:11], s45 offen offset:64 sc1
    s_mov_b64 exec, -1
F1S_105:
    s_add_u32 s34, s34, 1
    s_cmp_lt_u32 s34, 64
    s_cbranch_scc1 F1L_100
    s_waitcnt vmcnt(0)
    s_barrier
    s_cmp_lg_u32 s33, 0
    s_cbranch_scc1 F1E_106
    v_mov_b32 v1, 64
    v_mov_b32 v2, s54
    s_mov_b64 exec, 1
    buffer_store_dword v1, v2, s[8:11], 0 offen sc1
    s_mov_b64 exec, -1
F1E_106:
    s_endpgm
L_F2:
    s_waitcnt vmcnt(0) lgkmcnt(0)
    s_barrier
    s_cmp_lg_u32 s33, 0
    s_cbranch_scc1 SI_107
    v_mov_b32 v1, 1
    v_mov_b32 v2, 4
    s_mov_b64 exec, 1
    buffer_atomic_add v1, v2, s[28:31], 0 offen sc1
    s_mov_b64 exec, -1
SI_107:
    s_load_dwordx2 s[4:5], s[0:1], 80
    s_waitcnt lgkmcnt(0)
    s_mov_b32 s16, s4
    s_mov_b32 s17, s5
    s_mov_b32 s18, 1966080
    s_mov_b32 s19, 0x20000
    v_lshlrev_b32 v4, 4, v0
    v_lshrrev_b32 v1, 2, v0
    v_mul_u32_u24 v1, 1280, v1
    v_and_b32 v2, 3, v0
    v_lshl_add_u32 v5, v2, 4, v1
    v_lshrrev_b32 v1, 4, v0
    v_bfe_u32 v3, v0, 2, 2
    v_lshl_add_u32 v1, v1, 3, v3
    v_lshlrev_b32 v1, 6, v1
    v_lshl_add_u32 v6, v2, 4, v1
    s_mul_i32 s50, s33, 16384
    v_add_u32 v6, s50, v6
    s_mul_i32 s51, s33, 491520
    s_lshl_b32 s45, s32, 7
    s_add_u32 s51, s51, s45
    s_add_u32 s46, s51, 0
    s_add_u32 m0, s50, 0
    s_nop 0
    buffer_load_dwordx4 v5, s[16:19], s46 offen lds
    s_add_u32 s46, s51, 20480
    s_add_u32 m0, s50, 1024
    s_nop 0
    buffer_load_dwordx4 v5, s[16:19], s46 offen lds
    s_add_u32 s46, s51, 64
    s_add_u32 m0, s50, 2048
    s_nop 0
    buffer_load_dwordx4 v5, s[16:19], s46 offen lds
    s_add_u32 s46, s51, 20544
    s_add_u32 m0, s50, 3072
    s_nop 0
    buffer_load_dwordx4 v5, s[16:19], s46 offen lds
    s_add_u32 s46, s51, 40960
    s_add_u32 m0, s50, 4096
    s_nop 0
    buffer_load_dwordx4 v5, s[16:19], s46 offen lds
    s_add_u32 s46, s51, 61440
    s_add_u32 m0, s50, 5120
    s_nop 0
    buffer_load_dwordx4 v5, s[16:19], s46 offen lds
    s_add_u32 s46, s51, 41024
    s_add_u32 m0, s50, 6144
    s_nop 0
    buffer_load_dwordx4 v5, s[16:19], s46 offen lds
    s_add_u32 s46, s51, 61504
    s_add_u32 m0, s50, 7168
    s_nop 0
    buffer_load_dwordx4 v5, s[16:19], s46 offen lds
    s_add_u32 s46, s51, 81920
    s_add_u32 m0, s50, 8192
    s_nop 0
    buffer_load_dwordx4 v5, s[16:19], s46 offen lds
    s_add_u32 s46, s51, 102400
    s_add_u32 m0, s50, 9216
    s_nop 0
    buffer_load_dwordx4 v5, s[16:19], s46 offen lds
    s_add_u32 s46, s51, 81984
    s_add_u32 m0, s50, 10240
    s_nop 0
    buffer_load_dwordx4 v5, s[16:19], s46 offen lds
    s_add_u32 s46, s51, 102464
    s_add_u32 m0, s50, 11264
    s_nop 0
    buffer_load_dwordx4 v5, s[16:19], s46 offen lds
    s_add_u32 s46, s51, 122880
    s_add_u32 m0, s50, 12288
    s_nop 0
    buffer_load_dwordx4 v5, s[16:19], s46 offen lds
    s_add_u32 s46, s51, 143360
    s_add_u32 m0, s50, 13312
    s_nop 0
    buffer_load_dwordx4 v5, s[16:19], s46 offen lds
    s_add_u32 s46, s51, 122944
    s_add_u32 m0, s50, 14336
    s_nop 0
    buffer_load_dwordx4 v5, s[16:19], s46 offen lds
    s_add_u32 s46, s51, 143424
    s_add_u32 m0, s50, 15360
    s_nop 0
    buffer_load_dwordx4 v5, s[16:19], s46 offen lds
    s_waitcnt vmcnt(12)
    ds_read_b64_tr_b16 a[0:1], v6 offset:0
    ds_read_b64_tr_b16 a[2:3], v6 offset:256
    ds_read_b64_tr_b16 a[4:5], v6 offset:8
    ds_read_b64_tr_b16 a[6:7], v6 offset:264
    ds_read_b64_tr_b16 a[8:9], v6 offset:2048
    ds_read_b64_tr_b16 a[10:11], v6 offset:2304
    ds_read_b64_tr_b16 a[12:13], v6 offset:2056
    ds_read_b64_tr_b16 a[14:15], v6 offset:2312
    s_waitcnt lgkmcnt(0)
    s_add_u32 s46, s51, 163840
    s_add_u32 m0, s50, 0
    s_nop 0
    buffer_load_dwordx4 v5, s[16:19], s46 offen lds
    s_add_u32 s46, s51, 184320
    s_add_u32 m0, s50, 1024
    s_nop 0
    buffer_load_dwordx4 v5, s[16:19], s46 offen lds
    s_add_u32 s46, s51, 163904
    s_add_u32 m0, s50, 2048
    s_nop 0
    buffer_load_dwordx4 v5, s[16:19], s46 offen lds
    s_add_u32 s46, s51, 184384
    s_add_u32 m0, s50, 3072
    s_nop 0
    buffer_load_dwordx4 v5, s[16:19], s46 offen lds
    s_waitcnt vmcnt(12)
    ds_read_b64_tr_b16 a[16:17], v6 offset:4096
    ds_read_b64_tr_b16 a[18:19], v6 offset:4352
    ds_read_b64_tr_b16 a[20:21], v6 offset:4104
    ds_read_b64_tr_b16 a[22:23], v6 offset:4360
    ds_read_b64_tr_b16 a[24:25], v6 offset:6144
    ds_read_b64_tr_b16 a[26:27], v6 offset:6400
    ds_read_b64_tr_b16 a[28:29], v6 offset:6152
    ds_read_b64_tr_b16 a[30:31], v6 offset:6408
    s_waitcnt lgkmcnt(0)
    s_add_u32 s46, s51, 204800
    s_add_u32 m0, s50, 4096
    s_nop 0
    buffer_load_dwordx4 v5, s[16:19], s46 offen lds
    s_add_u32 s46, s51, 225280
    s_add_u32 m0, s50, 5120
    s_nop 0
    buffer_load_dwordx4 v5, s[16:19], s46 offen lds
    s_add_u32 s46, s51, 204864
    s_add_u32 m0, s50, 6144
    s_nop 0
    buffer_load_dwordx4 v5, s[16:19], s46 offen lds
    s_add_u32 s46, s51, 225344
    s_add_u32 m0, s50, 7168
    s_nop 0
    buffer_load_dwordx4 v5, s[16:19], s46 offen lds
    s_waitcnt vmcnt(12)
    ds_read_b64_tr_b16 a[32:33], v6 offset:8192
    ds_read_b64_tr_b16 a[34:35], v6 offset:8448
    ds_read_b64_tr_b16 a[36:37], v6 offset:8200
    ds_read_b64_tr_b16 a[38:39], v6 offset:8456
    ds_read_b64_tr_b16 a[40:41], v6 offset:10240
    ds_read_b64_tr_b16 a[42:43], v6 offset:10496
    ds_read_b64_tr_b16 a[44:45], v6 offset:10248
    ds_read_b64_tr_b16 a[46:47], v6 offset:10504
    s_waitcnt lgkmcnt(0)
    s_add_u32 s46, s51, 245760
    s_add_u32 m0, s50, 8192
    s_nop 0
    buffer_load_dwordx4 v5, s[16:19], s46 offen lds
    s_add_u32 s46, s51, 266240
    s_add_u32 m0, s50, 9216
    s_nop 0
    buffer_load_dwordx4 v5, s[16:19], s46 offen lds
    s_add_u32 s46, s51, 245824
    s_add_u32 m0, s50, 10240
    s_nop 0
    buffer_load_dwordx4 v5, s[16:19], s46 offen lds
    s_add_u32 s46, s51, 266304
    s_add_u32 m0, s50, 11264
    s_nop 0
    buffer_load_dwordx4 v5, s[16:19], s46 offen lds
    s_waitcnt vmcnt(12)
    ds_read_b64_tr_b16 a[48:49], v6 offset:12288
    ds_read_b64_tr_b16 a[50:51], v6 offset:12544
    ds_read_b64_tr_b16 a[52:53], v6 offset:12296
    ds_read_b64_tr_b16 a[54:55], v6 offset:12552
    ds_read_b64_tr_b16 a[56:57], v6 offset:14336
    ds_read_b64_tr_b16 a[58:59], v6 offset:14592
    ds_read_b64_tr_b16 a[60:61], v6 offset:14344
    ds_read_b64_tr_b16 a[62:63], v6 offset:14600
    s_waitcnt lgkmcnt(0)
    s_add_u32 s46, s51, 286720
    s_add_u32 m0, s50, 12288
    s_nop 0
    buffer_load_dwordx4 v5, s[16:19], s46 offen lds
    s_add_u32 s46, s51, 307200
    s_add_u32 m0, s50, 13312
    s_nop 0
    buffer_load_dwordx4 v5, s[16:19], s46 offen lds
    s_add_u32 s46, s51, 286784
    s_add_u32 m0, s50, 14336
    s_nop 0
    buffer_load_dwordx4 v5, s[16:19], s46 offen lds
    s_add_u32 s46, s51, 307264
    s_add_u32 m0, s50, 15360
    s_nop 0
    buffer_load_dwordx4 v5, s[16:19], s46 offen lds
    s_waitcnt vmcnt(12)
    ds_read_b64_tr_b16 a[64:65], v6 offset:0
    ds_read_b64_tr_b16 a[66:67], v6 offset:256
    ds_read_b64_tr_b16 a[68:69], v6 offset:8
    ds_read_b64_tr_b16 a[70:71], v6 offset:264
    ds_read_b64_tr_b16 a[72:73], v6 offset:2048
    ds_read_b64_tr_b16 a[74:75], v6 offset:2304
    ds_read_b64_tr_b16 a[76:77], v6 offset:2056
    ds_read_b64_tr_b16 a[78:79], v6 offset:2312
    s_waitcnt lgkmcnt(0)
    s_add_u32 s46, s51, 327680
    s_add_u32 m0, s50, 0
    s_nop 0
    buffer_load_dwordx4 v5, s[16:19], s46 offen lds
    s_add_u32 s46, s51, 348160
    s_add_u32 m0, s50, 1024
    s_nop 0
    buffer_load_dwordx4 v5, s[16:19], s46 offen lds
    s_add_u32 s46, s51, 327744
    s_add_u32 m0, s50, 2048
    s_nop 0
    buffer_load_dwordx4 v5, s[16:19], s46 offen lds
    s_add_u32 s46, s51, 348224
    s_add_u32 m0, s50, 3072
    s_nop 0
    buffer_load_dwordx4 v5, s[16:19], s46 offen lds
    s_waitcnt vmcnt(12)
    ds_read_b64_tr_b16 a[80:81], v6 offset:4096
    ds_read_b64_tr_b16 a[82:83], v6 offset:4352
    ds_read_b64_tr_b16 a[84:85], v6 offset:4104
    ds_read_b64_tr_b16 a[86:87], v6 offset:4360
    ds_read_b64_tr_b16 a[88:89], v6 offset:6144
    ds_read_b64_tr_b16 a[90:91], v6 offset:6400
    ds_read_b64_tr_b16 a[92:93], v6 offset:6152
    ds_read_b64_tr_b16 a[94:95], v6 offset:6408
    s_waitcnt lgkmcnt(0)
    s_add_u32 s46, s51, 368640
    s_add_u32 m0, s50, 4096
    s_nop 0
    buffer_load_dwordx4 v5, s[16:19], s46 offen lds
    s_add_u32 s46, s51, 389120
    s_add_u32 m0, s50, 5120
    s_nop 0
    buffer_load_dwordx4 v5, s[16:19], s46 offen lds
    s_add_u32 s46, s51, 368704
    s_add_u32 m0, s50, 6144
    s_nop 0
    buffer_load_dwordx4 v5, s[16:19], s46 offen lds
    s_add_u32 s46, s51, 389184
    s_add_u32 m0, s50, 7168
    s_nop 0
    buffer_load_dwordx4 v5, s[16:19], s46 offen lds
    s_waitcnt vmcnt(12)
    ds_read_b64_tr_b16 a[96:97], v6 offset:8192
    ds_read_b64_tr_b16 a[98:99], v6 offset:8448
    ds_read_b64_tr_b16 a[100:101], v6 offset:8200
    ds_read_b64_tr_b16 a[102:103], v6 offset:8456
    ds_read_b64_tr_b16 a[104:105], v6 offset:10240
    ds_read_b64_tr_b16 a[106:107], v6 offset:10496
    ds_read_b64_tr_b16 a[108:109], v6 offset:10248
    ds_read_b64_tr_b16 a[110:111], v6 offset:10504
    s_waitcnt lgkmcnt(0)
    s_add_u32 s46, s51, 409600
    s_add_u32 m0, s50, 8192
    s_nop 0
    buffer_load_dwordx4 v5, s[16:19], s46 offen lds
    s_add_u32 s46, s51, 430080
    s_add_u32 m0, s50, 9216
    s_nop 0
    buffer_load_dwordx4 v5, s[16:19], s46 offen lds
    s_add_u32 s46, s51, 409664
    s_add_u32 m0, s50, 10240
    s_nop 0
    buffer_load_dwordx4 v5, s[16:19], s46 offen lds
    s_add_u32 s46, s51, 430144
    s_add_u32 m0, s50, 11264
    s_nop 0
    buffer_load_dwordx4 v5, s[16:19], s46 offen lds
    s_waitcnt vmcnt(12)
    ds_read_b64_tr_b16 a[112:113], v6 offset:12288
    ds_read_b64_tr_b16 a[114:115], v6 offset:12544
    ds_read_b64_tr_b16 a[116:117], v6 offset:12296
    ds_read_b64_tr_b16 a[118:119], v6 offset:12552
    ds_read_b64_tr_b16 a[120:121], v6 offset:14336
    ds_read_b64_tr_b16 a[122:123], v6 offset:14592
    ds_read_b64_tr_b16 a[124:125], v6 offset:14344
    ds_read_b64_tr_b16 a[126:127], v6 offset:14600
    s_waitcnt lgkmcnt(0)
    s_add_u32 s46, s51, 450560
    s_add_u32 m0, s50, 12288
    s_nop 0
    buffer_load_dwordx4 v5, s[16:19], s46 offen lds
    s_add_u32 s46, s51, 471040
    s_add_u32 m0, s50, 13312
    s_nop 0
    buffer_load_dwordx4 v5, s[16:19], s46 offen lds
    s_add_u32 s46, s51, 450624
    s_add_u32 m0, s50, 14336
    s_nop 0
    buffer_load_dwordx4 v5, s[16:19], s46 offen lds
    s_add_u32 s46, s51, 471104
    s_add_u32 m0, s50, 15360
    s_nop 0
    buffer_load_dwordx4 v5, s[16:19], s46 offen lds
    s_waitcnt vmcnt(12)
    ds_read_b64_tr_b16 a[128:129], v6 offset:0
    ds_read_b64_tr_b16 a[130:131], v6 offset:256
    ds_read_b64_tr_b16 a[132:133], v6 offset:8
    ds_read_b64_tr_b16 a[134:135], v6 offset:264
    ds_read_b64_tr_b16 a[136:137], v6 offset:2048
    ds_read_b64_tr_b16 a[138:139], v6 offset:2304
    ds_read_b64_tr_b16 a[140:141], v6 offset:2056
    ds_read_b64_tr_b16 a[142:143], v6 offset:2312
    s_waitcnt lgkmcnt(0)
    s_waitcnt vmcnt(8)
    ds_read_b64_tr_b16 a[144:145], v6 offset:4096
    ds_read_b64_tr_b16 a[146:147], v6 offset:4352
    ds_read_b64_tr_b16 a[148:149], v6 offset:4104
    ds_read_b64_tr_b16 a[150:151], v6 offset:4360
    ds_read_b64_tr_b16 a[152:153], v6 offset:6144
    ds_read_b64_tr_b16 a[154:155], v6 offset:6400
    ds_read_b64_tr_b16 a[156:157], v6 offset:6152
    ds_read_b64_tr_b16 a[158:159], v6 offset:6408
    s_waitcnt lgkmcnt(0)
    s_waitcnt vmcnt(4)
    ds_read_b64_tr_b16 a[160:161], v6 offset:8192
    ds_read_b64_tr_b16 a[162:163], v6 offset:8448
    ds_read_b64_tr_b16 a[164:165], v6 offset:8200
    ds_read_b64_tr_b16 a[166:167], v6 offset:8456
    ds_read_b64_tr_b16 a[168:169], v6 offset:10240
    ds_read_b64_tr_b16 a[170:171], v6 offset:10496
    ds_read_b64_tr_b16 a[172:173], v6 offset:10248
    ds_read_b64_tr_b16 a[174:175], v6 offset:10504
    s_waitcnt lgkmcnt(0)
    s_waitcnt vmcnt(0)
    ds_read_b64_tr_b16 a[176:177], v6 offset:12288
    ds_read_b64_tr_b16 a[178:179], v6 offset:12544
    ds_read_b64_tr_b16 a[180:181], v6 offset:12296
    ds_read_b64_tr_b16 a[182:183], v6 offset:12552
    ds_read_b64_tr_b16 a[184:185], v6 offset:14336
    ds_read_b64_tr_b16 a[186:187], v6 offset:14592
    ds_read_b64_tr_b16 a[188:189], v6 offset:14344
    ds_read_b64_tr_b16 a[190:191], v6 offset:14600
    s_waitcnt lgkmcnt(0)
    v_and_b32 v1, 15, v0
    v_min_u32 v1, 11, v1
    v_lshlrev_b32 v1, 2, v1
    v_add_u32 v1, 8448, v1
    v_and_b32 v2, 15, v0
    v_lshlrev_b32 v2, 2, v2
    s_lshl_b32 s45, s32, 7
    s_add_u32 s45, s45, 8704
    v_add_u32 v2, s45, v2
    v_and_b32 v3, 16, v0
    v_cmp_ne_u32 s[66:67], 0, v3
    s_nop 1
    v_cndmask_b32 v7, v1, v2, s[66:67]
    s_and_b32 s48, s33, 1
    s_lshr_b32 s49, s33, 1
    v_lshrrev_b32 v1, 4, v0
    v_and_b32 v2, 15, v0
    v_lshrrev_b32 v3, 1, v1
    v_lshlrev_b32 v3, 11, v3
    v_lshl_add_u32 v9, v2, 4, v3
    v_and_b32 v3, 1, v1
    v_lshl_add_u32 v9, v3, 9, v9
    s_lshl_b32 s53, s32, 2
    s_lshl_b32 s45, s49, 1
    s_add_u32 s53, s53, s45
    s_lshl_b32 s53, s53, 11
    s_lshl_b32 s45, s48, 10
    s_add_u32 s53, s53, s45
    s_add_u32 s53, s53, 13631488
    v_lshlrev_b32 v10, 2, v2
    s_lshl_b32 s45, s48, 6
    s_add_u32 s54, s45, 65536
    v_mul_u32_u24 v3, 1280, v2
    v_lshl_add_u32 v11, v1, 4, v3
    s_mul_i32 s55, s48, 20480
    s_lshl_b32 s45, s32, 7
    s_add_u32 s55, s55, s45
    s_lshl_b32 s45, s49, 6
    s_add_u32 s55, s55, s45
    s_lshl_b32 s45, s33, 13
    s_add_u32 s45, s45, 65536
    v_add_u32 v12, s45, v4
    s_lshl_b32 s45, s48, 12
    s_lshl_b32 s46, s49, 11
    s_add_u32 s45, s45, s46
    s_add_u32 s45, s45, 65536
    v_add_u32 v13, s45, v4
    s_mul_i32 s52, s33, 12288
    s_add_u32 s52, s52, 7340032
    v_mov_b32 v2, 4
    s_movk_i32 s45, 254
PL_108:
    buffer_load_dword v1, v2, s[28:31], 0 offen sc1
    s_waitcnt vmcnt(0)
    v_cmp_gt_u32 vcc, s45, v1
    s_cbranch_vccz PD_109
    s_sub_u32 s35, s35, 1
    s_cbranch_scc1 TO_110
    s_branch PL_108
PD_109:
    v_and_b32 v1, 15, v0
    v_min_u32 v1, 11, v1
    v_lshlrev_b32 v1, 2, v1
    v_add_u32 v2, 8448, v1
    s_mov_b32 s46, 1
PL_111:
    buffer_load_dword v1, v2, s[8:11], 0 offen sc1
    s_waitcnt vmcnt(0)
    v_cmp_gt_u32 vcc, s46, v1
    s_cbranch_vccz PD_112
    s_sub_u32 s35, s35, 1
    s_cbranch_scc1 TO_113
    s_branch PL_111
PD_112:
    s_mul_i32 s45, s34, 98304
    s_add_u32 s45, s45, s52
    buffer_load_dwordx4 v[64:67], v4, s[8:11], s45 offen offset:0 sc1
    buffer_load_dwordx4 v[68:71], v4, s[8:11], s45 offen offset:1024 sc1
    buffer_load_dwordx4 v[72:75], v4, s[8:11], s45 offen offset:2048 sc1
    buffer_load_dwordx4 v[76:79], v4, s[8:11], s45 offen offset:3072 sc1
    s_add_u32 s45, s45, 4096
    buffer_load_dwordx4 v[80:83], v4, s[8:11], s45 offen offset:0 sc1
    buffer_load_dwordx4 v[84:87], v4, s[8:11], s45 offen offset:1024 sc1
    buffer_load_dwordx4 v[88:91], v4, s[8:11], s45 offen offset:2048 sc1
    buffer_load_dwordx4 v[92:95], v4, s[8:11], s45 offen offset:3072 sc1
    s_add_u32 s45, s45, 4096
    buffer_load_dwordx4 v[96:99], v4, s[8:11], s45 offen offset:0 sc1
    buffer_load_dwordx4 v[100:103], v4, s[8:11], s45 offen offset:1024 sc1
    buffer_load_dwordx4 v[104:107], v4, s[8:11], s45 offen offset:2048 sc1
    buffer_load_dwordx4 v[108:111], v4, s[8:11], s45 offen offset:3072 sc1
    s_add_u32 s45, s45, 40960
    buffer_load_dwordx4 v[112:115], v4, s[8:11], s45 offen offset:0 sc1
    buffer_load_dwordx4 v[116:119], v4, s[8:11], s45 offen offset:1024 sc1
    buffer_load_dwordx4 v[120:123], v4, s[8:11], s45 offen offset:2048 sc1
    buffer_load_dwordx4 v[124:127], v4, s[8:11], s45 offen offset:3072 sc1
    s_add_u32 s45, s45, 4096
    buffer_load_dwordx4 v[128:131], v4, s[8:11], s45 offen offset:0 sc1
    buffer_load_dwordx4 v[132:135], v4, s[8:11], s45 offen offset:1024 sc1
    buffer_load_dwordx4 v[136:139], v4, s[8:11], s45 offen offset:2048 sc1
    buffer_load_dwordx4 v[140:143], v4, s[8:11], s45 offen offset:3072 sc1
    s_add_u32 s45, s45, 4096
    buffer_load_dwordx4 v[144:147], v4, s[8:11], s45 offen offset:0 sc1
    buffer_load_dwordx4 v[148:151], v4, s[8:11], s45 offen offset:1024 sc1
    buffer_load_dwordx4 v[152:155], v4, s[8:11], s45 offen offset:2048 sc1
    buffer_load_dwordx4 v[156:159], v4, s[8:11], s45 offen offset:3072 sc1
F2L_114:
    s_add_u32 s56, s34, 1
    s_add_u32 s57, s34, 2
    s_min_u32 s57, s57, 64
    v_mov_b32 v2, s57
    v_mov_b32 v3, s56
    v_cndmask_b32 v8, v2, v3, s[66:67]
PL_116:
    buffer_load_dword v1, v7, s[8:11], 0 offen sc1
    s_waitcnt vmcnt(0)
    v_cmp_gt_u32 vcc, v8, v1
    s_cbranch_vccz PD_117
    s_sub_u32 s35, s35, 1
    s_cbranch_scc1 TO_118
    s_branch PL_116
PD_117:
    s_mul_i32 s45, s34, 163840
    s_add_u32 s45, s45, s53
    buffer_load_dwordx4 v[48:51], v9, s[8:11], s45 offen offset:0 sc1
    buffer_load_dwordx4 v[52:55], v9, s[8:11], s45 offen offset:256 sc1
    s_add_u32 s45, s45, 81920
    buffer_load_dwordx4 v[56:59], v9, s[8:11], s45 offen offset:0 sc1
    buffer_load_dwordx4 v[60:63], v9, s[8:11], s45 offen offset:256 sc1
    s_lshl_b32 s45, s34, 7
    s_add_u32 s45, s45, s54
    buffer_load_dword v14, v10, s[8:11], s45 offen sc1
    s_min_u32 s46, s56, 63
    s_mul_i32 s45, s46, 98304
    s_add_u32 s45, s45, s52
    buffer_load_dwordx4 v[160:163], v4, s[8:11], s45 offen offset:0 sc1
    buffer_load_dwordx4 v[164:167], v4, s[8:11], s45 offen offset:1024 sc1
    buffer_load_dwordx4 v[168:171], v4, s[8:11], s45 offen offset:2048 sc1
    buffer_load_dwordx4 v[172:175], v4, s[8:11], s45 offen offset:3072 sc1
    s_add_u32 s45, s45, 4096
    buffer_load_dwordx4 v[176:179], v4, s[8:11], s45 offen offset:0 sc1
    buffer_load_dwordx4 v[180:183], v4, s[8:11], s45 offen offset:1024 sc1
    buffer_load_dwordx4 v[184:187], v4, s[8:11], s45 offen offset:2048 sc1
    buffer_load_dwordx4 v[188:191], v4, s[8:11], s45 offen offset:3072 sc1
    s_add_u32 s45, s45, 4096
    buffer_load_dwordx4 v[192:195], v4, s[8:11], s45 offen offset:0 sc1
    buffer_load_dwordx4 v[196:199], v4, s[8:11], s45 offen offset:1024 sc1
    buffer_load_dwordx4 v[200:203], v4, s[8:11], s45 offen offset:2048 sc1
    buffer_load_dwordx4 v[204:207], v4, s[8:11], s45 offen offset:3072 sc1
    s_add_u32 s45, s45, 40960
    buffer_load_dwordx4 v[208:211], v4, s[8:11], s45 offen offset:0 sc1
    buffer_load_dwordx4 v[212:215], v4, s[8:11], s45 offen offset:1024 sc1
    buffer_load_dwordx4 v[216:219], v4, s[8:11], s45 offen offset:2048 sc1
    buffer_load_dwordx4 v[220:223], v4, s[8:11], s45 offen offset:3072 sc1
    s_add_u32 s45, s45, 4096
    buffer_load_dwordx4 v[224:227], v4, s[8:11], s45 offen offset:0 sc1
    buffer_load_dwordx4 v[228:231], v4, s[8:11], s45 offen offset:1024 sc1
    buffer_load_dwordx4 v[232:235], v4, s[8:11], s45 offen offset:2048 sc1
    buffer_load_dwordx4 v[236:239], v4, s[8:11], s45 offen offset:3072 sc1
    s_add_u32 s45, s45, 4096
    buffer_load_dwordx4 v[240:243], v4, s[8:11], s45 offen offset:0 sc1
    buffer_load_dwordx4 v[244:247], v4, s[8:11], s45 offen offset:1024 sc1
    buffer_load_dwordx4 v[248:251], v4, s[8:11], s45 offen offset:2048 sc1
    buffer_load_dwordx4 v[252:255], v4, s[8:11], s45 offen offset:3072 sc1
    v_mfma_f32_16x16x32_bf16 v[16:19], a[0:3], v[64:67], 0
    v_mfma_f32_16x16x32_bf16 v[20:23], a[4:7], v[64:67], 0
    v_mfma_f32_16x16x32_bf16 v[24:27], a[8:11], v[64:67], 0
    v_mfma_f32_16x16x32_bf16 v[28:31], a[12:15], v[64:67], 0
    v_mfma_f32_16x16x32_bf16 v[32:35], a[0:3], v[112:115], 0
    v_mfma_f32_16x16x32_bf16 v[36:39], a[4:7], v[112:115], 0
    v_mfma_f32_16x16x32_bf16 v[40:43], a[8:11], v[112:115], 0
    v_mfma_f32_16x16x32_bf16 v[44:47], a[12:15], v[112:115], 0
    v_mfma_f32_16x16x32_bf16 v[16:19], a[16:19], v[68:71], v[16:19]
    v_mfma_f32_16x16x32_bf16 v[20:23], a[20:23], v[68:71], v[20:23]
    v_mfma_f32_16x16x32_bf16 v[24:27], a[24:27], v[68:71], v[24:27]
    v_mfma_f32_16x16x32_bf16 v[28:31], a[28:31], v[68:71], v[28:31]
    v_mfma_f32_16x16x32_bf16 v[32:35], a[16:19], v[116:119], v[32:35]
    v_mfma_f32_16x16x32_bf16 v[36:39], a[20:23], v[116:119], v[36:39]
    v_mfma_f32_16x16x32_bf16 v[40:43], a[24:27], v[116:119], v[40:43]
    v_mfma_f32_16x16x32_bf16 v[44:47], a[28:31], v[116:119], v[44:47]
    v_mfma_f32_16x16x32_bf16 v[16:19], a[32:35], v[72:75], v[16:19]
    v_mfma_f32_16x16x32_bf16 v[20:23], a[36:39], v[72:75], v[20:23]
    v_mfma_f32_16x16x32_bf16 v[24:27], a[40:43], v[72:75], v[24:27]
    v_mfma_f32_16x16x32_bf16 v[28:31], a[44:47], v[72:75], v[28:31]
    v_mfma_f32_16x16x32_bf16 v[32:35], a[32:35], v[120:123], v[32:35]
    v_mfma_f32_16x16x32_bf16 v[36:39], a[36:39], v[120:123], v[36:39]
    v_mfma_f32_16x16x32_bf16 v[40:43], a[40:43], v[120:123], v[40:43]
    v_mfma_f32_16x16x32_bf16 v[44:47], a[44:47], v[120:123], v[44:47]
    v_mfma_f32_16x16x32_bf16 v[16:19], a[48:51], v[76:79], v[16:19]
    v_mfma_f32_16x16x32_bf16 v[20:23], a[52:55], v[76:79], v[20:23]
    v_mfma_f32_16x16x32_bf16 v[24:27], a[56:59], v[76:79], v[24:27]
    v_mfma_f32_16x16x32_bf16 v[28:31], a[60:63], v[76:79], v[28:31]
    v_mfma_f32_16x16x32_bf16 v[32:35], a[48:51], v[124:127], v[32:35]
    v_mfma_f32_16x16x32_bf16 v[36:39], a[52:55], v[124:127], v[36:39]
    v_mfma_f32_16x16x32_bf16 v[40:43], a[56:59], v[124:127], v[40:43]
    v_mfma_f32_16x16x32_bf16 v[44:47], a[60:63], v[124:127], v[44:47]
    v_mfma_f32_16x16x32_bf16 v[16:19], a[64:67], v[80:83], v[16:19]
    v_mfma_f32_16x16x32_bf16 v[20:23], a[68:71], v[80:83], v[20:23]
    v_mfma_f32_16x16x32_bf16 v[24:27], a[72:75], v[80:83], v[24:27]
    v_mfma_f32_16x16x32_bf16 v[28:31], a[76:79], v[80:83], v[28:31]
    v_mfma_f32_16x16x32_bf16 v[32:35], a[64:67], v[128:131], v[32:35]
    v_mfma_f32_16x16x32_bf16 v[36:39], a[68:71], v[128:131], v[36:39]
    v_mfma_f32_16x16x32_bf16 v[40:43], a[72:75], v[128:131], v[40:43]
    v_mfma_f32_16x16x32_bf16 v[44:47], a[76:79], v[128:131], v[44:47]
    v_mfma_f32_16x16x32_bf16 v[16:19], a[80:83], v[84:87], v[16:19]
    v_mfma_f32_16x16x32_bf16 v[20:23], a[84:87], v[84:87], v[20:23]
    v_mfma_f32_16x16x32_bf16 v[24:27], a[88:91], v[84:87], v[24:27]
    v_mfma_f32_16x16x32_bf16 v[28:31], a[92:95], v[84:87], v[28:31]
    v_mfma_f32_16x16x32_bf16 v[32:35], a[80:83], v[132:135], v[32:35]
    v_mfma_f32_16x16x32_bf16 v[36:39], a[84:87], v[132:135], v[36:39]
    v_mfma_f32_16x16x32_bf16 v[40:43], a[88:91], v[132:135], v[40:43]
    v_mfma_f32_16x16x32_bf16 v[44:47], a[92:95], v[132:135], v[44:47]
    v_mfma_f32_16x16x32_bf16 v[16:19], a[96:99], v[88:91], v[16:19]
    v_mfma_f32_16x16x32_bf16 v[20:23], a[100:103], v[88:91], v[20:23]
    v_mfma_f32_16x16x32_bf16 v[24:27], a[104:107], v[88:91], v[24:27]
    v_mfma_f32_16x16x32_bf16 v[28:31], a[108:111], v[88:91], v[28:31]
    v_mfma_f32_16x16x32_bf16 v[32:35], a[96:99], v[136:139], v[32:35]
    v_mfma_f32_16x16x32_bf16 v[36:39], a[100:103], v[136:139], v[36:39]
    v_mfma_f32_16x16x32_bf16 v[40:43], a[104:107], v[136:139], v[40:43]
    v_mfma_f32_16x16x32_bf16 v[44:47], a[108:111], v[136:139], v[44:47]
    v_mfma_f32_16x16x32_bf16 v[16:19], a[112:115], v[92:95], v[16:19]
    v_mfma_f32_16x16x32_bf16 v[20:23], a[116:119], v[92:95], v[20:23]
    v_mfma_f32_16x16x32_bf16 v[24:27], a[120:123], v[92:95], v[24:27]
    v_mfma_f32_16x16x32_bf16 v[28:31], a[124:127], v[92:95], v[28:31]
    v_mfma_f32_16x16x32_bf16 v[32:35], a[112:115], v[140:143], v[32:35]
    v_mfma_f32_16x16x32_bf16 v[36:39], a[116:119], v[140:143], v[36:39]
    v_mfma_f32_16x16x32_bf16 v[40:43], a[120:123], v[140:143], v[40:43]
    v_mfma_f32_16x16x32_bf16 v[44:47], a[124:127], v[140:143], v[44:47]
    v_mfma_f32_16x16x32_bf16 v[16:19], a[128:131], v[96:99], v[16:19]
    v_mfma_f32_16x16x32_bf16 v[20:23], a[132:135], v[96:99], v[20:23]
    v_mfma_f32_16x16x32_bf16 v[24:27], a[136:139], v[96:99], v[24:27]
    v_mfma_f32_16x16x32_bf16 v[28:31], a[140:143], v[96:99], v[28:31]
    v_mfma_f32_16x16x32_bf16 v[32:35], a[128:131], v[144:147], v[32:35]
    v_mfma_f32_16x16x32_bf16 v[36:39], a[132:135], v[144:147], v[36:39]
    v_mfma_f32_16x16x32_bf16 v[40:43], a[136:139], v[144:147], v[40:43]
    v_mfma_f32_16x16x32_bf16 v[44:47], a[140:143], v[144:147], v[44:47]
    v_mfma_f32_16x16x32_bf16 v[16:19], a[144:147], v[100:103], v[16:19]
    v_mfma_f32_16x16x32_bf16 v[20:23], a[148:151], v[100:103], v[20:23]
    v_mfma_f32_16x16x32_bf16 v[24:27], a[152:155], v[100:103], v[24:27]
    v_mfma_f32_16x16x32_bf16 v[28:31], a[156:159], v[100:103], v[28:31]
    v_mfma_f32_16x16x32_bf16 v[32:35], a[144:147], v[148:151], v[32:35]
    v_mfma_f32_16x16x32_bf16 v[36:39], a[148:151], v[148:151], v[36:39]
    v_mfma_f32_16x16x32_bf16 v[40:43], a[152:155], v[148:151], v[40:43]
    v_mfma_f32_16x16x32_bf16 v[44:47], a[156:159], v[148:151], v[44:47]
    v_mfma_f32_16x16x32_bf16 v[16:19], a[160:163], v[104:107], v[16:19]
    v_mfma_f32_16x16x32_bf16 v[20:23], a[164:167], v[104:107], v[20:23]
    v_mfma_f32_16x16x32_bf16 v[24:27], a[168:171], v[104:107], v[24:27]
    v_mfma_f32_16x16x32_bf16 v[28:31], a[172:175], v[104:107], v[28:31]
    v_mfma_f32_16x16x32_bf16 v[32:35], a[160:163], v[152:155], v[32:35]
    v_mfma_f32_16x16x32_bf16 v[36:39], a[164:167], v[152:155], v[36:39]
    v_mfma_f32_16x16x32_bf16 v[40:43], a[168:171], v[152:155], v[40:43]
    v_mfma_f32_16x16x32_bf16 v[44:47], a[172:175], v[152:155], v[44:47]
    v_mfma_f32_16x16x32_bf16 v[16:19], a[176:179], v[108:111], v[16:19]
    v_mfma_f32_16x16x32_bf16 v[20:23], a[180:183], v[108:111], v[20:23]
    v_mfma_f32_16x16x32_bf16 v[24:27], a[184:187], v[108:111], v[24:27]
    v_mfma_f32_16x16x32_bf16 v[28:31], a[188:191], v[108:111], v[28:31]
    v_mfma_f32_16x16x32_bf16 v[32:35], a[176:179], v[156:159], v[32:35]
    v_mfma_f32_16x16x32_bf16 v[36:39], a[180:183], v[156:159], v[36:39]
    v_mfma_f32_16x16x32_bf16 v[40:43], a[184:187], v[156:159], v[40:43]
    v_mfma_f32_16x16x32_bf16 v[44:47], a[188:191], v[156:159], v[44:47]
    s_nop 0
    ds_write_b128 v12, v[16:19] offset:0
    ds_write_b128 v12, v[20:23] offset:1024
    ds_write_b128 v12, v[24:27] offset:2048
    ds_write_b128 v12, v[28:31] offset:3072
    ds_write_b128 v12, v[32:35] offset:4096
    ds_write_b128 v12, v[36:39] offset:5120
    ds_write_b128 v12, v[40:43] offset:6144
    ds_write_b128 v12, v[44:47] offset:7168
    s_waitcnt lgkmcnt(0)
    s_barrier
    ds_read_b128 v[16:19], v13 offset:0
    ds_read_b128 v[20:23], v13 offset:1024
    ds_read_b128 v[24:27], v13 offset:8192
    ds_read_b128 v[28:31], v13 offset:9216
    ds_read_b128 v[32:35], v13 offset:16384
    ds_read_b128 v[36:39], v13 offset:17408
    ds_read_b128 v[40:43], v13 offset:24576
    ds_read_b128 v[44:47], v13 offset:25600
    s_mul_i32 s45, s34, 40960
    s_add_u32 s45, s45, s55
    s_waitcnt vmcnt(24) lgkmcnt(0)
    v_pk_add_f32 v[16:17], v[16:17], v[24:25]
    v_pk_add_f32 v[32:33], v[32:33], v[40:41]
    v_pk_add_f32 v[18:19], v[18:19], v[26:27]
    v_pk_add_f32 v[34:35], v[34:35], v[42:43]
    v_pk_add_f32 v[20:21], v[20:21], v[28:29]
    v_pk_add_f32 v[36:37], v[36:37], v[44:45]
    v_pk_add_f32 v[22:23], v[22:23], v[30:31]
    v_pk_add_f32 v[38:39], v[38:39], v[46:47]
    v_pk_add_f32 v[16:17], v[16:17], v[32:33]
    v_pk_add_f32 v[18:19], v[18:19], v[34:35]
    v_pk_add_f32 v[20:21], v[20:21], v[36:37]
    v_pk_add_f32 v[22:23], v[22:23], v[38:39]
    v_pk_add_f32 v[48:49], v[48:49], v[56:57]
    v_pk_add_f32 v[50:51], v[50:51], v[58:59]
    v_pk_add_f32 v[52:53], v[52:53], v[60:61]
    v_pk_add_f32 v[54:55], v[54:55], v[62:63]
    v_sub_f32 v48, v48, v16
    v_sub_f32 v49, v49, v17
    v_sub_f32 v50, v50, v18
    v_sub_f32 v51, v51, v19
    v_sub_f32 v52, v52, v20
    v_sub_f32 v53, v53, v21
    v_sub_f32 v54, v54, v22
    v_sub_f32 v55, v55, v23
    v_fma_f32 v16, v14, v48, v16
    v_fma_f32 v17, v14, v49, v17
    v_fma_f32 v18, v14, v50, v18
    v_fma_f32 v19, v14, v51, v19
    v_fma_f32 v20, v14, v52, v20
    v_fma_f32 v21, v14, v53, v21
    v_fma_f32 v22, v14, v54, v22
    v_fma_f32 v23, v14, v55, v23
    v_cvt_pk_bf16_f32 v48, v16, v17
    v_cvt_pk_bf16_f32 v49, v18, v19
    v_cvt_pk_bf16_f32 v50, v20, v21
    v_cvt_pk_bf16_f32 v51, v22, v23
    buffer_store_dwordx4 v[48:51], v11, s[24:27], s45 offen
    s_add_u32 s34, s34, 1
    s_cmp_lg_u32 s34, 63
    s_cbranch_scc1 F2A_119
    s_waitcnt vmcnt(0)
    s_branch F2G_120
F2A_119:
    s_add_u32 s56, s34, 1
    s_add_u32 s57, s34, 2
    s_min_u32 s57, s57, 64
    v_mov_b32 v2, s57
    v_mov_b32 v3, s56
    v_cndmask_b32 v8, v2, v3, s[66:67]
PL_122:
    buffer_load_dword v1, v7, s[8:11], 0 offen sc1
    s_waitcnt vmcnt(0)
    v_cmp_gt_u32 vcc, v8, v1
    s_cbranch_vccz PD_123
    s_sub_u32 s35, s35, 1
    s_cbranch_scc1 TO_124
    s_branch PL_122
PD_123:
    s_mul_i32 s45, s34, 163840
    s_add_u32 s45, s45, s53
    buffer_load_dwordx4 v[48:51], v9, s[8:11], s45 offen offset:0 sc1
    buffer_load_dwordx4 v[52:55], v9, s[8:11], s45 offen offset:256 sc1
    s_add_u32 s45, s45, 81920
    buffer_load_dwordx4 v[56:59], v9, s[8:11], s45 offen offset:0 sc1
    buffer_load_dwordx4 v[60:63], v9, s[8:11], s45 offen offset:256 sc1
    s_lshl_b32 s45, s34, 7
    s_add_u32 s45, s45, s54
    buffer_load_dword v14, v10, s[8:11], s45 offen sc1
    s_cmp_lg_u32 s34, 63
    s_cbranch_scc1 F2H_125
    s_waitcnt vmcnt(0)
    s_branch F2F_121
F2H_125:
    s_min_u32 s46, s56, 63
    s_mul_i32 s45, s46, 98304
    s_add_u32 s45, s45, s52
    buffer_load_dwordx4 v[64:67], v4, s[8:11], s45 offen offset:0 sc1
    buffer_load_dwordx4 v[68:71], v4, s[8:11], s45 offen offset:1024 sc1
    buffer_load_dwordx4 v[72:75], v4, s[8:11], s45 offen offset:2048 sc1
    buffer_load_dwordx4 v[76:79], v4, s[8:11], s45 offen offset:3072 sc1
    s_add_u32 s45, s45, 4096
    buffer_load_dwordx4 v[80:83], v4, s[8:11], s45 offen offset:0 sc1
    buffer_load_dwordx4 v[84:87], v4, s[8:11], s45 offen offset:1024 sc1
    buffer_load_dwordx4 v[88:91], v4, s[8:11], s45 offen offset:2048 sc1
    buffer_load_dwordx4 v[92:95], v4, s[8:11], s45 offen offset:3072 sc1
    s_add_u32 s45, s45, 4096
    buffer_load_dwordx4 v[96:99], v4, s[8:11], s45 offen offset:0 sc1
    buffer_load_dwordx4 v[100:103], v4, s[8:11], s45 offen offset:1024 sc1
    buffer_load_dwordx4 v[104:107], v4, s[8:11], s45 offen offset:2048 sc1
    buffer_load_dwordx4 v[108:111], v4, s[8:11], s45 offen offset:3072 sc1
    s_add_u32 s45, s45, 40960
    buffer_load_dwordx4 v[112:115], v4, s[8:11], s45 offen offset:0 sc1
    buffer_load_dwordx4 v[116:119], v4, s[8:11], s45 offen offset:1024 sc1
    buffer_load_dwordx4 v[120:123], v4, s[8:11], s45 offen offset:2048 sc1
    buffer_load_dwordx4 v[124:127], v4, s[8:11], s45 offen offset:3072 sc1
    s_add_u32 s45, s45, 4096
    buffer_load_dwordx4 v[128:131], v4, s[8:11], s45 offen offset:0 sc1
    buffer_load_dwordx4 v[132:135], v4, s[8:11], s45 offen offset:1024 sc1
    buffer_load_dwordx4 v[136:139], v4, s[8:11], s45 offen offset:2048 sc1
    buffer_load_dwordx4 v[140:143], v4, s[8:11], s45 offen offset:3072 sc1
    s_add_u32 s45, s45, 4096
    buffer_load_dwordx4 v[144:147], v4, s[8:11], s45 offen offset:0 sc1
    buffer_load_dwordx4 v[148:151], v4, s[8:11], s45 offen offset:1024 sc1
    buffer_load_dwordx4 v[152:155], v4, s[8:11], s45 offen offset:2048 sc1
    buffer_load_dwordx4 v[156:159], v4, s[8:11], s45 offen offset:3072 sc1
F2G_120:
    v_mfma_f32_16x16x32_bf16 v[16:19], a[0:3], v[160:163], 0
    v_mfma_f32_16x16x32_bf16 v[20:23], a[4:7], v[160:163], 0
    v_mfma_f32_16x16x32_bf16 v[24:27], a[8:11], v[160:163], 0
    v_mfma_f32_16x16x32_bf16 v[28:31], a[12:15], v[160:163], 0
    v_mfma_f32_16x16x32_bf16 v[32:35], a[0:3], v[208:211], 0
    v_mfma_f32_16x16x32_bf16 v[36:39], a[4:7], v[208:211], 0
    v_mfma_f32_16x16x32_bf16 v[40:43], a[8:11], v[208:211], 0
    v_mfma_f32_16x16x32_bf16 v[44:47], a[12:15], v[208:211], 0
    v_mfma_f32_16x16x32_bf16 v[16:19], a[16:19], v[164:167], v[16:19]
    v_mfma_f32_16x16x32_bf16 v[20:23], a[20:23], v[164:167], v[20:23]
    v_mfma_f32_16x16x32_bf16 v[24:27], a[24:27], v[164:167], v[24:27]
    v_mfma_f32_16x16x32_bf16 v[28:31], a[28:31], v[164:167], v[28:31]
    v_mfma_f32_16x16x32_bf16 v[32:35], a[16:19], v[212:215], v[32:35]
    v_mfma_f32_16x16x32_bf16 v[36:39], a[20:23], v[212:215], v[36:39]
    v_mfma_f32_16x16x32_bf16 v[40:43], a[24:27], v[212:215], v[40:43]
    v_mfma_f32_16x16x32_bf16 v[44:47], a[28:31], v[212:215], v[44:47]
    v_mfma_f32_16x16x32_bf16 v[16:19], a[32:35], v[168:171], v[16:19]
    v_mfma_f32_16x16x32_bf16 v[20:23], a[36:39], v[168:171], v[20:23]
    v_mfma_f32_16x16x32_bf16 v[24:27], a[40:43], v[168:171], v[24:27]
    v_mfma_f32_16x16x32_bf16 v[28:31], a[44:47], v[168:171], v[28:31]
    v_mfma_f32_16x16x32_bf16 v[32:35], a[32:35], v[216:219], v[32:35]
    v_mfma_f32_16x16x32_bf16 v[36:39], a[36:39], v[216:219], v[36:39]
    v_mfma_f32_16x16x32_bf16 v[40:43], a[40:43], v[216:219], v[40:43]
    v_mfma_f32_16x16x32_bf16 v[44:47], a[44:47], v[216:219], v[44:47]
    v_mfma_f32_16x16x32_bf16 v[16:19], a[48:51], v[172:175], v[16:19]
    v_mfma_f32_16x16x32_bf16 v[20:23], a[52:55], v[172:175], v[20:23]
    v_mfma_f32_16x16x32_bf16 v[24:27], a[56:59], v[172:175], v[24:27]
    v_mfma_f32_16x16x32_bf16 v[28:31], a[60:63], v[172:175], v[28:31]
    v_mfma_f32_16x16x32_bf16 v[32:35], a[48:51], v[220:223], v[32:35]
    v_mfma_f32_16x16x32_bf16 v[36:39], a[52:55], v[220:223], v[36:39]
    v_mfma_f32_16x16x32_bf16 v[40:43], a[56:59], v[220:223], v[40:43]
    v_mfma_f32_16x16x32_bf16 v[44:47], a[60:63], v[220:223], v[44:47]
    v_mfma_f32_16x16x32_bf16 v[16:19], a[64:67], v[176:179], v[16:19]
    v_mfma_f32_16x16x32_bf16 v[20:23], a[68:71], v[176:179], v[20:23]
    v_mfma_f32_16x16x32_bf16 v[24:27], a[72:75], v[176:179], v[24:27]
    v_mfma_f32_16x16x32_bf16 v[28:31], a[76:79], v[176:179], v[28:31]
    v_mfma_f32_16x16x32_bf16 v[32:35], a[64:67], v[224:227], v[32:35]
    v_mfma_f32_16x16x32_bf16 v[36:39], a[68:71], v[224:227], v[36:39]
    v_mfma_f32_16x16x32_bf16 v[40:43], a[72:75], v[224:227], v[40:43]
    v_mfma_f32_16x16x32_bf16 v[44:47], a[76:79], v[224:227], v[44:47]
    v_mfma_f32_16x16x32_bf16 v[16:19], a[80:83], v[180:183], v[16:19]
    v_mfma_f32_16x16x32_bf16 v[20:23], a[84:87], v[180:183], v[20:23]
    v_mfma_f32_16x16x32_bf16 v[24:27], a[88:91], v[180:183], v[24:27]
    v_mfma_f32_16x16x32_bf16 v[28:31], a[92:95], v[180:183], v[28:31]
    v_mfma_f32_16x16x32_bf16 v[32:35], a[80:83], v[228:231], v[32:35]
    v_mfma_f32_16x16x32_bf16 v[36:39], a[84:87], v[228:231], v[36:39]
    v_mfma_f32_16x16x32_bf16 v[40:43], a[88:91], v[228:231], v[40:43]
    v_mfma_f32_16x16x32_bf16 v[44:47], a[92:95], v[228:231], v[44:47]
    v_mfma_f32_16x16x32_bf16 v[16:19], a[96:99], v[184:187], v[16:19]
    v_mfma_f32_16x16x32_bf16 v[20:23], a[100:103], v[184:187], v[20:23]
    v_mfma_f32_16x16x32_bf16 v[24:27], a[104:107], v[184:187], v[24:27]
    v_mfma_f32_16x16x32_bf16 v[28:31], a[108:111], v[184:187], v[28:31]
    v_mfma_f32_16x16x32_bf16 v[32:35], a[96:99], v[232:235], v[32:35]
    v_mfma_f32_16x16x32_bf16 v[36:39], a[100:103], v[232:235], v[36:39]
    v_mfma_f32_16x16x32_bf16 v[40:43], a[104:107], v[232:235], v[40:43]
    v_mfma_f32_16x16x32_bf16 v[44:47], a[108:111], v[232:235], v[44:47]
    v_mfma_f32_16x16x32_bf16 v[16:19], a[112:115], v[188:191], v[16:19]
    v_mfma_f32_16x16x32_bf16 v[20:23], a[116:119], v[188:191], v[20:23]
    v_mfma_f32_16x16x32_bf16 v[24:27], a[120:123], v[188:191], v[24:27]
    v_mfma_f32_16x16x32_bf16 v[28:31], a[124:127], v[188:191], v[28:31]
    v_mfma_f32_16x16x32_bf16 v[32:35], a[112:115], v[236:239], v[32:35]
    v_mfma_f32_16x16x32_bf16 v[36:39], a[116:119], v[236:239], v[36:39]
    v_mfma_f32_16x16x32_bf16 v[40:43], a[120:123], v[236:239], v[40:43]
    v_mfma_f32_16x16x32_bf16 v[44:47], a[124:127], v[236:239], v[44:47]
    v_mfma_f32_16x16x32_bf16 v[16:19], a[128:131], v[192:195], v[16:19]
    v_mfma_f32_16x16x32_bf16 v[20:23], a[132:135], v[192:195], v[20:23]
    v_mfma_f32_16x16x32_bf16 v[24:27], a[136:139], v[192:195], v[24:27]
    v_mfma_f32_16x16x32_bf16 v[28:31], a[140:143], v[192:195], v[28:31]
    v_mfma_f32_16x16x32_bf16 v[32:35], a[128:131], v[240:243], v[32:35]
    v_mfma_f32_16x16x32_bf16 v[36:39], a[132:135], v[240:243], v[36:39]
    v_mfma_f32_16x16x32_bf16 v[40:43], a[136:139], v[240:243], v[40:43]
    v_mfma_f32_16x16x32_bf16 v[44:47], a[140:143], v[240:243], v[44:47]
    v_mfma_f32_16x16x32_bf16 v[16:19], a[144:147], v[196:199], v[16:19]
    v_mfma_f32_16x16x32_bf16 v[20:23], a[148:151], v[196:199], v[20:23]
    v_mfma_f32_16x16x32_bf16 v[24:27], a[152:155], v[196:199], v[24:27]
    v_mfma_f32_16x16x32_bf16 v[28:31], a[156:159], v[196:199], v[28:31]
    v_mfma_f32_16x16x32_bf16 v[32:35], a[144:147], v[244:247], v[32:35]
    v_mfma_f32_16x16x32_bf16 v[36:39], a[148:151], v[244:247], v[36:39]
    v_mfma_f32_16x16x32_bf16 v[40:43], a[152:155], v[244:247], v[40:43]
    v_mfma_f32_16x16x32_bf16 v[44:47], a[156:159], v[244:247], v[44:47]
    v_mfma_f32_16x16x32_bf16 v[16:19], a[160:163], v[200:203], v[16:19]
    v_mfma_f32_16x16x32_bf16 v[20:23], a[164:167], v[200:203], v[20:23]
    v_mfma_f32_16x16x32_bf16 v[24:27], a[168:171], v[200:203], v[24:27]
    v_mfma_f32_16x16x32_bf16 v[28:31], a[172:175], v[200:203], v[28:31]
    v_mfma_f32_16x16x32_bf16 v[32:35], a[160:163], v[248:251], v[32:35]
    v_mfma_f32_16x16x32_bf16 v[36:39], a[164:167], v[248:251], v[36:39]
    v_mfma_f32_16x16x32_bf16 v[40:43], a[168:171], v[248:251], v[40:43]
    v_mfma_f32_16x16x32_bf16 v[44:47], a[172:175], v[248:251], v[44:47]
    v_mfma_f32_16x16x32_bf16 v[16:19], a[176:179], v[204:207], v[16:19]
    v_mfma_f32_16x16x32_bf16 v[20:23], a[180:183], v[204:207], v[20:23]
    v_mfma_f32_16x16x32_bf16 v[24:27], a[184:187], v[204:207], v[24:27]
    v_mfma_f32_16x16x32_bf16 v[28:31], a[188:191], v[204:207], v[28:31]
    v_mfma_f32_16x16x32_bf16 v[32:35], a[176:179], v[252:255], v[32:35]
    v_mfma_f32_16x16x32_bf16 v[36:39], a[180:183], v[252:255], v[36:39]
    v_mfma_f32_16x16x32_bf16 v[40:43], a[184:187], v[252:255], v[40:43]
    v_mfma_f32_16x16x32_bf16 v[44:47], a[188:191], v[252:255], v[44:47]
    s_nop 0
    ds_write_b128 v12, v[16:19] offset:32768
    ds_write_b128 v12, v[20:23] offset:33792
    ds_write_b128 v12, v[24:27] offset:34816
    ds_write_b128 v12, v[28:31] offset:35840
    ds_write_b128 v12, v[32:35] offset:36864
    ds_write_b128 v12, v[36:39] offset:37888
    ds_write_b128 v12, v[40:43] offset:38912
    ds_write_b128 v12, v[44:47] offset:39936
    s_waitcnt lgkmcnt(0)
    s_barrier
    ds_read_b128 v[16:19], v13 offset:32768
    ds_read_b128 v[20:23], v13 offset:33792
    ds_read_b128 v[24:27], v13 offset:40960
    ds_read_b128 v[28:31], v13 offset:41984
    ds_read_b128 v[32:35], v13 offset:49152
    ds_read_b128 v[36:39], v13 offset:50176
    ds_read_b128 v[40:43], v13 offset:57344
    ds_read_b128 v[44:47], v13 offset:58368
    s_cmp_eq_u32 s34, 63
    s_cbranch_scc1 F2A_119
F2F_121:
    s_mul_i32 s45, s34, 40960
    s_add_u32 s45, s45, s55
    s_waitcnt vmcnt(24) lgkmcnt(0)
    v_pk_add_f32 v[16:17], v[16:17], v[24:25]
    v_pk_add_f32 v[32:33], v[32:33], v[40:41]
    v_pk_add_f32 v[18:19], v[18:19], v[26:27]
    v_pk_add_f32 v[34:35], v[34:35], v[42:43]
    v_pk_add_f32 v[20:21], v[20:21], v[28:29]
    v_pk_add_f32 v[36:37], v[36:37], v[44:45]
    v_pk_add_f32 v[22:23], v[22:23], v[30:31]
    v_pk_add_f32 v[38:39], v[38:39], v[46:47]
    v_pk_add_f32 v[16:17], v[16:17], v[32:33]
    v_pk_add_f32 v[18:19], v[18:19], v[34:35]
    v_pk_add_f32 v[20:21], v[20:21], v[36:37]
    v_pk_add_f32 v[22:23], v[22:23], v[38:39]
    v_pk_add_f32 v[48:49], v[48:49], v[56:57]
    v_pk_add_f32 v[50:51], v[50:51], v[58:59]
    v_pk_add_f32 v[52:53], v[52:53], v[60:61]
    v_pk_add_f32 v[54:55], v[54:55], v[62:63]
    v_sub_f32 v48, v48, v16
    v_sub_f32 v49, v49, v17
    v_sub_f32 v50, v50, v18
    v_sub_f32 v51, v51, v19
    v_sub_f32 v52, v52, v20
    v_sub_f32 v53, v53, v21
    v_sub_f32 v54, v54, v22
    v_sub_f32 v55, v55, v23
    v_fma_f32 v16, v14, v48, v16
    v_fma_f32 v17, v14, v49, v17
    v_fma_f32 v18, v14, v50, v18
    v_fma_f32 v19, v14, v51, v19
    v_fma_f32 v20, v14, v52, v20
    v_fma_f32 v21, v14, v53, v21
    v_fma_f32 v22, v14, v54, v22
    v_fma_f32 v23, v14, v55, v23
    v_cvt_pk_bf16_f32 v48, v16, v17
    v_cvt_pk_bf16_f32 v49, v18, v19
    v_cvt_pk_bf16_f32 v50, v20, v21
    v_cvt_pk_bf16_f32 v51, v22, v23
    buffer_store_dwordx4 v[48:51], v11, s[24:27], s45 offen
    s_add_u32 s34, s34, 1
    s_cmp_lt_u32 s34, 64
    s_cbranch_scc1 F2L_114
    s_waitcnt vmcnt(0)
    s_endpgm
TO_9:
    s_mov_b32 s46, 1
    s_branch L_TIMEOUT
TO_13:
    s_mov_b32 s46, 5
    s_branch L_TIMEOUT
TO_18:
    s_mov_b32 s46, 6
    s_branch L_TIMEOUT
TO_32:
    s_mov_b32 s46, 5
    s_branch L_TIMEOUT
TO_40:
    s_mov_b32 s46, 1
    s_branch L_TIMEOUT
TO_43:
    s_mov_b32 s46, 2
    s_branch L_TIMEOUT
TO_47:
    s_mov_b32 s46, 3
    s_branch L_TIMEOUT
TO_51:
    s_mov_b32 s46, 4
    s_branch L_TIMEOUT
TO_60:
    s_mov_b32 s46, 1
    s_branch L_TIMEOUT
TO_63:
    s_mov_b32 s46, 2
    s_branch L_TIMEOUT
TO_68:
    s_mov_b32 s46, 10
    s_branch L_TIMEOUT
TO_73:
    s_mov_b32 s46, 9
    s_branch L_TIMEOUT
TO_89:
    s_mov_b32 s46, 1
    s_branch L_TIMEOUT
TO_92:
    s_mov_b32 s46, 7
    s_branch L_TIMEOUT
TO_96:
    s_mov_b32 s46, 8
    s_branch L_TIMEOUT
TO_110:
    s_mov_b32 s46, 1
    s_branch L_TIMEOUT
TO_113:
    s_mov_b32 s46, 11
    s_branch L_TIMEOUT
TO_118:
    s_mov_b32 s46, 12
    s_branch L_TIMEOUT
TO_124:
    s_mov_b32 s46, 12
    s_branch L_TIMEOUT
L_TIMEOUT:
    s_lshl_b32 s45, s44, 16
    s_lshl_b32 s46, s46, 8
    s_or_b32 s45, s45, s46
    s_and_b32 s46, s34, 255
    s_or_b32 s45, s45, s46
    s_or_b32 s45, s45, 0x80000000
    v_mov_b32 v1, s45
    v_mov_b32 v2, 8
    s_mov_b64 exec, 1
    buffer_store_dword v1, v2, s[28:31], 0 offen sc1
    s_waitcnt vmcnt(0)
    s_endpgm
.section .rodata,"a"
.p2align 6
.amdhsa_kernel gated_mix__memory_aug_recurrent_mem_tr__glu_gated_glu__prompt_kernel
  .amdhsa_next_free_vgpr 512
  .amdhsa_next_free_sgpr 102
  .amdhsa_accum_offset 256
  .amdhsa_group_segment_fixed_size 0
  .amdhsa_kernarg_size 120
  .amdhsa_user_sgpr_count 2
  .amdhsa_user_sgpr_kernarg_segment_ptr 1
  .amdhsa_system_sgpr_workgroup_id_x 1
.end_amdhsa_kernel
```
